```python
import torch

def _softmax(x, axis=-1):
    return torch.softmax(x, dim=axis)
def _gelu(x):
    return torch.nn.functional.gelu(x, approximate="tanh")
def _silu(x):
    return torch.nn.functional.silu(x)
def _sigmoid(x):
    return torch.sigmoid(x)
def _layernorm(x, axis=-1, eps=1e-5):
    m = x.mean(dim=axis, keepdim=True)
    v = x.var(dim=axis, keepdim=True, unbiased=False)
    return (x - m) / torch.sqrt(v + eps)
def _scatter_add(tgt, idx, src, axis=0):
    return tgt.clone().index_add_(axis, idx, src)
def _segment_sum(src, seg, n):
    out = torch.zeros((n,) + src.shape[1:], dtype=src.dtype)
    return out.index_add_(0, seg, src)
def _pad(x, pw):
    flat = tuple(v for pair in reversed(pw) for v in pair)
    return torch.nn.functional.pad(x, flat)

kernel_name = 'sequential_preLN__gqa_block_cached__glu_gated_glu__decode'

def setup_inputs():

    _w = (lambda a: (lambda t: t.to(torch.bfloat16) if t.is_floating_point() else t)(torch.as_tensor(a)))
    def _A_setup():
        B, Sq, D = 1, 1, 512
        Hq, Hkv, Sk, Dh = 32, 8, 32768, 128
        assert Hq % Hkv == 0, (Hq, Hkv)
        return {
            "x": _w((lambda *s: torch.randn(*s, dtype=torch.bfloat16) * 0.05)(B, Sq, D)),
            "k_cache": _w((lambda *s: torch.randn(*s, dtype=torch.bfloat16) * 3.2)(B, Hkv, Sk, Dh)),
            "v_cache": _w((lambda *s: torch.randn(*s, dtype=torch.bfloat16) * 0.4)(B, Hkv, Sk, Dh)),
            "wq": _w((lambda *s: torch.randn(*s, dtype=torch.bfloat16) * 3.2)(D, Hq * Dh) * (D ** -0.5)),
            "wo": _w((lambda *s: torch.randn(*s, dtype=torch.bfloat16) * 0.4)(Hq * Dh, D) * ((Hq * Dh) ** -0.5)),
        }
    _A_in = _A_setup()

    def _B_setup():
        B, S, D, F = 1, 1, 512, 1792
        return {
            "x": _w((lambda *s: torch.randn(*s, dtype=torch.bfloat16) * 0.05)(B, S, D)),
            "w_gate": _w((lambda *s: torch.randn(*s, dtype=torch.bfloat16) * 0.05)(D, F)),
            "w_up": _w((lambda *s: torch.randn(*s, dtype=torch.bfloat16) * 0.05)(D, F)),
            "w_down": _w((lambda *s: torch.randn(*s, dtype=torch.bfloat16) * 0.05)(F, D)),
        }
    _B_in = _B_setup()

    return {
        "A_x": _A_in["x"],
        "A_k_cache": _A_in["k_cache"],
        "A_v_cache": _A_in["v_cache"],
        "A_wq": _A_in["wq"],
        "A_wo": _A_in["wo"],
        "B_x": _B_in["x"],
        "B_w_gate": _B_in["w_gate"],
        "B_w_up": _B_in["w_up"],
        "B_w_down": _B_in["w_down"],
    }

def reference(A_x, A_k_cache, A_v_cache, A_wq, A_wo, B_x, B_w_gate, B_w_up, B_w_down):
    def _A_ref(x, k_cache, v_cache, wq, wo):
        B, Sq, D = x.shape
        Hq, Dh = 32, 128
        Hkv = k_cache.shape[1]
        rep = Hq // Hkv
        q = (lambda x, *d: x.permute(*d))((x @ wq).reshape(B, Sq, Hq, Dh), 0, 2, 1, 3)
        k = (lambda x, n, axis: torch.repeat_interleave(x, n, dim=axis))(k_cache, rep, axis=1)
        v = (lambda x, n, axis: torch.repeat_interleave(x, n, dim=axis))(v_cache, rep, axis=1)
        scores = torch.einsum("bhqd,bhkd->bhqk", q, k) * (Dh ** -0.5)
        p = _softmax(scores, axis=-1)
        o = torch.einsum("bhqk,bhkd->bhqd", p, v)
        return (lambda x, *d: x.permute(*d))(o, 0, 2, 1, 3).reshape(B, Sq, Hq * Dh) @ wo

    def _B_ref(x, w_gate, w_up, w_down):
        g = torch.einsum("bsd,df->bsf", x, w_gate)
        u = torch.einsum("bsd,df->bsf", x, w_up)
        h = _sigmoid(g) * u
        return torch.einsum("bsf,fd->bsd", h, w_down)

    x = A_x
    h = x + _A_ref(_layernorm(x, axis=-1), A_k_cache, A_v_cache, A_wq, A_wo)
    h2 = h + _B_ref(_layernorm(h, axis=-1), B_w_gate, B_w_up, B_w_down)
    return h2
```

```asm
; @launch grid=(256,1,1) block=(512,1,1) lds=147648
.amdgcn_target "amdgcn-amd-amdhsa--gfx950"
.text
.globl sequential_preLN__gqa_block_cached__glu_gated_glu__decode_kernel
.p2align 8
.type sequential_preLN__gqa_block_cached__glu_gated_glu__decode_kernel,@function
sequential_preLN__gqa_block_cached__glu_gated_glu__decode_kernel:
    s_load_dwordx2 s[8:9], s[0:1], 8
    s_load_dwordx2 s[12:13], s[0:1], 16
    s_load_dwordx2 s[16:17], s[0:1], 88
    s_cmp_ge_u32 s2, 256
    s_cbranch_scc1 L_end
    v_readfirstlane_b32 s3, v0
    s_and_b32 s4, s2, 7
    s_lshr_b32 s5, s2, 3
    v_and_b32 v0, 63, v0
    s_lshr_b32 s3, s3, 6
    s_lshl_b32 s100, s4, 3
    s_add_u32 s100, s100, s5
    s_cmp_lt_u32 s5, 8
    s_cselect_b32 s100, s100, 63
    s_mov_b32 s18, 851968
    s_mov_b32 s19, 0x20000
    s_cmp_ge_u32 s3, 4
    s_cbranch_scc1 L_helper
    s_mov_b32 s10, 0x4000000
    s_mov_b32 s11, 0x20000
    s_mov_b32 s14, 0x4000000
    s_mov_b32 s15, 0x20000
    v_bfe_u32 v1, v0, 2, 2
    v_lshlrev_b32 v1, 8, v1
    v_and_b32 v3, 3, v0
    v_lshl_add_u32 v1, v3, 4, v1
    v_lshrrev_b32 v3, 4, v0
    v_lshl_add_u32 v1, v3, 6, v1
    v_lshlrev_b32 v2, 4, v0
    s_lshl_b32 s56, s4, 23
    s_lshl_b32 s57, s3, 10
    s_add_u32 s56, s56, s57
    s_min_u32 s6, s5, 8
    s_mul_i32 s57, s6, 266240
    s_add_u32 s56, s56, s57
    s_sub_u32 s7, s5, s6
    s_min_u32 s6, s7, 16
    s_mul_i32 s57, s6, 262144
    s_add_u32 s56, s56, s57
    s_sub_u32 s7, s7, s6
    s_mul_i32 s57, s7, 258048
    s_add_u32 s56, s56, s57
    s_cmp_lt_u32 s5, 8
    s_cbranch_scc1 L_stream_1
    s_cmp_ge_u32 s5, 24
    s_cbranch_scc1 L_stream_2
L_stream_0:
    s_mov_b32 s57, s56
    s_waitcnt lgkmcnt(0)
    buffer_load_dwordx4 v[64:67], v1, s[8:11], s56 offen nt
    s_add_u32 s56, s56, 4096
    buffer_load_dwordx4 v[68:71], v1, s[8:11], s56 offen nt
    s_add_u32 s56, s56, 4096
    buffer_load_dwordx4 v[72:75], v1, s[8:11], s56 offen nt
    s_add_u32 s56, s56, 4096
    buffer_load_dwordx4 v[76:79], v1, s[8:11], s56 offen nt
    s_add_u32 s56, s56, 4096
    buffer_load_dwordx4 v[80:83], v1, s[8:11], s56 offen nt
    s_add_u32 s56, s56, 4096
    v_mov_b32 v25, 144000
    v_mov_b32 v26, 1
    s_mov_b32 s58, 0x3db504f3
    s_mov_b32 s59, 0x3fb8aa3b
    s_mov_b32 s60, 0xffff0000
    v_and_b32 v3, 3, v0
    v_lshlrev_b32 v3, 8, v3
    v_bfe_u32 v4, v0, 2, 2
    v_lshl_add_u32 v3, v4, 4, v3
    v_lshrrev_b32 v4, 4, v0
    v_lshl_add_u32 v3, v4, 6, v3
    v_add_u32 v3, 140288, v3
    s_barrier
    s_waitcnt vmcnt(4)
    buffer_load_dwordx4 v[84:87], v1, s[8:11], s56 offen nt
    s_add_u32 s56, s56, 4096
    s_waitcnt vmcnt(4)
    buffer_load_dwordx4 v[88:91], v1, s[8:11], s56 offen nt
    s_add_u32 s56, s56, 4096
    s_waitcnt vmcnt(4)
    buffer_load_dwordx4 v[92:95], v1, s[8:11], s56 offen nt
    s_add_u32 s56, s56, 4096
    s_waitcnt vmcnt(4)
    buffer_load_dwordx4 v[96:99], v1, s[8:11], s56 offen nt
    s_add_u32 s56, s56, 4096
    s_waitcnt vmcnt(4)
    buffer_load_dwordx4 v[100:103], v1, s[8:11], s56 offen nt
    s_add_u32 s56, s56, 4096
    s_waitcnt vmcnt(4)
    buffer_load_dwordx4 v[104:107], v1, s[8:11], s56 offen nt
    s_add_u32 s56, s56, 4096
    s_waitcnt vmcnt(4)
    buffer_load_dwordx4 v[108:111], v1, s[8:11], s56 offen nt
    s_add_u32 s56, s56, 4096
    s_waitcnt vmcnt(4)
    buffer_load_dwordx4 v[112:115], v1, s[8:11], s56 offen nt
    s_add_u32 s56, s56, 4096
    s_waitcnt vmcnt(4)
    buffer_load_dwordx4 v[116:119], v1, s[8:11], s56 offen nt
    s_add_u32 s56, s56, 4096
    s_waitcnt vmcnt(4)
    buffer_load_dwordx4 v[120:123], v1, s[8:11], s56 offen nt
    s_add_u32 s56, s56, 4096
    s_waitcnt vmcnt(4)
    buffer_load_dwordx4 v[124:127], v1, s[8:11], s56 offen nt
    s_add_u32 s56, s56, 4096
    s_waitcnt vmcnt(4)
    buffer_load_dwordx4 v[128:131], v1, s[8:11], s56 offen nt
    s_add_u32 s56, s56, 4096
    s_waitcnt vmcnt(4)
    buffer_load_dwordx4 v[132:135], v1, s[8:11], s56 offen nt
    s_add_u32 s56, s56, 4096
    s_waitcnt vmcnt(4)
    buffer_load_dwordx4 v[136:139], v1, s[8:11], s56 offen nt
    s_add_u32 s56, s56, 4096
    s_mov_b64 exec, 1
    ds_add_u32 v25, v26 offset:12
    s_mov_b64 exec, -1
    s_waitcnt vmcnt(4)
    buffer_load_dwordx4 v[140:143], v1, s[8:11], s56 offen nt
    s_add_u32 s56, s56, 4096
    s_waitcnt vmcnt(4)
    buffer_load_dwordx4 v[144:147], v1, s[8:11], s56 offen nt
    s_add_u32 s56, s56, 4096
    s_waitcnt vmcnt(4)
    buffer_load_dwordx4 v[148:151], v1, s[8:11], s56 offen nt
    s_add_u32 s56, s56, 4096
    s_waitcnt vmcnt(4)
    buffer_load_dwordx4 v[152:155], v1, s[8:11], s56 offen nt
    s_add_u32 s56, s56, 4096
    s_waitcnt vmcnt(4)
    buffer_load_dwordx4 v[156:159], v1, s[8:11], s56 offen nt
    s_add_u32 s56, s56, 4096
    s_waitcnt vmcnt(4)
    buffer_load_dwordx4 v[160:163], v1, s[8:11], s56 offen nt
    s_add_u32 s56, s56, 4096
    s_waitcnt vmcnt(4)
    buffer_load_dwordx4 v[164:167], v1, s[8:11], s56 offen nt
    s_add_u32 s56, s56, 4096
    s_waitcnt vmcnt(4)
    buffer_load_dwordx4 v[168:171], v1, s[8:11], s56 offen nt
    s_add_u32 s56, s56, 4096
    s_waitcnt vmcnt(4)
    buffer_load_dwordx4 v[172:175], v1, s[8:11], s56 offen nt
    s_add_u32 s56, s56, 4096
    s_waitcnt vmcnt(4)
    buffer_load_dwordx4 v[176:179], v1, s[8:11], s56 offen nt
    s_add_u32 s56, s56, 4096
    s_waitcnt vmcnt(4)
    buffer_load_dwordx4 v[180:183], v1, s[8:11], s56 offen nt
    s_add_u32 s56, s56, 4096
    s_waitcnt vmcnt(4)
    buffer_load_dwordx4 v[184:187], v1, s[8:11], s56 offen nt
    s_add_u32 s56, s56, 4096
    s_waitcnt vmcnt(4)
    buffer_load_dwordx4 v[188:191], v1, s[8:11], s56 offen nt
    s_add_u32 s56, s56, 4096
    s_waitcnt vmcnt(4)
    buffer_load_dwordx4 v[192:195], v1, s[8:11], s56 offen nt
    s_add_u32 s56, s56, 4096
    s_waitcnt vmcnt(4)
    buffer_load_dwordx4 v[196:199], v1, s[8:11], s56 offen nt
    s_add_u32 s56, s56, 4096
    s_waitcnt vmcnt(4)
    buffer_load_dwordx4 v[200:203], v1, s[8:11], s56 offen nt
    s_add_u32 s56, s56, 4096
    s_waitcnt vmcnt(4)
    buffer_load_dwordx4 v[204:207], v1, s[8:11], s56 offen nt
    s_add_u32 s56, s56, 4096
    s_waitcnt vmcnt(4)
    buffer_load_dwordx4 v[208:211], v1, s[8:11], s56 offen nt
    s_add_u32 s56, s56, 4096
    s_waitcnt vmcnt(4)
    buffer_load_dwordx4 v[212:215], v1, s[8:11], s56 offen nt
    s_add_u32 s56, s56, 4096
    s_waitcnt vmcnt(4)
    buffer_load_dwordx4 v[216:219], v1, s[8:11], s56 offen nt
    s_add_u32 s56, s56, 4096
    s_waitcnt vmcnt(4)
    buffer_load_dwordx4 v[220:223], v1, s[8:11], s56 offen nt
    s_add_u32 s56, s56, 4096
    s_waitcnt vmcnt(4)
    buffer_load_dwordx4 v[224:227], v1, s[8:11], s56 offen nt
    s_add_u32 s56, s56, 4096
    s_waitcnt vmcnt(4)
    buffer_load_dwordx4 v[228:231], v1, s[8:11], s56 offen nt
    s_add_u32 s56, s56, 4096
    s_waitcnt vmcnt(4)
    buffer_load_dwordx4 v[232:235], v1, s[8:11], s56 offen nt
    s_add_u32 s56, s56, 4096
    s_waitcnt vmcnt(4)
    buffer_load_dwordx4 v[236:239], v1, s[8:11], s56 offen nt
    s_add_u32 s56, s56, 4096
    s_waitcnt vmcnt(4)
    buffer_load_dwordx4 v[240:243], v1, s[8:11], s56 offen nt
    s_add_u32 s56, s56, 4096
    s_waitcnt vmcnt(4)
    buffer_load_dwordx4 v[244:247], v1, s[8:11], s56 offen nt
    s_add_u32 s56, s56, 4096
    s_waitcnt vmcnt(4)
    buffer_load_dwordx4 v[248:251], v1, s[8:11], s56 offen nt
    s_add_u32 s56, s56, 4096
    s_waitcnt vmcnt(4)
    buffer_load_dwordx4 v[252:255], v1, s[8:11], s56 offen nt
    s_add_u32 s56, s56, 4096
    s_mov_b32 s7, 0
L_fl_1:
    ds_read_b32 v27, v25 offset:0
    ds_read_b128 v[4:7], v3
    ds_read_b32 v49, v25 offset:24
    s_add_u32 s7, s7, 1
    s_cmp_gt_u32 s7, 33554432
    s_cbranch_scc1 L_flok_2
    s_waitcnt lgkmcnt(2)
    v_cmp_le_u32 vcc, 1, v27
    s_cbranch_vccnz L_flok_2
    s_waitcnt lgkmcnt(0)
    s_branch L_fl_1
L_flok_2:
    s_waitcnt lgkmcnt(0)
    v_readfirstlane_b32 s63, v49
    v_mfma_f32_16x16x32_bf16 v[28:31], v[64:67], v[4:7], 0
    v_mfma_f32_16x16x32_bf16 v[32:35], v[68:71], v[4:7], 0
    v_mfma_f32_16x16x32_bf16 v[36:39], v[72:75], v[4:7], 0
    v_mfma_f32_16x16x32_bf16 v[40:43], v[76:79], v[4:7], 0
    s_nop 4
    v_add_f32_dpp v44, v29, v28 row_ror:12 row_mask:0xf bank_mask:0x1
    s_nop 0
    v_add_f32_dpp v45, v37, v36 row_ror:12 row_mask:0xf bank_mask:0x1
    v_add_f32_dpp v44, v32, v33 row_ror:4 row_mask:0xf bank_mask:0x2
    s_nop 0
    v_add_f32_dpp v45, v40, v41 row_ror:4 row_mask:0xf bank_mask:0x2
    v_add_f32_dpp v44, v31, v30 row_ror:12 row_mask:0xf bank_mask:0x4
    s_nop 0
    v_add_f32_dpp v45, v39, v38 row_ror:12 row_mask:0xf bank_mask:0x4
    v_add_f32_dpp v44, v34, v35 row_ror:4 row_mask:0xf bank_mask:0x8
    s_nop 0
    v_add_f32_dpp v45, v42, v43 row_ror:4 row_mask:0xf bank_mask:0x8
    v_add_f32_dpp v8, v44, v44 row_ror:8 row_mask:0xf bank_mask:0x3
    s_nop 1
    v_add_f32_dpp v8, v45, v45 row_ror:8 row_mask:0xf bank_mask:0xc
    v_mfma_f32_16x16x32_bf16 v[28:31], v[80:83], v[4:7], 0
    v_mfma_f32_16x16x32_bf16 v[32:35], v[84:87], v[4:7], 0
    v_mfma_f32_16x16x32_bf16 v[36:39], v[88:91], v[4:7], 0
    v_mfma_f32_16x16x32_bf16 v[40:43], v[92:95], v[4:7], 0
    s_nop 4
    v_add_f32_dpp v44, v29, v28 row_ror:12 row_mask:0xf bank_mask:0x1
    s_nop 0
    v_add_f32_dpp v45, v37, v36 row_ror:12 row_mask:0xf bank_mask:0x1
    v_add_f32_dpp v44, v32, v33 row_ror:4 row_mask:0xf bank_mask:0x2
    s_nop 0
    v_add_f32_dpp v45, v40, v41 row_ror:4 row_mask:0xf bank_mask:0x2
    v_add_f32_dpp v44, v31, v30 row_ror:12 row_mask:0xf bank_mask:0x4
    s_nop 0
    v_add_f32_dpp v45, v39, v38 row_ror:12 row_mask:0xf bank_mask:0x4
    v_add_f32_dpp v44, v34, v35 row_ror:4 row_mask:0xf bank_mask:0x8
    s_nop 0
    v_add_f32_dpp v45, v42, v43 row_ror:4 row_mask:0xf bank_mask:0x8
    v_add_f32_dpp v9, v44, v44 row_ror:8 row_mask:0xf bank_mask:0x3
    s_nop 1
    v_add_f32_dpp v9, v45, v45 row_ror:8 row_mask:0xf bank_mask:0xc
    s_waitcnt vmcnt(4)
    buffer_load_dwordx4 v[64:67], v1, s[8:11], s56 offen nt
    s_add_u32 s56, s56, 4096
    v_cvt_pk_bf16_f32 v49, v8, v9
    v_lshlrev_b32 v8, 16, v49
    v_and_b32 v9, s60, v49
    v_mul_f32 v8, s58, v8
    v_mul_f32 v9, s58, v9
    v_cvt_pk_bf16_f32 v49, v8, v9
    v_lshlrev_b32 v8, 16, v49
    v_and_b32 v9, s60, v49
    v_max_f32 v46, v8, v9
    v_mfma_f32_16x16x32_bf16 v[28:31], v[96:99], v[4:7], 0
    v_mfma_f32_16x16x32_bf16 v[32:35], v[100:103], v[4:7], 0
    v_mfma_f32_16x16x32_bf16 v[36:39], v[104:107], v[4:7], 0
    v_mfma_f32_16x16x32_bf16 v[40:43], v[108:111], v[4:7], 0
    s_nop 4
    v_add_f32_dpp v44, v29, v28 row_ror:12 row_mask:0xf bank_mask:0x1
    s_nop 0
    v_add_f32_dpp v45, v37, v36 row_ror:12 row_mask:0xf bank_mask:0x1
    v_add_f32_dpp v44, v32, v33 row_ror:4 row_mask:0xf bank_mask:0x2
    s_nop 0
    v_add_f32_dpp v45, v40, v41 row_ror:4 row_mask:0xf bank_mask:0x2
    v_add_f32_dpp v44, v31, v30 row_ror:12 row_mask:0xf bank_mask:0x4
    s_nop 0
    v_add_f32_dpp v45, v39, v38 row_ror:12 row_mask:0xf bank_mask:0x4
    v_add_f32_dpp v44, v34, v35 row_ror:4 row_mask:0xf bank_mask:0x8
    s_nop 0
    v_add_f32_dpp v45, v42, v43 row_ror:4 row_mask:0xf bank_mask:0x8
    v_add_f32_dpp v10, v44, v44 row_ror:8 row_mask:0xf bank_mask:0x3
    s_nop 1
    v_add_f32_dpp v10, v45, v45 row_ror:8 row_mask:0xf bank_mask:0xc
    v_mfma_f32_16x16x32_bf16 v[28:31], v[112:115], v[4:7], 0
    v_mfma_f32_16x16x32_bf16 v[32:35], v[116:119], v[4:7], 0
    v_mfma_f32_16x16x32_bf16 v[36:39], v[120:123], v[4:7], 0
    v_mfma_f32_16x16x32_bf16 v[40:43], v[124:127], v[4:7], 0
    s_nop 4
    v_add_f32_dpp v44, v29, v28 row_ror:12 row_mask:0xf bank_mask:0x1
    s_nop 0
    v_add_f32_dpp v45, v37, v36 row_ror:12 row_mask:0xf bank_mask:0x1
    v_add_f32_dpp v44, v32, v33 row_ror:4 row_mask:0xf bank_mask:0x2
    s_nop 0
    v_add_f32_dpp v45, v40, v41 row_ror:4 row_mask:0xf bank_mask:0x2
    v_add_f32_dpp v44, v31, v30 row_ror:12 row_mask:0xf bank_mask:0x4
    s_nop 0
    v_add_f32_dpp v45, v39, v38 row_ror:12 row_mask:0xf bank_mask:0x4
    v_add_f32_dpp v44, v34, v35 row_ror:4 row_mask:0xf bank_mask:0x8
    s_nop 0
    v_add_f32_dpp v45, v42, v43 row_ror:4 row_mask:0xf bank_mask:0x8
    v_add_f32_dpp v11, v44, v44 row_ror:8 row_mask:0xf bank_mask:0x3
    s_nop 1
    v_add_f32_dpp v11, v45, v45 row_ror:8 row_mask:0xf bank_mask:0xc
    s_waitcnt vmcnt(4)
    buffer_load_dwordx4 v[68:71], v1, s[8:11], s56 offen nt
    s_add_u32 s56, s56, 4096
    v_cvt_pk_bf16_f32 v49, v10, v11
    v_lshlrev_b32 v10, 16, v49
    v_and_b32 v11, s60, v49
    v_mul_f32 v10, s58, v10
    v_mul_f32 v11, s58, v11
    v_cvt_pk_bf16_f32 v49, v10, v11
    v_lshlrev_b32 v10, 16, v49
    v_and_b32 v11, s60, v49
    v_max3_f32 v46, v46, v10, v11
    v_mfma_f32_16x16x32_bf16 v[28:31], v[128:131], v[4:7], 0
    v_mfma_f32_16x16x32_bf16 v[32:35], v[132:135], v[4:7], 0
    v_mfma_f32_16x16x32_bf16 v[36:39], v[136:139], v[4:7], 0
    v_mfma_f32_16x16x32_bf16 v[40:43], v[140:143], v[4:7], 0
    s_nop 4
    v_add_f32_dpp v44, v29, v28 row_ror:12 row_mask:0xf bank_mask:0x1
    s_nop 0
    v_add_f32_dpp v45, v37, v36 row_ror:12 row_mask:0xf bank_mask:0x1
    v_add_f32_dpp v44, v32, v33 row_ror:4 row_mask:0xf bank_mask:0x2
    s_nop 0
    v_add_f32_dpp v45, v40, v41 row_ror:4 row_mask:0xf bank_mask:0x2
    v_add_f32_dpp v44, v31, v30 row_ror:12 row_mask:0xf bank_mask:0x4
    s_nop 0
    v_add_f32_dpp v45, v39, v38 row_ror:12 row_mask:0xf bank_mask:0x4
    v_add_f32_dpp v44, v34, v35 row_ror:4 row_mask:0xf bank_mask:0x8
    s_nop 0
    v_add_f32_dpp v45, v42, v43 row_ror:4 row_mask:0xf bank_mask:0x8
    v_add_f32_dpp v12, v44, v44 row_ror:8 row_mask:0xf bank_mask:0x3
    s_nop 1
    v_add_f32_dpp v12, v45, v45 row_ror:8 row_mask:0xf bank_mask:0xc
    v_mfma_f32_16x16x32_bf16 v[28:31], v[144:147], v[4:7], 0
    v_mfma_f32_16x16x32_bf16 v[32:35], v[148:151], v[4:7], 0
    v_mfma_f32_16x16x32_bf16 v[36:39], v[152:155], v[4:7], 0
    v_mfma_f32_16x16x32_bf16 v[40:43], v[156:159], v[4:7], 0
    s_nop 4
    v_add_f32_dpp v44, v29, v28 row_ror:12 row_mask:0xf bank_mask:0x1
    s_nop 0
    v_add_f32_dpp v45, v37, v36 row_ror:12 row_mask:0xf bank_mask:0x1
    v_add_f32_dpp v44, v32, v33 row_ror:4 row_mask:0xf bank_mask:0x2
    s_nop 0
    v_add_f32_dpp v45, v40, v41 row_ror:4 row_mask:0xf bank_mask:0x2
    v_add_f32_dpp v44, v31, v30 row_ror:12 row_mask:0xf bank_mask:0x4
    s_nop 0
    v_add_f32_dpp v45, v39, v38 row_ror:12 row_mask:0xf bank_mask:0x4
    v_add_f32_dpp v44, v34, v35 row_ror:4 row_mask:0xf bank_mask:0x8
    s_nop 0
    v_add_f32_dpp v45, v42, v43 row_ror:4 row_mask:0xf bank_mask:0x8
    v_add_f32_dpp v13, v44, v44 row_ror:8 row_mask:0xf bank_mask:0x3
    s_nop 1
    v_add_f32_dpp v13, v45, v45 row_ror:8 row_mask:0xf bank_mask:0xc
    s_waitcnt vmcnt(4)
    buffer_load_dwordx4 v[72:75], v1, s[8:11], s56 offen nt
    s_add_u32 s56, s56, 4096
    v_cvt_pk_bf16_f32 v49, v12, v13
    v_lshlrev_b32 v12, 16, v49
    v_and_b32 v13, s60, v49
    v_mul_f32 v12, s58, v12
    v_mul_f32 v13, s58, v13
    v_cvt_pk_bf16_f32 v49, v12, v13
    v_lshlrev_b32 v12, 16, v49
    v_and_b32 v13, s60, v49
    v_max3_f32 v46, v46, v12, v13
    v_mfma_f32_16x16x32_bf16 v[28:31], v[160:163], v[4:7], 0
    v_mfma_f32_16x16x32_bf16 v[32:35], v[164:167], v[4:7], 0
    v_mfma_f32_16x16x32_bf16 v[36:39], v[168:171], v[4:7], 0
    v_mfma_f32_16x16x32_bf16 v[40:43], v[172:175], v[4:7], 0
    s_nop 4
    v_add_f32_dpp v44, v29, v28 row_ror:12 row_mask:0xf bank_mask:0x1
    s_nop 0
    v_add_f32_dpp v45, v37, v36 row_ror:12 row_mask:0xf bank_mask:0x1
    v_add_f32_dpp v44, v32, v33 row_ror:4 row_mask:0xf bank_mask:0x2
    s_nop 0
    v_add_f32_dpp v45, v40, v41 row_ror:4 row_mask:0xf bank_mask:0x2
    v_add_f32_dpp v44, v31, v30 row_ror:12 row_mask:0xf bank_mask:0x4
    s_nop 0
    v_add_f32_dpp v45, v39, v38 row_ror:12 row_mask:0xf bank_mask:0x4
    v_add_f32_dpp v44, v34, v35 row_ror:4 row_mask:0xf bank_mask:0x8
    s_nop 0
    v_add_f32_dpp v45, v42, v43 row_ror:4 row_mask:0xf bank_mask:0x8
    v_add_f32_dpp v14, v44, v44 row_ror:8 row_mask:0xf bank_mask:0x3
    s_nop 1
    v_add_f32_dpp v14, v45, v45 row_ror:8 row_mask:0xf bank_mask:0xc
    v_mfma_f32_16x16x32_bf16 v[28:31], v[176:179], v[4:7], 0
    v_mfma_f32_16x16x32_bf16 v[32:35], v[180:183], v[4:7], 0
    v_mfma_f32_16x16x32_bf16 v[36:39], v[184:187], v[4:7], 0
    v_mfma_f32_16x16x32_bf16 v[40:43], v[188:191], v[4:7], 0
    s_nop 4
    v_add_f32_dpp v44, v29, v28 row_ror:12 row_mask:0xf bank_mask:0x1
    s_nop 0
    v_add_f32_dpp v45, v37, v36 row_ror:12 row_mask:0xf bank_mask:0x1
    v_add_f32_dpp v44, v32, v33 row_ror:4 row_mask:0xf bank_mask:0x2
    s_nop 0
    v_add_f32_dpp v45, v40, v41 row_ror:4 row_mask:0xf bank_mask:0x2
    v_add_f32_dpp v44, v31, v30 row_ror:12 row_mask:0xf bank_mask:0x4
    s_nop 0
    v_add_f32_dpp v45, v39, v38 row_ror:12 row_mask:0xf bank_mask:0x4
    v_add_f32_dpp v44, v34, v35 row_ror:4 row_mask:0xf bank_mask:0x8
    s_nop 0
    v_add_f32_dpp v45, v42, v43 row_ror:4 row_mask:0xf bank_mask:0x8
    v_add_f32_dpp v15, v44, v44 row_ror:8 row_mask:0xf bank_mask:0x3
    s_nop 1
    v_add_f32_dpp v15, v45, v45 row_ror:8 row_mask:0xf bank_mask:0xc
    s_waitcnt vmcnt(4)
    buffer_load_dwordx4 v[76:79], v1, s[8:11], s56 offen nt
    s_add_u32 s56, s56, 4096
    v_cvt_pk_bf16_f32 v49, v14, v15
    v_lshlrev_b32 v14, 16, v49
    v_and_b32 v15, s60, v49
    v_mul_f32 v14, s58, v14
    v_mul_f32 v15, s58, v15
    v_cvt_pk_bf16_f32 v49, v14, v15
    v_lshlrev_b32 v14, 16, v49
    v_and_b32 v15, s60, v49
    v_max3_f32 v46, v46, v14, v15
    v_mfma_f32_16x16x32_bf16 v[28:31], v[192:195], v[4:7], 0
    v_mfma_f32_16x16x32_bf16 v[32:35], v[196:199], v[4:7], 0
    v_mfma_f32_16x16x32_bf16 v[36:39], v[200:203], v[4:7], 0
    v_mfma_f32_16x16x32_bf16 v[40:43], v[204:207], v[4:7], 0
    s_nop 4
    v_add_f32_dpp v44, v29, v28 row_ror:12 row_mask:0xf bank_mask:0x1
    s_nop 0
    v_add_f32_dpp v45, v37, v36 row_ror:12 row_mask:0xf bank_mask:0x1
    v_add_f32_dpp v44, v32, v33 row_ror:4 row_mask:0xf bank_mask:0x2
    s_nop 0
    v_add_f32_dpp v45, v40, v41 row_ror:4 row_mask:0xf bank_mask:0x2
    v_add_f32_dpp v44, v31, v30 row_ror:12 row_mask:0xf bank_mask:0x4
    s_nop 0
    v_add_f32_dpp v45, v39, v38 row_ror:12 row_mask:0xf bank_mask:0x4
    v_add_f32_dpp v44, v34, v35 row_ror:4 row_mask:0xf bank_mask:0x8
    s_nop 0
    v_add_f32_dpp v45, v42, v43 row_ror:4 row_mask:0xf bank_mask:0x8
    v_add_f32_dpp v16, v44, v44 row_ror:8 row_mask:0xf bank_mask:0x3
    s_nop 1
    v_add_f32_dpp v16, v45, v45 row_ror:8 row_mask:0xf bank_mask:0xc
    v_mfma_f32_16x16x32_bf16 v[28:31], v[208:211], v[4:7], 0
    v_mfma_f32_16x16x32_bf16 v[32:35], v[212:215], v[4:7], 0
    v_mfma_f32_16x16x32_bf16 v[36:39], v[216:219], v[4:7], 0
    v_mfma_f32_16x16x32_bf16 v[40:43], v[220:223], v[4:7], 0
    s_nop 4
    v_add_f32_dpp v44, v29, v28 row_ror:12 row_mask:0xf bank_mask:0x1
    s_nop 0
    v_add_f32_dpp v45, v37, v36 row_ror:12 row_mask:0xf bank_mask:0x1
    v_add_f32_dpp v44, v32, v33 row_ror:4 row_mask:0xf bank_mask:0x2
    s_nop 0
    v_add_f32_dpp v45, v40, v41 row_ror:4 row_mask:0xf bank_mask:0x2
    v_add_f32_dpp v44, v31, v30 row_ror:12 row_mask:0xf bank_mask:0x4
    s_nop 0
    v_add_f32_dpp v45, v39, v38 row_ror:12 row_mask:0xf bank_mask:0x4
    v_add_f32_dpp v44, v34, v35 row_ror:4 row_mask:0xf bank_mask:0x8
    s_nop 0
    v_add_f32_dpp v45, v42, v43 row_ror:4 row_mask:0xf bank_mask:0x8
    v_add_f32_dpp v17, v44, v44 row_ror:8 row_mask:0xf bank_mask:0x3
    s_nop 1
    v_add_f32_dpp v17, v45, v45 row_ror:8 row_mask:0xf bank_mask:0xc
    s_waitcnt vmcnt(4)
    buffer_load_dwordx4 v[80:83], v1, s[8:11], s56 offen nt
    s_add_u32 s56, s56, 4096
    v_cvt_pk_bf16_f32 v49, v16, v17
    v_lshlrev_b32 v16, 16, v49
    v_and_b32 v17, s60, v49
    v_mul_f32 v16, s58, v16
    v_mul_f32 v17, s58, v17
    v_cvt_pk_bf16_f32 v49, v16, v17
    v_lshlrev_b32 v16, 16, v49
    v_and_b32 v17, s60, v49
    v_max3_f32 v46, v46, v16, v17
    v_mfma_f32_16x16x32_bf16 v[28:31], v[224:227], v[4:7], 0
    v_mfma_f32_16x16x32_bf16 v[32:35], v[228:231], v[4:7], 0
    v_mfma_f32_16x16x32_bf16 v[36:39], v[232:235], v[4:7], 0
    v_mfma_f32_16x16x32_bf16 v[40:43], v[236:239], v[4:7], 0
    s_nop 4
    v_add_f32_dpp v44, v29, v28 row_ror:12 row_mask:0xf bank_mask:0x1
    s_nop 0
    v_add_f32_dpp v45, v37, v36 row_ror:12 row_mask:0xf bank_mask:0x1
    v_add_f32_dpp v44, v32, v33 row_ror:4 row_mask:0xf bank_mask:0x2
    s_nop 0
    v_add_f32_dpp v45, v40, v41 row_ror:4 row_mask:0xf bank_mask:0x2
    v_add_f32_dpp v44, v31, v30 row_ror:12 row_mask:0xf bank_mask:0x4
    s_nop 0
    v_add_f32_dpp v45, v39, v38 row_ror:12 row_mask:0xf bank_mask:0x4
    v_add_f32_dpp v44, v34, v35 row_ror:4 row_mask:0xf bank_mask:0x8
    s_nop 0
    v_add_f32_dpp v45, v42, v43 row_ror:4 row_mask:0xf bank_mask:0x8
    v_add_f32_dpp v18, v44, v44 row_ror:8 row_mask:0xf bank_mask:0x3
    s_nop 1
    v_add_f32_dpp v18, v45, v45 row_ror:8 row_mask:0xf bank_mask:0xc
    v_mfma_f32_16x16x32_bf16 v[28:31], v[240:243], v[4:7], 0
    v_mfma_f32_16x16x32_bf16 v[32:35], v[244:247], v[4:7], 0
    v_mfma_f32_16x16x32_bf16 v[36:39], v[248:251], v[4:7], 0
    v_mfma_f32_16x16x32_bf16 v[40:43], v[252:255], v[4:7], 0
    s_nop 4
    v_add_f32_dpp v44, v29, v28 row_ror:12 row_mask:0xf bank_mask:0x1
    s_nop 0
    v_add_f32_dpp v45, v37, v36 row_ror:12 row_mask:0xf bank_mask:0x1
    v_add_f32_dpp v44, v32, v33 row_ror:4 row_mask:0xf bank_mask:0x2
    s_nop 0
    v_add_f32_dpp v45, v40, v41 row_ror:4 row_mask:0xf bank_mask:0x2
    v_add_f32_dpp v44, v31, v30 row_ror:12 row_mask:0xf bank_mask:0x4
    s_nop 0
    v_add_f32_dpp v45, v39, v38 row_ror:12 row_mask:0xf bank_mask:0x4
    v_add_f32_dpp v44, v34, v35 row_ror:4 row_mask:0xf bank_mask:0x8
    s_nop 0
    v_add_f32_dpp v45, v42, v43 row_ror:4 row_mask:0xf bank_mask:0x8
    v_add_f32_dpp v19, v44, v44 row_ror:8 row_mask:0xf bank_mask:0x3
    s_nop 1
    v_add_f32_dpp v19, v45, v45 row_ror:8 row_mask:0xf bank_mask:0xc
    s_waitcnt vmcnt(4)
    buffer_load_dwordx4 v[84:87], v1, s[8:11], s56 offen nt
    s_add_u32 s56, s56, 4096
    v_cvt_pk_bf16_f32 v49, v18, v19
    v_lshlrev_b32 v18, 16, v49
    v_and_b32 v19, s60, v49
    v_mul_f32 v18, s58, v18
    v_mul_f32 v19, s58, v19
    v_cvt_pk_bf16_f32 v49, v18, v19
    v_lshlrev_b32 v18, 16, v49
    v_and_b32 v19, s60, v49
    v_max3_f32 v46, v46, v18, v19
    s_waitcnt vmcnt(4)
    buffer_load_dwordx4 v[88:91], v1, s[8:11], s56 offen nt
    s_add_u32 s56, s56, 4096
    s_waitcnt vmcnt(4)
    buffer_load_dwordx4 v[92:95], v1, s[8:11], s56 offen nt
    s_add_u32 s56, s56, 4096
    s_waitcnt vmcnt(4)
    buffer_load_dwordx4 v[96:99], v1, s[8:11], s56 offen nt
    s_add_u32 s56, s56, 4096
    v_mfma_f32_16x16x32_bf16 v[28:31], v[64:67], v[4:7], 0
    v_mfma_f32_16x16x32_bf16 v[32:35], v[68:71], v[4:7], 0
    v_mfma_f32_16x16x32_bf16 v[36:39], v[72:75], v[4:7], 0
    v_mfma_f32_16x16x32_bf16 v[40:43], v[76:79], v[4:7], 0
    s_nop 4
    v_add_f32_dpp v44, v29, v28 row_ror:12 row_mask:0xf bank_mask:0x1
    s_nop 0
    v_add_f32_dpp v45, v37, v36 row_ror:12 row_mask:0xf bank_mask:0x1
    v_add_f32_dpp v44, v32, v33 row_ror:4 row_mask:0xf bank_mask:0x2
    s_nop 0
    v_add_f32_dpp v45, v40, v41 row_ror:4 row_mask:0xf bank_mask:0x2
    v_add_f32_dpp v44, v31, v30 row_ror:12 row_mask:0xf bank_mask:0x4
    s_nop 0
    v_add_f32_dpp v45, v39, v38 row_ror:12 row_mask:0xf bank_mask:0x4
    v_add_f32_dpp v44, v34, v35 row_ror:4 row_mask:0xf bank_mask:0x8
    s_nop 0
    v_add_f32_dpp v45, v42, v43 row_ror:4 row_mask:0xf bank_mask:0x8
    v_add_f32_dpp v20, v44, v44 row_ror:8 row_mask:0xf bank_mask:0x3
    s_nop 1
    v_add_f32_dpp v20, v45, v45 row_ror:8 row_mask:0xf bank_mask:0xc
    s_waitcnt vmcnt(4)
    buffer_load_dwordx4 v[100:103], v1, s[8:11], s56 offen nt
    s_add_u32 s56, s56, 4096
    s_waitcnt vmcnt(4)
    buffer_load_dwordx4 v[104:107], v1, s[8:11], s56 offen nt
    s_add_u32 s56, s56, 4096
    s_waitcnt vmcnt(4)
    buffer_load_dwordx4 v[108:111], v1, s[8:11], s56 offen nt
    s_add_u32 s56, s56, 4096
    s_waitcnt vmcnt(4)
    buffer_load_dwordx4 v[112:115], v1, s[8:11], s56 offen nt
    s_add_u32 s56, s56, 4096
    v_mfma_f32_16x16x32_bf16 v[28:31], v[80:83], v[4:7], 0
    v_mfma_f32_16x16x32_bf16 v[32:35], v[84:87], v[4:7], 0
    v_mfma_f32_16x16x32_bf16 v[36:39], v[88:91], v[4:7], 0
    v_mfma_f32_16x16x32_bf16 v[40:43], v[92:95], v[4:7], 0
    s_nop 4
    v_add_f32_dpp v44, v29, v28 row_ror:12 row_mask:0xf bank_mask:0x1
    s_nop 0
    v_add_f32_dpp v45, v37, v36 row_ror:12 row_mask:0xf bank_mask:0x1
    v_add_f32_dpp v44, v32, v33 row_ror:4 row_mask:0xf bank_mask:0x2
    s_nop 0
    v_add_f32_dpp v45, v40, v41 row_ror:4 row_mask:0xf bank_mask:0x2
    v_add_f32_dpp v44, v31, v30 row_ror:12 row_mask:0xf bank_mask:0x4
    s_nop 0
    v_add_f32_dpp v45, v39, v38 row_ror:12 row_mask:0xf bank_mask:0x4
    v_add_f32_dpp v44, v34, v35 row_ror:4 row_mask:0xf bank_mask:0x8
    s_nop 0
    v_add_f32_dpp v45, v42, v43 row_ror:4 row_mask:0xf bank_mask:0x8
    v_add_f32_dpp v21, v44, v44 row_ror:8 row_mask:0xf bank_mask:0x3
    s_nop 1
    v_add_f32_dpp v21, v45, v45 row_ror:8 row_mask:0xf bank_mask:0xc
    v_cvt_pk_bf16_f32 v49, v20, v21
    v_lshlrev_b32 v20, 16, v49
    v_and_b32 v21, s60, v49
    v_mul_f32 v20, s58, v20
    v_mul_f32 v21, s58, v21
    v_cvt_pk_bf16_f32 v49, v20, v21
    v_lshlrev_b32 v20, 16, v49
    v_and_b32 v21, s60, v49
    v_max3_f32 v46, v46, v20, v21
    s_waitcnt vmcnt(4)
    buffer_load_dwordx4 v[116:119], v1, s[8:11], s56 offen nt
    s_add_u32 s56, s56, 4096
    s_waitcnt vmcnt(4)
    buffer_load_dwordx4 v[120:123], v1, s[8:11], s56 offen nt
    s_add_u32 s56, s56, 4096
    s_waitcnt vmcnt(4)
    buffer_load_dwordx4 v[124:127], v1, s[8:11], s56 offen nt
    s_waitcnt vmcnt(4)
    buffer_load_dwordx4 v[128:131], v2, s[12:15], s57 offen nt
    s_add_u32 s57, s57, 4096
    v_mfma_f32_16x16x32_bf16 v[28:31], v[96:99], v[4:7], 0
    v_mfma_f32_16x16x32_bf16 v[32:35], v[100:103], v[4:7], 0
    v_mfma_f32_16x16x32_bf16 v[36:39], v[104:107], v[4:7], 0
    v_mfma_f32_16x16x32_bf16 v[40:43], v[108:111], v[4:7], 0
    s_nop 4
    v_add_f32_dpp v44, v29, v28 row_ror:12 row_mask:0xf bank_mask:0x1
    s_nop 0
    v_add_f32_dpp v45, v37, v36 row_ror:12 row_mask:0xf bank_mask:0x1
    v_add_f32_dpp v44, v32, v33 row_ror:4 row_mask:0xf bank_mask:0x2
    s_nop 0
    v_add_f32_dpp v45, v40, v41 row_ror:4 row_mask:0xf bank_mask:0x2
    v_add_f32_dpp v44, v31, v30 row_ror:12 row_mask:0xf bank_mask:0x4
    s_nop 0
    v_add_f32_dpp v45, v39, v38 row_ror:12 row_mask:0xf bank_mask:0x4
    v_add_f32_dpp v44, v34, v35 row_ror:4 row_mask:0xf bank_mask:0x8
    s_nop 0
    v_add_f32_dpp v45, v42, v43 row_ror:4 row_mask:0xf bank_mask:0x8
    v_add_f32_dpp v22, v44, v44 row_ror:8 row_mask:0xf bank_mask:0x3
    s_nop 1
    v_add_f32_dpp v22, v45, v45 row_ror:8 row_mask:0xf bank_mask:0xc
    s_waitcnt vmcnt(4)
    buffer_load_dwordx4 v[132:135], v2, s[12:15], s57 offen nt
    s_add_u32 s57, s57, 4096
    s_waitcnt vmcnt(4)
    buffer_load_dwordx4 v[136:139], v2, s[12:15], s57 offen nt
    s_add_u32 s57, s57, 4096
    s_waitcnt vmcnt(4)
    buffer_load_dwordx4 v[140:143], v2, s[12:15], s57 offen nt
    s_add_u32 s57, s57, 4096
    s_waitcnt vmcnt(4)
    buffer_load_dwordx4 v[144:147], v2, s[12:15], s57 offen nt
    s_add_u32 s57, s57, 4096
    v_mfma_f32_16x16x32_bf16 v[28:31], v[112:115], v[4:7], 0
    v_mfma_f32_16x16x32_bf16 v[32:35], v[116:119], v[4:7], 0
    v_mfma_f32_16x16x32_bf16 v[36:39], v[120:123], v[4:7], 0
    v_mfma_f32_16x16x32_bf16 v[40:43], v[124:127], v[4:7], 0
    s_nop 4
    v_add_f32_dpp v44, v29, v28 row_ror:12 row_mask:0xf bank_mask:0x1
    s_nop 0
    v_add_f32_dpp v45, v37, v36 row_ror:12 row_mask:0xf bank_mask:0x1
    v_add_f32_dpp v44, v32, v33 row_ror:4 row_mask:0xf bank_mask:0x2
    s_nop 0
    v_add_f32_dpp v45, v40, v41 row_ror:4 row_mask:0xf bank_mask:0x2
    v_add_f32_dpp v44, v31, v30 row_ror:12 row_mask:0xf bank_mask:0x4
    s_nop 0
    v_add_f32_dpp v45, v39, v38 row_ror:12 row_mask:0xf bank_mask:0x4
    v_add_f32_dpp v44, v34, v35 row_ror:4 row_mask:0xf bank_mask:0x8
    s_nop 0
    v_add_f32_dpp v45, v42, v43 row_ror:4 row_mask:0xf bank_mask:0x8
    v_add_f32_dpp v23, v44, v44 row_ror:8 row_mask:0xf bank_mask:0x3
    s_nop 1
    v_add_f32_dpp v23, v45, v45 row_ror:8 row_mask:0xf bank_mask:0xc
    v_cvt_pk_bf16_f32 v49, v22, v23
    v_lshlrev_b32 v22, 16, v49
    v_and_b32 v23, s60, v49
    v_mul_f32 v22, s58, v22
    v_mul_f32 v23, s58, v23
    v_cvt_pk_bf16_f32 v49, v22, v23
    v_lshlrev_b32 v22, 16, v49
    v_and_b32 v23, s60, v49
    v_max3_f32 v46, v46, v22, v23
    s_nop 1
    v_max_f32_dpp v46, v46, v46 row_ror:4 row_mask:0xf bank_mask:0xf
    s_nop 1
    v_max_f32_dpp v46, v46, v46 row_ror:8 row_mask:0xf bank_mask:0xf
    v_mov_b32 v49, v46
    s_nop 1
    v_permlane16_swap_b32 v46, v49
    v_max_f32 v46, v46, v49
    v_mov_b32 v49, v46
    s_nop 1
    v_permlane32_swap_b32 v46, v49
    v_max_f32 v46, v46, v49
    v_mul_f32 v50, s59, v46
    s_waitcnt vmcnt(4)
    buffer_load_dwordx4 v[148:151], v2, s[12:15], s57 offen nt
    s_add_u32 s57, s57, 4096
    v_fma_f32 v8, v8, s59, -v50
    v_fma_f32 v9, v9, s59, -v50
    v_fma_f32 v10, v10, s59, -v50
    v_fma_f32 v11, v11, s59, -v50
    v_fma_f32 v12, v12, s59, -v50
    v_fma_f32 v13, v13, s59, -v50
    v_fma_f32 v14, v14, s59, -v50
    v_fma_f32 v15, v15, s59, -v50
    v_exp_f32 v8, v8
    v_exp_f32 v9, v9
    v_exp_f32 v10, v10
    v_exp_f32 v11, v11
    v_exp_f32 v12, v12
    v_exp_f32 v13, v13
    v_exp_f32 v14, v14
    v_exp_f32 v15, v15
    v_add_f32 v47, v8, v9
    v_add_f32 v47, v47, v10
    v_add_f32 v47, v47, v11
    v_add_f32 v47, v47, v12
    v_add_f32 v47, v47, v13
    v_add_f32 v47, v47, v14
    v_add_f32 v47, v47, v15
    v_fma_f32 v16, v16, s59, -v50
    v_fma_f32 v17, v17, s59, -v50
    v_fma_f32 v18, v18, s59, -v50
    v_fma_f32 v19, v19, s59, -v50
    v_fma_f32 v20, v20, s59, -v50
    v_fma_f32 v21, v21, s59, -v50
    v_fma_f32 v22, v22, s59, -v50
    v_fma_f32 v23, v23, s59, -v50
    v_exp_f32 v16, v16
    v_exp_f32 v17, v17
    v_exp_f32 v18, v18
    v_exp_f32 v19, v19
    v_exp_f32 v20, v20
    v_exp_f32 v21, v21
    v_exp_f32 v22, v22
    v_exp_f32 v23, v23
    v_add_f32 v47, v47, v16
    v_add_f32 v47, v47, v17
    v_add_f32 v47, v47, v18
    v_add_f32 v47, v47, v19
    v_add_f32 v47, v47, v20
    v_add_f32 v47, v47, v21
    v_add_f32 v47, v47, v22
    v_add_f32 v47, v47, v23
    s_waitcnt vmcnt(4)
    buffer_load_dwordx4 v[152:155], v2, s[12:15], s57 offen nt
    s_add_u32 s57, s57, 4096
    v_add_f32_dpp v47, v47, v47 row_ror:4 row_mask:0xf bank_mask:0xf
    s_nop 1
    v_add_f32_dpp v47, v47, v47 row_ror:8 row_mask:0xf bank_mask:0xf
    v_mov_b32 v49, v47
    s_nop 1
    v_permlane16_swap_b32 v47, v49
    v_add_f32 v47, v47, v49
    v_mov_b32 v49, v47
    s_nop 1
    v_permlane32_swap_b32 v47, v49
    v_add_f32 v47, v47, v49
    v_and_b32 v3, 3, v0
    v_lshlrev_b32 v3, 4, v3
    v_add_u32 v3, 143872, v3
    s_lshl_b32 s6, s3, 2
    v_add_u32 v4, s6, v3
    s_mov_b64 exec, 15
    ds_write_b32 v4, v46
    ds_write_b32 v4, v47 offset:64
    s_mov_b64 exec, 1
    ds_add_u32 v25, v26 offset:4
    s_mov_b64 exec, -1
    v_mov_b32 v28, 0
    v_mov_b32 v29, 0
    v_mov_b32 v30, 0
    v_mov_b32 v31, 0
    v_mov_b32 v32, 0
    v_mov_b32 v33, 0
    v_mov_b32 v34, 0
    v_mov_b32 v35, 0
    v_mov_b32 v56, 0
    v_mov_b32 v57, 0
    v_mov_b32 v58, 0
    v_mov_b32 v59, 0
    v_mov_b32 v60, 0
    v_mov_b32 v61, 0
    v_mov_b32 v62, 0
    v_mov_b32 v63, 0
    s_lshl_b32 s6, s3, 10
    s_add_u32 s6, s6, 131072
    v_add_u32 v51, s6, v2
    s_lshl_b32 s61, s4, 16
    s_lshl_b32 s7, s5, 11
    s_add_u32 s61, s61, s7
    s_lshl_b32 s7, s3, 10
    s_add_u32 s61, s61, s7
    s_add_u32 s61, s61, 262144
    s_waitcnt vmcnt(4)
    buffer_load_dwordx4 v[156:159], v2, s[12:15], s57 offen nt
    s_add_u32 s57, s57, 4096
    s_waitcnt vmcnt(4)
    buffer_load_dwordx4 v[160:163], v2, s[12:15], s57 offen nt
    s_add_u32 s57, s57, 4096
    s_waitcnt vmcnt(4)
    buffer_load_dwordx4 v[164:167], v2, s[12:15], s57 offen nt
    s_add_u32 s57, s57, 4096
    s_mov_b32 s7, 0
L_fl_3:
    ds_read_b32 v27, v25 offset:4
    ds_read_b128 v[52:55], v3
    s_add_u32 s7, s7, 1
    s_cmp_gt_u32 s7, 33554432
    s_cbranch_scc1 L_flok_4
    s_waitcnt lgkmcnt(1)
    v_cmp_le_u32 vcc, 4, v27
    s_cbranch_vccnz L_flok_4
    s_waitcnt lgkmcnt(0)
    s_branch L_fl_3
L_flok_4:
    s_waitcnt lgkmcnt(0)
    v_max3_f32 v48, v52, v53, v54
    v_max_f32 v48, v48, v55
    v_sub_f32 v48, v46, v48
    v_mul_f32 v48, s59, v48
    v_exp_f32 v48, v48
    s_lshl_b32 s6, s3, 11
    s_add_u32 s6, s6, 131072
    v_add_u32 v3, s6, v2
    v_mul_f32 v49, v8, v48
    v_cvt_pk_bf16_f32 v36, v49, 0
    v_cvt_pk_bf16_f32 v37, 0, v49
    s_nop 0
    v_mov_b32_dpp v28, v36 quad_perm:[0,1,2,3] row_mask:0xf bank_mask:0x1
    v_mov_b32_dpp v29, v36 row_ror:8 row_mask:0xf bank_mask:0x4
    v_mov_b32_dpp v30, v36 row_ror:12 row_mask:0xf bank_mask:0x1
    v_mov_b32_dpp v31, v36 row_ror:4 row_mask:0xf bank_mask:0x4
    v_mov_b32_dpp v28, v37 row_ror:4 row_mask:0xf bank_mask:0x2
    v_mov_b32_dpp v29, v37 row_ror:12 row_mask:0xf bank_mask:0x8
    v_mov_b32_dpp v30, v37 quad_perm:[0,1,2,3] row_mask:0xf bank_mask:0x2
    v_mov_b32_dpp v31, v37 row_ror:8 row_mask:0xf bank_mask:0x8
    v_mfma_f32_16x16x16_bf16 v[56:59], v[28:29], v[128:129], v[56:59]
    v_mfma_f32_16x16x16_bf16 v[60:63], v[28:29], v[130:131], v[60:63]
    v_mfma_f32_16x16x16_bf16 v[56:59], v[30:31], v[132:133], v[56:59]
    v_mfma_f32_16x16x16_bf16 v[60:63], v[30:31], v[134:135], v[60:63]
    v_mov_b32_dpp v32, v36 row_ror:8 row_mask:0xf bank_mask:0x1
    v_mov_b32_dpp v33, v36 quad_perm:[0,1,2,3] row_mask:0xf bank_mask:0x4
    v_mov_b32_dpp v34, v36 row_ror:4 row_mask:0xf bank_mask:0x1
    v_mov_b32_dpp v35, v36 row_ror:12 row_mask:0xf bank_mask:0x4
    v_mov_b32_dpp v32, v37 row_ror:12 row_mask:0xf bank_mask:0x2
    v_mov_b32_dpp v33, v37 row_ror:4 row_mask:0xf bank_mask:0x8
    v_mov_b32_dpp v34, v37 row_ror:8 row_mask:0xf bank_mask:0x2
    v_mov_b32_dpp v35, v37 quad_perm:[0,1,2,3] row_mask:0xf bank_mask:0x8
    s_waitcnt vmcnt(4)
    buffer_load_dwordx4 v[168:171], v2, s[12:15], s57 offen nt
    s_add_u32 s57, s57, 4096
    v_mfma_f32_16x16x16_bf16 v[56:59], v[32:33], v[136:137], v[56:59]
    v_mfma_f32_16x16x16_bf16 v[60:63], v[32:33], v[138:139], v[60:63]
    v_mfma_f32_16x16x16_bf16 v[56:59], v[34:35], v[140:141], v[56:59]
    v_mfma_f32_16x16x16_bf16 v[60:63], v[34:35], v[142:143], v[60:63]
    v_mul_f32 v49, v9, v48
    v_cvt_pk_bf16_f32 v36, v49, 0
    v_cvt_pk_bf16_f32 v37, 0, v49
    s_nop 0
    v_mov_b32_dpp v28, v36 quad_perm:[0,1,2,3] row_mask:0xf bank_mask:0x1
    v_mov_b32_dpp v29, v36 row_ror:8 row_mask:0xf bank_mask:0x4
    v_mov_b32_dpp v30, v36 row_ror:12 row_mask:0xf bank_mask:0x1
    v_mov_b32_dpp v31, v36 row_ror:4 row_mask:0xf bank_mask:0x4
    v_mov_b32_dpp v28, v37 row_ror:4 row_mask:0xf bank_mask:0x2
    v_mov_b32_dpp v29, v37 row_ror:12 row_mask:0xf bank_mask:0x8
    v_mov_b32_dpp v30, v37 quad_perm:[0,1,2,3] row_mask:0xf bank_mask:0x2
    v_mov_b32_dpp v31, v37 row_ror:8 row_mask:0xf bank_mask:0x8
    v_mfma_f32_16x16x16_bf16 v[56:59], v[28:29], v[144:145], v[56:59]
    v_mfma_f32_16x16x16_bf16 v[60:63], v[28:29], v[146:147], v[60:63]
    s_waitcnt vmcnt(4)
    buffer_load_dwordx4 v[172:175], v2, s[12:15], s57 offen nt
    s_add_u32 s57, s57, 4096
    v_mfma_f32_16x16x16_bf16 v[56:59], v[30:31], v[148:149], v[56:59]
    v_mfma_f32_16x16x16_bf16 v[60:63], v[30:31], v[150:151], v[60:63]
    v_mov_b32_dpp v32, v36 row_ror:8 row_mask:0xf bank_mask:0x1
    v_mov_b32_dpp v33, v36 quad_perm:[0,1,2,3] row_mask:0xf bank_mask:0x4
    v_mov_b32_dpp v34, v36 row_ror:4 row_mask:0xf bank_mask:0x1
    v_mov_b32_dpp v35, v36 row_ror:12 row_mask:0xf bank_mask:0x4
    v_mov_b32_dpp v32, v37 row_ror:12 row_mask:0xf bank_mask:0x2
    v_mov_b32_dpp v33, v37 row_ror:4 row_mask:0xf bank_mask:0x8
    v_mov_b32_dpp v34, v37 row_ror:8 row_mask:0xf bank_mask:0x2
    v_mov_b32_dpp v35, v37 quad_perm:[0,1,2,3] row_mask:0xf bank_mask:0x8
    v_mfma_f32_16x16x16_bf16 v[56:59], v[32:33], v[152:153], v[56:59]
    v_mfma_f32_16x16x16_bf16 v[60:63], v[32:33], v[154:155], v[60:63]
    s_waitcnt vmcnt(4)
    buffer_load_dwordx4 v[176:179], v2, s[12:15], s57 offen nt
    s_add_u32 s57, s57, 4096
    v_mfma_f32_16x16x16_bf16 v[56:59], v[34:35], v[156:157], v[56:59]
    v_mfma_f32_16x16x16_bf16 v[60:63], v[34:35], v[158:159], v[60:63]
    v_mul_f32 v49, v10, v48
    v_cvt_pk_bf16_f32 v36, v49, 0
    v_cvt_pk_bf16_f32 v37, 0, v49
    s_nop 0
    v_mov_b32_dpp v28, v36 quad_perm:[0,1,2,3] row_mask:0xf bank_mask:0x1
    v_mov_b32_dpp v29, v36 row_ror:8 row_mask:0xf bank_mask:0x4
    v_mov_b32_dpp v30, v36 row_ror:12 row_mask:0xf bank_mask:0x1
    v_mov_b32_dpp v31, v36 row_ror:4 row_mask:0xf bank_mask:0x4
    v_mov_b32_dpp v28, v37 row_ror:4 row_mask:0xf bank_mask:0x2
    v_mov_b32_dpp v29, v37 row_ror:12 row_mask:0xf bank_mask:0x8
    v_mov_b32_dpp v30, v37 quad_perm:[0,1,2,3] row_mask:0xf bank_mask:0x2
    v_mov_b32_dpp v31, v37 row_ror:8 row_mask:0xf bank_mask:0x8
    s_waitcnt vmcnt(4)
    buffer_load_dwordx4 v[180:183], v2, s[12:15], s57 offen nt
    s_add_u32 s57, s57, 4096
    v_mfma_f32_16x16x16_bf16 v[56:59], v[28:29], v[160:161], v[56:59]
    v_mfma_f32_16x16x16_bf16 v[60:63], v[28:29], v[162:163], v[60:63]
    s_waitcnt vmcnt(4)
    buffer_load_dwordx4 v[184:187], v2, s[12:15], s57 offen nt
    s_add_u32 s57, s57, 4096
    v_mfma_f32_16x16x16_bf16 v[56:59], v[30:31], v[164:165], v[56:59]
    v_mfma_f32_16x16x16_bf16 v[60:63], v[30:31], v[166:167], v[60:63]
    v_mov_b32_dpp v32, v36 row_ror:8 row_mask:0xf bank_mask:0x1
    v_mov_b32_dpp v33, v36 quad_perm:[0,1,2,3] row_mask:0xf bank_mask:0x4
    v_mov_b32_dpp v34, v36 row_ror:4 row_mask:0xf bank_mask:0x1
    v_mov_b32_dpp v35, v36 row_ror:12 row_mask:0xf bank_mask:0x4
    v_mov_b32_dpp v32, v37 row_ror:12 row_mask:0xf bank_mask:0x2
    v_mov_b32_dpp v33, v37 row_ror:4 row_mask:0xf bank_mask:0x8
    v_mov_b32_dpp v34, v37 row_ror:8 row_mask:0xf bank_mask:0x2
    v_mov_b32_dpp v35, v37 quad_perm:[0,1,2,3] row_mask:0xf bank_mask:0x8
    s_waitcnt vmcnt(4)
    buffer_load_dwordx4 v[188:191], v2, s[12:15], s57 offen nt
    s_add_u32 s57, s57, 4096
    v_mfma_f32_16x16x16_bf16 v[56:59], v[32:33], v[168:169], v[56:59]
    v_mfma_f32_16x16x16_bf16 v[60:63], v[32:33], v[170:171], v[60:63]
    s_waitcnt vmcnt(4)
    buffer_load_dwordx4 v[192:195], v2, s[12:15], s57 offen nt
    s_add_u32 s57, s57, 4096
    v_mfma_f32_16x16x16_bf16 v[56:59], v[34:35], v[172:173], v[56:59]
    v_mfma_f32_16x16x16_bf16 v[60:63], v[34:35], v[174:175], v[60:63]
    v_mul_f32 v49, v11, v48
    v_cvt_pk_bf16_f32 v36, v49, 0
    v_cvt_pk_bf16_f32 v37, 0, v49
    s_nop 0
    v_mov_b32_dpp v28, v36 quad_perm:[0,1,2,3] row_mask:0xf bank_mask:0x1
    v_mov_b32_dpp v29, v36 row_ror:8 row_mask:0xf bank_mask:0x4
    v_mov_b32_dpp v30, v36 row_ror:12 row_mask:0xf bank_mask:0x1
    v_mov_b32_dpp v31, v36 row_ror:4 row_mask:0xf bank_mask:0x4
    v_mov_b32_dpp v28, v37 row_ror:4 row_mask:0xf bank_mask:0x2
    v_mov_b32_dpp v29, v37 row_ror:12 row_mask:0xf bank_mask:0x8
    v_mov_b32_dpp v30, v37 quad_perm:[0,1,2,3] row_mask:0xf bank_mask:0x2
    v_mov_b32_dpp v31, v37 row_ror:8 row_mask:0xf bank_mask:0x8
    ds_read_b32 v27, v25 offset:52
    s_waitcnt lgkmcnt(0)
    v_readfirstlane_b32 s76, v27
    s_nop 0
    s_lshr_b32 s77, s76, 8
    s_and_b32 s76, s76, 0xff
    s_cmp_gt_u32 s76, 0
    s_cbranch_scc1 L_bo_5
    s_cmp_le_u32 s77, 0
    s_cbranch_scc1 L_th_6
    s_waitcnt vmcnt(3)
L_th_6:
    s_waitcnt vmcnt(4)
L_bo_5:
    s_waitcnt vmcnt(5)
    buffer_load_dwordx4 v[196:199], v2, s[12:15], s57 offen nt
    s_add_u32 s57, s57, 4096
    s_cmp_gt_u32 s76, 1
    s_cbranch_scc1 L_bo_7
    s_cmp_le_u32 s77, 1
    s_cbranch_scc1 L_th_8
    s_waitcnt vmcnt(3)
L_th_8:
    s_waitcnt vmcnt(4)
L_bo_7:
    s_waitcnt vmcnt(5)
    buffer_load_dwordx4 v[200:203], v2, s[12:15], s57 offen nt
    s_add_u32 s57, s57, 4096
    v_mfma_f32_16x16x16_bf16 v[56:59], v[28:29], v[176:177], v[56:59]
    v_mfma_f32_16x16x16_bf16 v[60:63], v[28:29], v[178:179], v[60:63]
    s_cmp_gt_u32 s76, 2
    s_cbranch_scc1 L_bo_9
    s_cmp_le_u32 s77, 2
    s_cbranch_scc1 L_th_10
    s_waitcnt vmcnt(3)
L_th_10:
    s_waitcnt vmcnt(4)
L_bo_9:
    s_waitcnt vmcnt(5)
    buffer_load_dwordx4 v[204:207], v2, s[12:15], s57 offen nt
    s_add_u32 s57, s57, 4096
    v_mfma_f32_16x16x16_bf16 v[56:59], v[30:31], v[180:181], v[56:59]
    v_mfma_f32_16x16x16_bf16 v[60:63], v[30:31], v[182:183], v[60:63]
    v_mov_b32_dpp v32, v36 row_ror:8 row_mask:0xf bank_mask:0x1
    v_mov_b32_dpp v33, v36 quad_perm:[0,1,2,3] row_mask:0xf bank_mask:0x4
    v_mov_b32_dpp v34, v36 row_ror:4 row_mask:0xf bank_mask:0x1
    v_mov_b32_dpp v35, v36 row_ror:12 row_mask:0xf bank_mask:0x4
    v_mov_b32_dpp v32, v37 row_ror:12 row_mask:0xf bank_mask:0x2
    v_mov_b32_dpp v33, v37 row_ror:4 row_mask:0xf bank_mask:0x8
    v_mov_b32_dpp v34, v37 row_ror:8 row_mask:0xf bank_mask:0x2
    v_mov_b32_dpp v35, v37 quad_perm:[0,1,2,3] row_mask:0xf bank_mask:0x8
    s_cmp_gt_u32 s76, 3
    s_cbranch_scc1 L_bo_11
    s_cmp_le_u32 s77, 3
    s_cbranch_scc1 L_th_12
    s_waitcnt vmcnt(3)
L_th_12:
    s_waitcnt vmcnt(4)
L_bo_11:
    s_waitcnt vmcnt(5)
    buffer_load_dwordx4 v[208:211], v2, s[12:15], s57 offen nt
    s_add_u32 s57, s57, 4096
    v_mfma_f32_16x16x16_bf16 v[56:59], v[32:33], v[184:185], v[56:59]
    v_mfma_f32_16x16x16_bf16 v[60:63], v[32:33], v[186:187], v[60:63]
    s_cmp_gt_u32 s76, 4
    s_cbranch_scc1 L_bo_13
    s_cmp_le_u32 s77, 4
    s_cbranch_scc1 L_th_14
    s_waitcnt vmcnt(3)
L_th_14:
    s_waitcnt vmcnt(4)
L_bo_13:
    s_waitcnt vmcnt(5)
    buffer_load_dwordx4 v[212:215], v2, s[12:15], s57 offen nt
    s_add_u32 s57, s57, 4096
    v_mfma_f32_16x16x16_bf16 v[56:59], v[34:35], v[188:189], v[56:59]
    v_mfma_f32_16x16x16_bf16 v[60:63], v[34:35], v[190:191], v[60:63]
    v_mul_f32 v49, v12, v48
    v_cvt_pk_bf16_f32 v36, v49, 0
    v_cvt_pk_bf16_f32 v37, 0, v49
    s_nop 0
    v_mov_b32_dpp v28, v36 quad_perm:[0,1,2,3] row_mask:0xf bank_mask:0x1
    v_mov_b32_dpp v29, v36 row_ror:8 row_mask:0xf bank_mask:0x4
    v_mov_b32_dpp v30, v36 row_ror:12 row_mask:0xf bank_mask:0x1
    v_mov_b32_dpp v31, v36 row_ror:4 row_mask:0xf bank_mask:0x4
    v_mov_b32_dpp v28, v37 row_ror:4 row_mask:0xf bank_mask:0x2
    v_mov_b32_dpp v29, v37 row_ror:12 row_mask:0xf bank_mask:0x8
    v_mov_b32_dpp v30, v37 quad_perm:[0,1,2,3] row_mask:0xf bank_mask:0x2
    v_mov_b32_dpp v31, v37 row_ror:8 row_mask:0xf bank_mask:0x8
    s_cmp_gt_u32 s76, 5
    s_cbranch_scc1 L_bo_15
    s_cmp_le_u32 s77, 5
    s_cbranch_scc1 L_th_16
    s_waitcnt vmcnt(3)
L_th_16:
    s_waitcnt vmcnt(4)
L_bo_15:
    s_waitcnt vmcnt(5)
    buffer_load_dwordx4 v[216:219], v2, s[12:15], s57 offen nt
    s_add_u32 s57, s57, 4096
    v_mfma_f32_16x16x16_bf16 v[56:59], v[28:29], v[192:193], v[56:59]
    v_mfma_f32_16x16x16_bf16 v[60:63], v[28:29], v[194:195], v[60:63]
    s_cmp_gt_u32 s76, 6
    s_cbranch_scc1 L_bo_17
    s_cmp_le_u32 s77, 6
    s_cbranch_scc1 L_th_18
    s_waitcnt vmcnt(3)
L_th_18:
    s_waitcnt vmcnt(4)
L_bo_17:
    s_waitcnt vmcnt(5)
    buffer_load_dwordx4 v[220:223], v2, s[12:15], s57 offen nt
    s_add_u32 s57, s57, 4096
    v_mfma_f32_16x16x16_bf16 v[56:59], v[30:31], v[196:197], v[56:59]
    v_mfma_f32_16x16x16_bf16 v[60:63], v[30:31], v[198:199], v[60:63]
    v_mov_b32_dpp v32, v36 row_ror:8 row_mask:0xf bank_mask:0x1
    v_mov_b32_dpp v33, v36 quad_perm:[0,1,2,3] row_mask:0xf bank_mask:0x4
    v_mov_b32_dpp v34, v36 row_ror:4 row_mask:0xf bank_mask:0x1
    v_mov_b32_dpp v35, v36 row_ror:12 row_mask:0xf bank_mask:0x4
    v_mov_b32_dpp v32, v37 row_ror:12 row_mask:0xf bank_mask:0x2
    v_mov_b32_dpp v33, v37 row_ror:4 row_mask:0xf bank_mask:0x8
    v_mov_b32_dpp v34, v37 row_ror:8 row_mask:0xf bank_mask:0x2
    v_mov_b32_dpp v35, v37 quad_perm:[0,1,2,3] row_mask:0xf bank_mask:0x8
    s_cmp_gt_u32 s76, 7
    s_cbranch_scc1 L_bo_19
    s_cmp_le_u32 s77, 7
    s_cbranch_scc1 L_th_20
    s_waitcnt vmcnt(3)
L_th_20:
    s_waitcnt vmcnt(4)
L_bo_19:
    s_waitcnt vmcnt(5)
    buffer_load_dwordx4 v[224:227], v2, s[12:15], s57 offen nt
    s_add_u32 s57, s57, 4096
    v_mfma_f32_16x16x16_bf16 v[56:59], v[32:33], v[200:201], v[56:59]
    v_mfma_f32_16x16x16_bf16 v[60:63], v[32:33], v[202:203], v[60:63]
    s_cmp_gt_u32 s76, 8
    s_cbranch_scc1 L_bo_21
    s_cmp_le_u32 s77, 8
    s_cbranch_scc1 L_th_22
    s_waitcnt vmcnt(3)
L_th_22:
    s_waitcnt vmcnt(4)
L_bo_21:
    s_waitcnt vmcnt(5)
    buffer_load_dwordx4 v[228:231], v2, s[12:15], s57 offen nt
    s_add_u32 s57, s57, 4096
    v_mfma_f32_16x16x16_bf16 v[56:59], v[34:35], v[204:205], v[56:59]
    v_mfma_f32_16x16x16_bf16 v[60:63], v[34:35], v[206:207], v[60:63]
    v_mul_f32 v49, v13, v48
    v_cvt_pk_bf16_f32 v36, v49, 0
    v_cvt_pk_bf16_f32 v37, 0, v49
    s_nop 0
    v_mov_b32_dpp v28, v36 quad_perm:[0,1,2,3] row_mask:0xf bank_mask:0x1
    v_mov_b32_dpp v29, v36 row_ror:8 row_mask:0xf bank_mask:0x4
    v_mov_b32_dpp v30, v36 row_ror:12 row_mask:0xf bank_mask:0x1
    v_mov_b32_dpp v31, v36 row_ror:4 row_mask:0xf bank_mask:0x4
    v_mov_b32_dpp v28, v37 row_ror:4 row_mask:0xf bank_mask:0x2
    v_mov_b32_dpp v29, v37 row_ror:12 row_mask:0xf bank_mask:0x8
    v_mov_b32_dpp v30, v37 quad_perm:[0,1,2,3] row_mask:0xf bank_mask:0x2
    v_mov_b32_dpp v31, v37 row_ror:8 row_mask:0xf bank_mask:0x8
    s_cmp_gt_u32 s76, 9
    s_cbranch_scc1 L_bo_23
    s_cmp_le_u32 s77, 9
    s_cbranch_scc1 L_th_24
    s_waitcnt vmcnt(3)
L_th_24:
    s_waitcnt vmcnt(4)
L_bo_23:
    s_waitcnt vmcnt(5)
    buffer_load_dwordx4 v[232:235], v2, s[12:15], s57 offen nt
    s_add_u32 s57, s57, 4096
    v_mfma_f32_16x16x16_bf16 v[56:59], v[28:29], v[208:209], v[56:59]
    v_mfma_f32_16x16x16_bf16 v[60:63], v[28:29], v[210:211], v[60:63]
    s_cmp_gt_u32 s76, 10
    s_cbranch_scc1 L_bo_25
    s_cmp_le_u32 s77, 10
    s_cbranch_scc1 L_th_26
    s_waitcnt vmcnt(3)
L_th_26:
    s_waitcnt vmcnt(4)
L_bo_25:
    s_waitcnt vmcnt(5)
    buffer_load_dwordx4 v[236:239], v2, s[12:15], s57 offen nt
    s_add_u32 s57, s57, 4096
    v_mfma_f32_16x16x16_bf16 v[56:59], v[30:31], v[212:213], v[56:59]
    v_mfma_f32_16x16x16_bf16 v[60:63], v[30:31], v[214:215], v[60:63]
    v_mov_b32_dpp v32, v36 row_ror:8 row_mask:0xf bank_mask:0x1
    v_mov_b32_dpp v33, v36 quad_perm:[0,1,2,3] row_mask:0xf bank_mask:0x4
    v_mov_b32_dpp v34, v36 row_ror:4 row_mask:0xf bank_mask:0x1
    v_mov_b32_dpp v35, v36 row_ror:12 row_mask:0xf bank_mask:0x4
    v_mov_b32_dpp v32, v37 row_ror:12 row_mask:0xf bank_mask:0x2
    v_mov_b32_dpp v33, v37 row_ror:4 row_mask:0xf bank_mask:0x8
    v_mov_b32_dpp v34, v37 row_ror:8 row_mask:0xf bank_mask:0x2
    v_mov_b32_dpp v35, v37 quad_perm:[0,1,2,3] row_mask:0xf bank_mask:0x8
    s_cmp_gt_u32 s76, 11
    s_cbranch_scc1 L_bo_27
    s_cmp_le_u32 s77, 11
    s_cbranch_scc1 L_th_28
    s_waitcnt vmcnt(3)
L_th_28:
    s_waitcnt vmcnt(4)
L_bo_27:
    s_waitcnt vmcnt(5)
    buffer_load_dwordx4 v[240:243], v2, s[12:15], s57 offen nt
    s_add_u32 s57, s57, 4096
    v_mfma_f32_16x16x16_bf16 v[56:59], v[32:33], v[216:217], v[56:59]
    v_mfma_f32_16x16x16_bf16 v[60:63], v[32:33], v[218:219], v[60:63]
    s_cmp_gt_u32 s76, 12
    s_cbranch_scc1 L_bo_29
    s_waitcnt vmcnt(4)
L_bo_29:
    s_waitcnt vmcnt(5)
    buffer_load_dwordx4 v[244:247], v2, s[12:15], s57 offen nt
    s_add_u32 s57, s57, 4096
    v_mfma_f32_16x16x16_bf16 v[56:59], v[34:35], v[220:221], v[56:59]
    v_mfma_f32_16x16x16_bf16 v[60:63], v[34:35], v[222:223], v[60:63]
    v_mul_f32 v49, v14, v48
    v_cvt_pk_bf16_f32 v36, v49, 0
    v_cvt_pk_bf16_f32 v37, 0, v49
    s_nop 0
    v_mov_b32_dpp v28, v36 quad_perm:[0,1,2,3] row_mask:0xf bank_mask:0x1
    v_mov_b32_dpp v29, v36 row_ror:8 row_mask:0xf bank_mask:0x4
    v_mov_b32_dpp v30, v36 row_ror:12 row_mask:0xf bank_mask:0x1
    v_mov_b32_dpp v31, v36 row_ror:4 row_mask:0xf bank_mask:0x4
    v_mov_b32_dpp v28, v37 row_ror:4 row_mask:0xf bank_mask:0x2
    v_mov_b32_dpp v29, v37 row_ror:12 row_mask:0xf bank_mask:0x8
    v_mov_b32_dpp v30, v37 quad_perm:[0,1,2,3] row_mask:0xf bank_mask:0x2
    v_mov_b32_dpp v31, v37 row_ror:8 row_mask:0xf bank_mask:0x8
    s_cmp_gt_u32 s76, 13
    s_cbranch_scc1 L_bo_31
    s_waitcnt vmcnt(4)
L_bo_31:
    s_waitcnt vmcnt(5)
    buffer_load_dwordx4 v[248:251], v2, s[12:15], s57 offen nt
    s_add_u32 s57, s57, 4096
    v_mfma_f32_16x16x16_bf16 v[56:59], v[28:29], v[224:225], v[56:59]
    v_mfma_f32_16x16x16_bf16 v[60:63], v[28:29], v[226:227], v[60:63]
    s_cmp_gt_u32 s76, 14
    s_cbranch_scc1 L_bo_33
    s_waitcnt vmcnt(4)
L_bo_33:
    s_waitcnt vmcnt(5)
    buffer_load_dwordx4 v[252:255], v2, s[12:15], s57 offen nt
    s_add_u32 s57, s57, 4096
    v_mfma_f32_16x16x16_bf16 v[56:59], v[30:31], v[228:229], v[56:59]
    v_mfma_f32_16x16x16_bf16 v[60:63], v[30:31], v[230:231], v[60:63]
    v_mov_b32_dpp v32, v36 row_ror:8 row_mask:0xf bank_mask:0x1
    v_mov_b32_dpp v33, v36 quad_perm:[0,1,2,3] row_mask:0xf bank_mask:0x4
    v_mov_b32_dpp v34, v36 row_ror:4 row_mask:0xf bank_mask:0x1
    v_mov_b32_dpp v35, v36 row_ror:12 row_mask:0xf bank_mask:0x4
    v_mov_b32_dpp v32, v37 row_ror:12 row_mask:0xf bank_mask:0x2
    v_mov_b32_dpp v33, v37 row_ror:4 row_mask:0xf bank_mask:0x8
    v_mov_b32_dpp v34, v37 row_ror:8 row_mask:0xf bank_mask:0x2
    v_mov_b32_dpp v35, v37 quad_perm:[0,1,2,3] row_mask:0xf bank_mask:0x8
    s_cmp_gt_u32 s76, 15
    s_cbranch_scc1 L_bo_35
    s_waitcnt vmcnt(4)
L_bo_35:
    s_waitcnt vmcnt(5)
    buffer_load_dwordx4 v[64:67], v2, s[12:15], s57 offen nt
    s_add_u32 s57, s57, 4096
    v_mfma_f32_16x16x16_bf16 v[56:59], v[32:33], v[232:233], v[56:59]
    v_mfma_f32_16x16x16_bf16 v[60:63], v[32:33], v[234:235], v[60:63]
    s_cmp_gt_u32 s76, 16
    s_cbranch_scc1 L_bo_37
    s_waitcnt vmcnt(4)
L_bo_37:
    s_waitcnt vmcnt(5)
    buffer_load_dwordx4 v[68:71], v2, s[12:15], s57 offen nt
    s_add_u32 s57, s57, 4096
    v_mfma_f32_16x16x16_bf16 v[56:59], v[34:35], v[236:237], v[56:59]
    v_mfma_f32_16x16x16_bf16 v[60:63], v[34:35], v[238:239], v[60:63]
    v_mul_f32 v49, v15, v48
    v_cvt_pk_bf16_f32 v36, v49, 0
    v_cvt_pk_bf16_f32 v37, 0, v49
    s_nop 0
    v_mov_b32_dpp v28, v36 quad_perm:[0,1,2,3] row_mask:0xf bank_mask:0x1
    v_mov_b32_dpp v29, v36 row_ror:8 row_mask:0xf bank_mask:0x4
    v_mov_b32_dpp v30, v36 row_ror:12 row_mask:0xf bank_mask:0x1
    v_mov_b32_dpp v31, v36 row_ror:4 row_mask:0xf bank_mask:0x4
    v_mov_b32_dpp v28, v37 row_ror:4 row_mask:0xf bank_mask:0x2
    v_mov_b32_dpp v29, v37 row_ror:12 row_mask:0xf bank_mask:0x8
    v_mov_b32_dpp v30, v37 quad_perm:[0,1,2,3] row_mask:0xf bank_mask:0x2
    v_mov_b32_dpp v31, v37 row_ror:8 row_mask:0xf bank_mask:0x8
    s_cmp_gt_u32 s76, 17
    s_cbranch_scc1 L_bo_39
    s_waitcnt vmcnt(4)
L_bo_39:
    s_waitcnt vmcnt(5)
    buffer_load_dwordx4 v[72:75], v2, s[12:15], s57 offen nt
    s_add_u32 s57, s57, 4096
    v_mfma_f32_16x16x16_bf16 v[56:59], v[28:29], v[240:241], v[56:59]
    v_mfma_f32_16x16x16_bf16 v[60:63], v[28:29], v[242:243], v[60:63]
    s_cmp_gt_u32 s76, 18
    s_cbranch_scc1 L_bo_41
    s_waitcnt vmcnt(4)
L_bo_41:
    s_waitcnt vmcnt(5)
    buffer_load_dwordx4 v[76:79], v2, s[12:15], s57 offen nt
    s_add_u32 s57, s57, 4096
    v_mfma_f32_16x16x16_bf16 v[56:59], v[30:31], v[244:245], v[56:59]
    v_mfma_f32_16x16x16_bf16 v[60:63], v[30:31], v[246:247], v[60:63]
    v_mov_b32_dpp v32, v36 row_ror:8 row_mask:0xf bank_mask:0x1
    v_mov_b32_dpp v33, v36 quad_perm:[0,1,2,3] row_mask:0xf bank_mask:0x4
    v_mov_b32_dpp v34, v36 row_ror:4 row_mask:0xf bank_mask:0x1
    v_mov_b32_dpp v35, v36 row_ror:12 row_mask:0xf bank_mask:0x4
    v_mov_b32_dpp v32, v37 row_ror:12 row_mask:0xf bank_mask:0x2
    v_mov_b32_dpp v33, v37 row_ror:4 row_mask:0xf bank_mask:0x8
    v_mov_b32_dpp v34, v37 row_ror:8 row_mask:0xf bank_mask:0x2
    v_mov_b32_dpp v35, v37 quad_perm:[0,1,2,3] row_mask:0xf bank_mask:0x8
    s_cmp_gt_u32 s76, 19
    s_cbranch_scc1 L_bo_43
    s_waitcnt vmcnt(4)
L_bo_43:
    s_waitcnt vmcnt(5)
    buffer_load_dwordx4 v[80:83], v2, s[12:15], s57 offen nt
    s_add_u32 s57, s57, 4096
    v_mfma_f32_16x16x16_bf16 v[56:59], v[32:33], v[248:249], v[56:59]
    v_mfma_f32_16x16x16_bf16 v[60:63], v[32:33], v[250:251], v[60:63]
    s_cmp_gt_u32 s76, 20
    s_cbranch_scc1 L_bo_45
    s_waitcnt vmcnt(4)
L_bo_45:
    s_waitcnt vmcnt(5)
    buffer_load_dwordx4 v[84:87], v2, s[12:15], s57 offen nt
    s_add_u32 s57, s57, 4096
    v_mfma_f32_16x16x16_bf16 v[56:59], v[34:35], v[252:253], v[56:59]
    v_mfma_f32_16x16x16_bf16 v[60:63], v[34:35], v[254:255], v[60:63]
    v_mul_f32 v49, v16, v48
    v_cvt_pk_bf16_f32 v36, v49, 0
    v_cvt_pk_bf16_f32 v37, 0, v49
    s_nop 0
    v_mov_b32_dpp v28, v36 quad_perm:[0,1,2,3] row_mask:0xf bank_mask:0x1
    v_mov_b32_dpp v29, v36 row_ror:8 row_mask:0xf bank_mask:0x4
    v_mov_b32_dpp v30, v36 row_ror:12 row_mask:0xf bank_mask:0x1
    v_mov_b32_dpp v31, v36 row_ror:4 row_mask:0xf bank_mask:0x4
    v_mov_b32_dpp v28, v37 row_ror:4 row_mask:0xf bank_mask:0x2
    v_mov_b32_dpp v29, v37 row_ror:12 row_mask:0xf bank_mask:0x8
    v_mov_b32_dpp v30, v37 quad_perm:[0,1,2,3] row_mask:0xf bank_mask:0x2
    v_mov_b32_dpp v31, v37 row_ror:8 row_mask:0xf bank_mask:0x8
    s_cmp_gt_u32 s76, 21
    s_cbranch_scc1 L_bo_47
    s_waitcnt vmcnt(4)
L_bo_47:
    s_waitcnt vmcnt(5)
    buffer_load_dwordx4 v[88:91], v2, s[12:15], s57 offen nt
    s_add_u32 s57, s57, 4096
    s_mov_b64 exec, 1
    ds_add_u32 v25, v26 offset:16
    s_mov_b64 exec, -1
    v_mfma_f32_16x16x16_bf16 v[56:59], v[28:29], v[64:65], v[56:59]
    v_mfma_f32_16x16x16_bf16 v[60:63], v[28:29], v[66:67], v[60:63]
    s_cmp_gt_u32 s76, 22
    s_cbranch_scc1 L_bo_49
    s_waitcnt vmcnt(4)
L_bo_49:
    s_waitcnt vmcnt(5)
    buffer_load_dwordx4 v[92:95], v2, s[12:15], s57 offen nt
    s_add_u32 s57, s57, 4096
    v_mfma_f32_16x16x16_bf16 v[56:59], v[30:31], v[68:69], v[56:59]
    v_mfma_f32_16x16x16_bf16 v[60:63], v[30:31], v[70:71], v[60:63]
    v_mov_b32_dpp v32, v36 row_ror:8 row_mask:0xf bank_mask:0x1
    v_mov_b32_dpp v33, v36 quad_perm:[0,1,2,3] row_mask:0xf bank_mask:0x4
    v_mov_b32_dpp v34, v36 row_ror:4 row_mask:0xf bank_mask:0x1
    v_mov_b32_dpp v35, v36 row_ror:12 row_mask:0xf bank_mask:0x4
    v_mov_b32_dpp v32, v37 row_ror:12 row_mask:0xf bank_mask:0x2
    v_mov_b32_dpp v33, v37 row_ror:4 row_mask:0xf bank_mask:0x8
    v_mov_b32_dpp v34, v37 row_ror:8 row_mask:0xf bank_mask:0x2
    v_mov_b32_dpp v35, v37 quad_perm:[0,1,2,3] row_mask:0xf bank_mask:0x8
    s_cmp_gt_u32 s76, 23
    s_cbranch_scc1 L_bo_51
    s_waitcnt vmcnt(4)
L_bo_51:
    s_waitcnt vmcnt(5)
    buffer_load_dwordx4 v[96:99], v2, s[12:15], s57 offen nt
    s_add_u32 s57, s57, 4096
    v_mfma_f32_16x16x16_bf16 v[56:59], v[32:33], v[72:73], v[56:59]
    v_mfma_f32_16x16x16_bf16 v[60:63], v[32:33], v[74:75], v[60:63]
    s_cmp_gt_u32 s76, 24
    s_cbranch_scc1 L_bo_53
    s_waitcnt vmcnt(4)
L_bo_53:
    s_waitcnt vmcnt(5)
    buffer_load_dwordx4 v[100:103], v2, s[12:15], s57 offen nt
    s_add_u32 s57, s57, 4096
    v_mfma_f32_16x16x16_bf16 v[56:59], v[34:35], v[76:77], v[56:59]
    v_mfma_f32_16x16x16_bf16 v[60:63], v[34:35], v[78:79], v[60:63]
    v_mul_f32 v49, v17, v48
    v_cvt_pk_bf16_f32 v36, v49, 0
    v_cvt_pk_bf16_f32 v37, 0, v49
    s_nop 0
    v_mov_b32_dpp v28, v36 quad_perm:[0,1,2,3] row_mask:0xf bank_mask:0x1
    v_mov_b32_dpp v29, v36 row_ror:8 row_mask:0xf bank_mask:0x4
    v_mov_b32_dpp v30, v36 row_ror:12 row_mask:0xf bank_mask:0x1
    v_mov_b32_dpp v31, v36 row_ror:4 row_mask:0xf bank_mask:0x4
    v_mov_b32_dpp v28, v37 row_ror:4 row_mask:0xf bank_mask:0x2
    v_mov_b32_dpp v29, v37 row_ror:12 row_mask:0xf bank_mask:0x8
    v_mov_b32_dpp v30, v37 quad_perm:[0,1,2,3] row_mask:0xf bank_mask:0x2
    v_mov_b32_dpp v31, v37 row_ror:8 row_mask:0xf bank_mask:0x8
    s_cmp_gt_u32 s76, 25
    s_cbranch_scc1 L_bo_55
    s_waitcnt vmcnt(4)
L_bo_55:
    s_waitcnt vmcnt(5)
    buffer_load_dwordx4 v[104:107], v2, s[12:15], s57 offen nt
    s_add_u32 s57, s57, 4096
    v_mfma_f32_16x16x16_bf16 v[56:59], v[28:29], v[80:81], v[56:59]
    v_mfma_f32_16x16x16_bf16 v[60:63], v[28:29], v[82:83], v[60:63]
    s_cmp_gt_u32 s76, 26
    s_cbranch_scc1 L_bo_57
    s_waitcnt vmcnt(4)
L_bo_57:
    s_waitcnt vmcnt(5)
    buffer_load_dwordx4 v[108:111], v2, s[12:15], s57 offen nt
    s_add_u32 s57, s57, 4096
    v_mfma_f32_16x16x16_bf16 v[56:59], v[30:31], v[84:85], v[56:59]
    v_mfma_f32_16x16x16_bf16 v[60:63], v[30:31], v[86:87], v[60:63]
    v_mov_b32_dpp v32, v36 row_ror:8 row_mask:0xf bank_mask:0x1
    v_mov_b32_dpp v33, v36 quad_perm:[0,1,2,3] row_mask:0xf bank_mask:0x4
    v_mov_b32_dpp v34, v36 row_ror:4 row_mask:0xf bank_mask:0x1
    v_mov_b32_dpp v35, v36 row_ror:12 row_mask:0xf bank_mask:0x4
    v_mov_b32_dpp v32, v37 row_ror:12 row_mask:0xf bank_mask:0x2
    v_mov_b32_dpp v33, v37 row_ror:4 row_mask:0xf bank_mask:0x8
    v_mov_b32_dpp v34, v37 row_ror:8 row_mask:0xf bank_mask:0x2
    v_mov_b32_dpp v35, v37 quad_perm:[0,1,2,3] row_mask:0xf bank_mask:0x8
    s_cmp_gt_u32 s76, 27
    s_cbranch_scc1 L_bo_59
    s_waitcnt vmcnt(4)
L_bo_59:
    s_waitcnt vmcnt(5)
    buffer_load_dwordx4 v[112:115], v2, s[12:15], s57 offen nt
    s_add_u32 s57, s57, 4096
    v_mfma_f32_16x16x16_bf16 v[56:59], v[32:33], v[88:89], v[56:59]
    v_mfma_f32_16x16x16_bf16 v[60:63], v[32:33], v[90:91], v[60:63]
    s_cmp_gt_u32 s76, 28
    s_cbranch_scc1 L_bo_61
    s_waitcnt vmcnt(4)
L_bo_61:
    s_waitcnt vmcnt(5)
    buffer_load_dwordx4 v[116:119], v2, s[12:15], s57 offen nt
    s_add_u32 s57, s57, 4096
    v_mfma_f32_16x16x16_bf16 v[56:59], v[34:35], v[92:93], v[56:59]
    v_mfma_f32_16x16x16_bf16 v[60:63], v[34:35], v[94:95], v[60:63]
    v_mul_f32 v49, v18, v48
    v_cvt_pk_bf16_f32 v36, v49, 0
    v_cvt_pk_bf16_f32 v37, 0, v49
    s_nop 0
    v_mov_b32_dpp v28, v36 quad_perm:[0,1,2,3] row_mask:0xf bank_mask:0x1
    v_mov_b32_dpp v29, v36 row_ror:8 row_mask:0xf bank_mask:0x4
    v_mov_b32_dpp v30, v36 row_ror:12 row_mask:0xf bank_mask:0x1
    v_mov_b32_dpp v31, v36 row_ror:4 row_mask:0xf bank_mask:0x4
    v_mov_b32_dpp v28, v37 row_ror:4 row_mask:0xf bank_mask:0x2
    v_mov_b32_dpp v29, v37 row_ror:12 row_mask:0xf bank_mask:0x8
    v_mov_b32_dpp v30, v37 quad_perm:[0,1,2,3] row_mask:0xf bank_mask:0x2
    v_mov_b32_dpp v31, v37 row_ror:8 row_mask:0xf bank_mask:0x8
    s_cmp_gt_u32 s76, 29
    s_cbranch_scc1 L_bo_63
    s_waitcnt vmcnt(4)
L_bo_63:
    s_waitcnt vmcnt(5)
    buffer_load_dwordx4 v[120:123], v2, s[12:15], s57 offen nt
    s_add_u32 s57, s57, 4096
    v_mfma_f32_16x16x16_bf16 v[56:59], v[28:29], v[96:97], v[56:59]
    v_mfma_f32_16x16x16_bf16 v[60:63], v[28:29], v[98:99], v[60:63]
    s_cmp_gt_u32 s76, 30
    s_cbranch_scc1 L_bo_65
    s_waitcnt vmcnt(4)
L_bo_65:
    s_waitcnt vmcnt(5)
    buffer_load_dwordx4 v[124:127], v2, s[12:15], s57 offen nt
    s_add_u32 s57, s57, 4096
    v_mfma_f32_16x16x16_bf16 v[56:59], v[30:31], v[100:101], v[56:59]
    v_mfma_f32_16x16x16_bf16 v[60:63], v[30:31], v[102:103], v[60:63]
    v_mov_b32_dpp v32, v36 row_ror:8 row_mask:0xf bank_mask:0x1
    v_mov_b32_dpp v33, v36 quad_perm:[0,1,2,3] row_mask:0xf bank_mask:0x4
    v_mov_b32_dpp v34, v36 row_ror:4 row_mask:0xf bank_mask:0x1
    v_mov_b32_dpp v35, v36 row_ror:12 row_mask:0xf bank_mask:0x4
    v_mov_b32_dpp v32, v37 row_ror:12 row_mask:0xf bank_mask:0x2
    v_mov_b32_dpp v33, v37 row_ror:4 row_mask:0xf bank_mask:0x8
    v_mov_b32_dpp v34, v37 row_ror:8 row_mask:0xf bank_mask:0x2
    v_mov_b32_dpp v35, v37 quad_perm:[0,1,2,3] row_mask:0xf bank_mask:0x8
    s_cmp_gt_u32 s76, 31
    s_cbranch_scc1 L_bo_67
    s_waitcnt vmcnt(4)
L_bo_67:
    s_waitcnt vmcnt(5)
    buffer_load_dwordx4 v[128:131], v2, s[12:15], s57 offen nt
    s_add_u32 s57, s57, 4096
    v_mfma_f32_16x16x16_bf16 v[56:59], v[32:33], v[104:105], v[56:59]
    v_mfma_f32_16x16x16_bf16 v[60:63], v[32:33], v[106:107], v[60:63]
    s_waitcnt vmcnt(4)
    buffer_load_dwordx4 v[132:135], v2, s[12:15], s57 offen nt
    s_add_u32 s57, s57, 4096
    v_mfma_f32_16x16x16_bf16 v[56:59], v[34:35], v[108:109], v[56:59]
    v_mfma_f32_16x16x16_bf16 v[60:63], v[34:35], v[110:111], v[60:63]
    v_mul_f32 v49, v19, v48
    v_cvt_pk_bf16_f32 v36, v49, 0
    v_cvt_pk_bf16_f32 v37, 0, v49
    s_nop 0
    v_mov_b32_dpp v28, v36 quad_perm:[0,1,2,3] row_mask:0xf bank_mask:0x1
    v_mov_b32_dpp v29, v36 row_ror:8 row_mask:0xf bank_mask:0x4
    v_mov_b32_dpp v30, v36 row_ror:12 row_mask:0xf bank_mask:0x1
    v_mov_b32_dpp v31, v36 row_ror:4 row_mask:0xf bank_mask:0x4
    v_mov_b32_dpp v28, v37 row_ror:4 row_mask:0xf bank_mask:0x2
    v_mov_b32_dpp v29, v37 row_ror:12 row_mask:0xf bank_mask:0x8
    v_mov_b32_dpp v30, v37 quad_perm:[0,1,2,3] row_mask:0xf bank_mask:0x2
    v_mov_b32_dpp v31, v37 row_ror:8 row_mask:0xf bank_mask:0x8
    v_mfma_f32_16x16x16_bf16 v[56:59], v[28:29], v[112:113], v[56:59]
    v_mfma_f32_16x16x16_bf16 v[60:63], v[28:29], v[114:115], v[60:63]
    s_waitcnt vmcnt(4)
    buffer_load_dwordx4 v[136:139], v2, s[12:15], s57 offen nt
    s_add_u32 s57, s57, 4096
    v_mfma_f32_16x16x16_bf16 v[56:59], v[30:31], v[116:117], v[56:59]
    v_mfma_f32_16x16x16_bf16 v[60:63], v[30:31], v[118:119], v[60:63]
    v_mov_b32_dpp v32, v36 row_ror:8 row_mask:0xf bank_mask:0x1
    v_mov_b32_dpp v33, v36 quad_perm:[0,1,2,3] row_mask:0xf bank_mask:0x4
    v_mov_b32_dpp v34, v36 row_ror:4 row_mask:0xf bank_mask:0x1
    v_mov_b32_dpp v35, v36 row_ror:12 row_mask:0xf bank_mask:0x4
    v_mov_b32_dpp v32, v37 row_ror:12 row_mask:0xf bank_mask:0x2
    v_mov_b32_dpp v33, v37 row_ror:4 row_mask:0xf bank_mask:0x8
    v_mov_b32_dpp v34, v37 row_ror:8 row_mask:0xf bank_mask:0x2
    v_mov_b32_dpp v35, v37 quad_perm:[0,1,2,3] row_mask:0xf bank_mask:0x8
    s_waitcnt vmcnt(4)
    buffer_load_dwordx4 v[140:143], v2, s[12:15], s57 offen nt
    s_add_u32 s57, s57, 4096
    v_mfma_f32_16x16x16_bf16 v[56:59], v[32:33], v[120:121], v[56:59]
    v_mfma_f32_16x16x16_bf16 v[60:63], v[32:33], v[122:123], v[60:63]
    buffer_load_dwordx4 v[144:147], v2, s[12:15], s57 offen nt
    s_add_u32 s57, s57, 4096
    buffer_load_dwordx4 v[148:151], v2, s[12:15], s57 offen nt
    s_add_u32 s57, s57, 4096
    buffer_load_dwordx4 v[152:155], v2, s[12:15], s57 offen nt
    s_add_u32 s57, s57, 4096
    buffer_load_dwordx4 v[156:159], v2, s[12:15], s57 offen nt
    s_add_u32 s57, s57, 4096
    buffer_load_dwordx4 v[160:163], v2, s[12:15], s57 offen nt
    s_add_u32 s57, s57, 4096
    buffer_load_dwordx4 v[164:167], v2, s[12:15], s57 offen nt
    s_add_u32 s57, s57, 4096
    buffer_load_dwordx4 v[168:171], v2, s[12:15], s57 offen nt
    s_add_u32 s57, s57, 4096
    s_waitcnt vmcnt(11)
    buffer_load_dwordx4 v[172:175], v2, s[12:15], s57 offen nt
    s_add_u32 s57, s57, 4096
    v_mfma_f32_16x16x16_bf16 v[56:59], v[34:35], v[124:125], v[56:59]
    v_mfma_f32_16x16x16_bf16 v[60:63], v[34:35], v[126:127], v[60:63]
    v_mul_f32 v49, v20, v48
    v_cvt_pk_bf16_f32 v36, v49, 0
    v_cvt_pk_bf16_f32 v37, 0, v49
    s_nop 0
    v_mov_b32_dpp v28, v36 quad_perm:[0,1,2,3] row_mask:0xf bank_mask:0x1
    v_mov_b32_dpp v29, v36 row_ror:8 row_mask:0xf bank_mask:0x4
    v_mov_b32_dpp v30, v36 row_ror:12 row_mask:0xf bank_mask:0x1
    v_mov_b32_dpp v31, v36 row_ror:4 row_mask:0xf bank_mask:0x4
    v_mov_b32_dpp v28, v37 row_ror:4 row_mask:0xf bank_mask:0x2
    v_mov_b32_dpp v29, v37 row_ror:12 row_mask:0xf bank_mask:0x8
    v_mov_b32_dpp v30, v37 quad_perm:[0,1,2,3] row_mask:0xf bank_mask:0x2
    v_mov_b32_dpp v31, v37 row_ror:8 row_mask:0xf bank_mask:0x8
    s_waitcnt vmcnt(11)
    buffer_load_dwordx4 v[176:179], v2, s[12:15], s57 offen nt
    s_add_u32 s57, s57, 4096
    v_mfma_f32_16x16x16_bf16 v[56:59], v[28:29], v[128:129], v[56:59]
    v_mfma_f32_16x16x16_bf16 v[60:63], v[28:29], v[130:131], v[60:63]
    s_waitcnt vmcnt(11)
    buffer_load_dwordx4 v[180:183], v2, s[12:15], s57 offen nt
    s_add_u32 s57, s57, 4096
    v_mfma_f32_16x16x16_bf16 v[56:59], v[30:31], v[132:133], v[56:59]
    v_mfma_f32_16x16x16_bf16 v[60:63], v[30:31], v[134:135], v[60:63]
    v_mov_b32_dpp v32, v36 row_ror:8 row_mask:0xf bank_mask:0x1
    v_mov_b32_dpp v33, v36 quad_perm:[0,1,2,3] row_mask:0xf bank_mask:0x4
    v_mov_b32_dpp v34, v36 row_ror:4 row_mask:0xf bank_mask:0x1
    v_mov_b32_dpp v35, v36 row_ror:12 row_mask:0xf bank_mask:0x4
    v_mov_b32_dpp v32, v37 row_ror:12 row_mask:0xf bank_mask:0x2
    v_mov_b32_dpp v33, v37 row_ror:4 row_mask:0xf bank_mask:0x8
    v_mov_b32_dpp v34, v37 row_ror:8 row_mask:0xf bank_mask:0x2
    v_mov_b32_dpp v35, v37 quad_perm:[0,1,2,3] row_mask:0xf bank_mask:0x8
    s_waitcnt vmcnt(11)
    buffer_load_dwordx4 v[184:187], v2, s[12:15], s57 offen nt
    s_add_u32 s57, s57, 4096
    v_mfma_f32_16x16x16_bf16 v[56:59], v[32:33], v[136:137], v[56:59]
    v_mfma_f32_16x16x16_bf16 v[60:63], v[32:33], v[138:139], v[60:63]
    s_waitcnt vmcnt(11)
    buffer_load_dwordx4 v[188:191], v2, s[12:15], s57 offen nt
    s_mov_b64 exec, 1
    ds_add_u32 v25, v26 offset:20
    s_mov_b64 exec, -1
    v_mfma_f32_16x16x16_bf16 v[56:59], v[34:35], v[140:141], v[56:59]
    v_mfma_f32_16x16x16_bf16 v[60:63], v[34:35], v[142:143], v[60:63]
    v_mul_f32 v49, v21, v48
    v_cvt_pk_bf16_f32 v36, v49, 0
    v_cvt_pk_bf16_f32 v37, 0, v49
    s_nop 0
    v_mov_b32_dpp v28, v36 quad_perm:[0,1,2,3] row_mask:0xf bank_mask:0x1
    v_mov_b32_dpp v29, v36 row_ror:8 row_mask:0xf bank_mask:0x4
    v_mov_b32_dpp v30, v36 row_ror:12 row_mask:0xf bank_mask:0x1
    v_mov_b32_dpp v31, v36 row_ror:4 row_mask:0xf bank_mask:0x4
    v_mov_b32_dpp v28, v37 row_ror:4 row_mask:0xf bank_mask:0x2
    v_mov_b32_dpp v29, v37 row_ror:12 row_mask:0xf bank_mask:0x8
    v_mov_b32_dpp v30, v37 quad_perm:[0,1,2,3] row_mask:0xf bank_mask:0x2
    v_mov_b32_dpp v31, v37 row_ror:8 row_mask:0xf bank_mask:0x8
    s_waitcnt vmcnt(11)
    v_mfma_f32_16x16x16_bf16 v[56:59], v[28:29], v[144:145], v[56:59]
    v_mfma_f32_16x16x16_bf16 v[60:63], v[28:29], v[146:147], v[60:63]
    s_waitcnt vmcnt(10)
    v_mfma_f32_16x16x16_bf16 v[56:59], v[30:31], v[148:149], v[56:59]
    v_mfma_f32_16x16x16_bf16 v[60:63], v[30:31], v[150:151], v[60:63]
    v_mov_b32_dpp v32, v36 row_ror:8 row_mask:0xf bank_mask:0x1
    v_mov_b32_dpp v33, v36 quad_perm:[0,1,2,3] row_mask:0xf bank_mask:0x4
    v_mov_b32_dpp v34, v36 row_ror:4 row_mask:0xf bank_mask:0x1
    v_mov_b32_dpp v35, v36 row_ror:12 row_mask:0xf bank_mask:0x4
    v_mov_b32_dpp v32, v37 row_ror:12 row_mask:0xf bank_mask:0x2
    v_mov_b32_dpp v33, v37 row_ror:4 row_mask:0xf bank_mask:0x8
    v_mov_b32_dpp v34, v37 row_ror:8 row_mask:0xf bank_mask:0x2
    v_mov_b32_dpp v35, v37 quad_perm:[0,1,2,3] row_mask:0xf bank_mask:0x8
    s_waitcnt vmcnt(9)
    v_mfma_f32_16x16x16_bf16 v[56:59], v[32:33], v[152:153], v[56:59]
    v_mfma_f32_16x16x16_bf16 v[60:63], v[32:33], v[154:155], v[60:63]
    s_waitcnt vmcnt(8)
    v_mfma_f32_16x16x16_bf16 v[56:59], v[34:35], v[156:157], v[56:59]
    v_mfma_f32_16x16x16_bf16 v[60:63], v[34:35], v[158:159], v[60:63]
    v_mul_f32 v49, v22, v48
    v_cvt_pk_bf16_f32 v36, v49, 0
    v_cvt_pk_bf16_f32 v37, 0, v49
    s_nop 0
    v_mov_b32_dpp v28, v36 quad_perm:[0,1,2,3] row_mask:0xf bank_mask:0x1
    v_mov_b32_dpp v29, v36 row_ror:8 row_mask:0xf bank_mask:0x4
    v_mov_b32_dpp v30, v36 row_ror:12 row_mask:0xf bank_mask:0x1
    v_mov_b32_dpp v31, v36 row_ror:4 row_mask:0xf bank_mask:0x4
    v_mov_b32_dpp v28, v37 row_ror:4 row_mask:0xf bank_mask:0x2
    v_mov_b32_dpp v29, v37 row_ror:12 row_mask:0xf bank_mask:0x8
    v_mov_b32_dpp v30, v37 quad_perm:[0,1,2,3] row_mask:0xf bank_mask:0x2
    v_mov_b32_dpp v31, v37 row_ror:8 row_mask:0xf bank_mask:0x8
    s_waitcnt vmcnt(7)
    v_mfma_f32_16x16x16_bf16 v[56:59], v[28:29], v[160:161], v[56:59]
    v_mfma_f32_16x16x16_bf16 v[60:63], v[28:29], v[162:163], v[60:63]
    s_waitcnt vmcnt(6)
    v_mfma_f32_16x16x16_bf16 v[56:59], v[30:31], v[164:165], v[56:59]
    v_mfma_f32_16x16x16_bf16 v[60:63], v[30:31], v[166:167], v[60:63]
    v_mov_b32_dpp v32, v36 row_ror:8 row_mask:0xf bank_mask:0x1
    v_mov_b32_dpp v33, v36 quad_perm:[0,1,2,3] row_mask:0xf bank_mask:0x4
    v_mov_b32_dpp v34, v36 row_ror:4 row_mask:0xf bank_mask:0x1
    v_mov_b32_dpp v35, v36 row_ror:12 row_mask:0xf bank_mask:0x4
    v_mov_b32_dpp v32, v37 row_ror:12 row_mask:0xf bank_mask:0x2
    v_mov_b32_dpp v33, v37 row_ror:4 row_mask:0xf bank_mask:0x8
    v_mov_b32_dpp v34, v37 row_ror:8 row_mask:0xf bank_mask:0x2
    v_mov_b32_dpp v35, v37 quad_perm:[0,1,2,3] row_mask:0xf bank_mask:0x8
    s_waitcnt vmcnt(5)
    v_mfma_f32_16x16x16_bf16 v[56:59], v[32:33], v[168:169], v[56:59]
    v_mfma_f32_16x16x16_bf16 v[60:63], v[32:33], v[170:171], v[60:63]
    s_waitcnt vmcnt(4)
    v_mfma_f32_16x16x16_bf16 v[56:59], v[34:35], v[172:173], v[56:59]
    v_mfma_f32_16x16x16_bf16 v[60:63], v[34:35], v[174:175], v[60:63]
    v_mul_f32 v49, v23, v48
    v_cvt_pk_bf16_f32 v36, v49, 0
    v_cvt_pk_bf16_f32 v37, 0, v49
    s_nop 0
    v_mov_b32_dpp v28, v36 quad_perm:[0,1,2,3] row_mask:0xf bank_mask:0x1
    v_mov_b32_dpp v29, v36 row_ror:8 row_mask:0xf bank_mask:0x4
    v_mov_b32_dpp v30, v36 row_ror:12 row_mask:0xf bank_mask:0x1
    v_mov_b32_dpp v31, v36 row_ror:4 row_mask:0xf bank_mask:0x4
    v_mov_b32_dpp v28, v37 row_ror:4 row_mask:0xf bank_mask:0x2
    v_mov_b32_dpp v29, v37 row_ror:12 row_mask:0xf bank_mask:0x8
    v_mov_b32_dpp v30, v37 quad_perm:[0,1,2,3] row_mask:0xf bank_mask:0x2
    v_mov_b32_dpp v31, v37 row_ror:8 row_mask:0xf bank_mask:0x8
    s_waitcnt vmcnt(3)
    v_mfma_f32_16x16x16_bf16 v[56:59], v[28:29], v[176:177], v[56:59]
    v_mfma_f32_16x16x16_bf16 v[60:63], v[28:29], v[178:179], v[60:63]
    s_waitcnt vmcnt(2)
    v_mfma_f32_16x16x16_bf16 v[56:59], v[30:31], v[180:181], v[56:59]
    v_mfma_f32_16x16x16_bf16 v[60:63], v[30:31], v[182:183], v[60:63]
    v_mov_b32_dpp v32, v36 row_ror:8 row_mask:0xf bank_mask:0x1
    v_mov_b32_dpp v33, v36 quad_perm:[0,1,2,3] row_mask:0xf bank_mask:0x4
    v_mov_b32_dpp v34, v36 row_ror:4 row_mask:0xf bank_mask:0x1
    v_mov_b32_dpp v35, v36 row_ror:12 row_mask:0xf bank_mask:0x4
    v_mov_b32_dpp v32, v37 row_ror:12 row_mask:0xf bank_mask:0x2
    v_mov_b32_dpp v33, v37 row_ror:4 row_mask:0xf bank_mask:0x8
    v_mov_b32_dpp v34, v37 row_ror:8 row_mask:0xf bank_mask:0x2
    v_mov_b32_dpp v35, v37 quad_perm:[0,1,2,3] row_mask:0xf bank_mask:0x8
    s_waitcnt vmcnt(1)
    v_mfma_f32_16x16x16_bf16 v[56:59], v[32:33], v[184:185], v[56:59]
    v_mfma_f32_16x16x16_bf16 v[60:63], v[32:33], v[186:187], v[60:63]
    s_waitcnt vmcnt(0)
    v_mfma_f32_16x16x16_bf16 v[56:59], v[34:35], v[188:189], v[56:59]
    v_mfma_f32_16x16x16_bf16 v[60:63], v[34:35], v[190:191], v[60:63]
    s_cmp_ge_u32 s3, 2
    s_nop 5
    ds_write_b128 v3, v[56:59]
    ds_write_b128 v3, v[60:63] offset:1024
    s_mov_b64 exec, 1
    ds_add_u32 v25, v26 offset:28
    s_mov_b64 exec, -1
    s_branch L_stail
L_stream_1:
    s_mov_b32 s57, s56
    s_waitcnt lgkmcnt(0)
    buffer_load_dwordx4 v[64:67], v1, s[8:11], s56 offen nt
    s_add_u32 s56, s56, 4096
    buffer_load_dwordx4 v[68:71], v1, s[8:11], s56 offen nt
    s_add_u32 s56, s56, 4096
    buffer_load_dwordx4 v[72:75], v1, s[8:11], s56 offen nt
    s_add_u32 s56, s56, 4096
    buffer_load_dwordx4 v[76:79], v1, s[8:11], s56 offen nt
    s_add_u32 s56, s56, 4096
    buffer_load_dwordx4 v[80:83], v1, s[8:11], s56 offen nt
    s_add_u32 s56, s56, 4096
    v_mov_b32 v25, 144000
    v_mov_b32 v26, 1
    s_mov_b32 s58, 0x3db504f3
    s_mov_b32 s59, 0x3fb8aa3b
    s_mov_b32 s60, 0xffff0000
    v_and_b32 v3, 3, v0
    v_lshlrev_b32 v3, 8, v3
    v_bfe_u32 v4, v0, 2, 2
    v_lshl_add_u32 v3, v4, 4, v3
    v_lshrrev_b32 v4, 4, v0
    v_lshl_add_u32 v3, v4, 6, v3
    v_add_u32 v3, 140288, v3
    s_barrier
    s_waitcnt vmcnt(4)
    buffer_load_dwordx4 v[84:87], v1, s[8:11], s56 offen nt
    s_add_u32 s56, s56, 4096
    s_waitcnt vmcnt(4)
    buffer_load_dwordx4 v[88:91], v1, s[8:11], s56 offen nt
    s_add_u32 s56, s56, 4096
    s_waitcnt vmcnt(4)
    buffer_load_dwordx4 v[92:95], v1, s[8:11], s56 offen nt
    s_add_u32 s56, s56, 4096
    s_waitcnt vmcnt(4)
    buffer_load_dwordx4 v[96:99], v1, s[8:11], s56 offen nt
    s_add_u32 s56, s56, 4096
    s_waitcnt vmcnt(4)
    buffer_load_dwordx4 v[100:103], v1, s[8:11], s56 offen nt
    s_add_u32 s56, s56, 4096
    s_waitcnt vmcnt(4)
    buffer_load_dwordx4 v[104:107], v1, s[8:11], s56 offen nt
    s_add_u32 s56, s56, 4096
    s_waitcnt vmcnt(4)
    buffer_load_dwordx4 v[108:111], v1, s[8:11], s56 offen nt
    s_add_u32 s56, s56, 4096
    s_waitcnt vmcnt(4)
    buffer_load_dwordx4 v[112:115], v1, s[8:11], s56 offen nt
    s_add_u32 s56, s56, 4096
    s_waitcnt vmcnt(4)
    buffer_load_dwordx4 v[116:119], v1, s[8:11], s56 offen nt
    s_add_u32 s56, s56, 4096
    s_waitcnt vmcnt(4)
    buffer_load_dwordx4 v[120:123], v1, s[8:11], s56 offen nt
    s_add_u32 s56, s56, 4096
    s_waitcnt vmcnt(4)
    buffer_load_dwordx4 v[124:127], v1, s[8:11], s56 offen nt
    s_add_u32 s56, s56, 4096
    s_waitcnt vmcnt(4)
    buffer_load_dwordx4 v[128:131], v1, s[8:11], s56 offen nt
    s_add_u32 s56, s56, 4096
    s_waitcnt vmcnt(4)
    buffer_load_dwordx4 v[132:135], v1, s[8:11], s56 offen nt
    s_add_u32 s56, s56, 4096
    s_waitcnt vmcnt(4)
    buffer_load_dwordx4 v[136:139], v1, s[8:11], s56 offen nt
    s_add_u32 s56, s56, 4096
    s_mov_b64 exec, 1
    ds_add_u32 v25, v26 offset:12
    s_mov_b64 exec, -1
    s_waitcnt vmcnt(4)
    buffer_load_dwordx4 v[140:143], v1, s[8:11], s56 offen nt
    s_add_u32 s56, s56, 4096
    s_waitcnt vmcnt(4)
    buffer_load_dwordx4 v[144:147], v1, s[8:11], s56 offen nt
    s_add_u32 s56, s56, 4096
    s_waitcnt vmcnt(4)
    buffer_load_dwordx4 v[148:151], v1, s[8:11], s56 offen nt
    s_add_u32 s56, s56, 4096
    s_waitcnt vmcnt(4)
    buffer_load_dwordx4 v[152:155], v1, s[8:11], s56 offen nt
    s_add_u32 s56, s56, 4096
    s_waitcnt vmcnt(4)
    buffer_load_dwordx4 v[156:159], v1, s[8:11], s56 offen nt
    s_add_u32 s56, s56, 4096
    s_waitcnt vmcnt(4)
    buffer_load_dwordx4 v[160:163], v1, s[8:11], s56 offen nt
    s_add_u32 s56, s56, 4096
    s_waitcnt vmcnt(4)
    buffer_load_dwordx4 v[164:167], v1, s[8:11], s56 offen nt
    s_add_u32 s56, s56, 4096
    s_waitcnt vmcnt(4)
    buffer_load_dwordx4 v[168:171], v1, s[8:11], s56 offen nt
    s_add_u32 s56, s56, 4096
    s_waitcnt vmcnt(4)
    buffer_load_dwordx4 v[172:175], v1, s[8:11], s56 offen nt
    s_add_u32 s56, s56, 4096
    s_waitcnt vmcnt(4)
    buffer_load_dwordx4 v[176:179], v1, s[8:11], s56 offen nt
    s_add_u32 s56, s56, 4096
    s_waitcnt vmcnt(4)
    buffer_load_dwordx4 v[180:183], v1, s[8:11], s56 offen nt
    s_add_u32 s56, s56, 4096
    s_waitcnt vmcnt(4)
    buffer_load_dwordx4 v[184:187], v1, s[8:11], s56 offen nt
    s_add_u32 s56, s56, 4096
    s_waitcnt vmcnt(4)
    buffer_load_dwordx4 v[188:191], v1, s[8:11], s56 offen nt
    s_add_u32 s56, s56, 4096
    s_waitcnt vmcnt(4)
    buffer_load_dwordx4 v[192:195], v1, s[8:11], s56 offen nt
    s_add_u32 s56, s56, 4096
    s_waitcnt vmcnt(4)
    buffer_load_dwordx4 v[196:199], v1, s[8:11], s56 offen nt
    s_add_u32 s56, s56, 4096
    s_waitcnt vmcnt(4)
    buffer_load_dwordx4 v[200:203], v1, s[8:11], s56 offen nt
    s_add_u32 s56, s56, 4096
    s_waitcnt vmcnt(4)
    buffer_load_dwordx4 v[204:207], v1, s[8:11], s56 offen nt
    s_add_u32 s56, s56, 4096
    s_waitcnt vmcnt(4)
    buffer_load_dwordx4 v[208:211], v1, s[8:11], s56 offen nt
    s_add_u32 s56, s56, 4096
    s_waitcnt vmcnt(4)
    buffer_load_dwordx4 v[212:215], v1, s[8:11], s56 offen nt
    s_add_u32 s56, s56, 4096
    s_waitcnt vmcnt(4)
    buffer_load_dwordx4 v[216:219], v1, s[8:11], s56 offen nt
    s_add_u32 s56, s56, 4096
    s_waitcnt vmcnt(4)
    buffer_load_dwordx4 v[220:223], v1, s[8:11], s56 offen nt
    s_add_u32 s56, s56, 4096
    s_waitcnt vmcnt(4)
    buffer_load_dwordx4 v[224:227], v1, s[8:11], s56 offen nt
    s_add_u32 s56, s56, 4096
    s_waitcnt vmcnt(4)
    buffer_load_dwordx4 v[228:231], v1, s[8:11], s56 offen nt
    s_add_u32 s56, s56, 4096
    s_waitcnt vmcnt(4)
    buffer_load_dwordx4 v[232:235], v1, s[8:11], s56 offen nt
    s_add_u32 s56, s56, 4096
    s_waitcnt vmcnt(4)
    buffer_load_dwordx4 v[236:239], v1, s[8:11], s56 offen nt
    s_add_u32 s56, s56, 4096
    s_waitcnt vmcnt(4)
    buffer_load_dwordx4 v[240:243], v1, s[8:11], s56 offen nt
    s_add_u32 s56, s56, 4096
    s_waitcnt vmcnt(4)
    buffer_load_dwordx4 v[244:247], v1, s[8:11], s56 offen nt
    s_add_u32 s56, s56, 4096
    s_waitcnt vmcnt(4)
    buffer_load_dwordx4 v[248:251], v1, s[8:11], s56 offen nt
    s_add_u32 s56, s56, 4096
    s_waitcnt vmcnt(4)
    buffer_load_dwordx4 v[252:255], v1, s[8:11], s56 offen nt
    s_add_u32 s56, s56, 4096
    s_mov_b32 s7, 0
L_fl_69:
    ds_read_b32 v27, v25 offset:0
    ds_read_b128 v[4:7], v3
    ds_read_b32 v49, v25 offset:24
    s_add_u32 s7, s7, 1
    s_cmp_gt_u32 s7, 33554432
    s_cbranch_scc1 L_flok_70
    s_waitcnt lgkmcnt(2)
    v_cmp_le_u32 vcc, 1, v27
    s_cbranch_vccnz L_flok_70
    s_waitcnt lgkmcnt(0)
    s_branch L_fl_69
L_flok_70:
    s_waitcnt lgkmcnt(0)
    v_readfirstlane_b32 s63, v49
    v_mfma_f32_16x16x32_bf16 v[28:31], v[64:67], v[4:7], 0
    v_mfma_f32_16x16x32_bf16 v[32:35], v[68:71], v[4:7], 0
    v_mfma_f32_16x16x32_bf16 v[36:39], v[72:75], v[4:7], 0
    v_mfma_f32_16x16x32_bf16 v[40:43], v[76:79], v[4:7], 0
    s_nop 4
    v_add_f32_dpp v44, v29, v28 row_ror:12 row_mask:0xf bank_mask:0x1
    s_nop 0
    v_add_f32_dpp v45, v37, v36 row_ror:12 row_mask:0xf bank_mask:0x1
    v_add_f32_dpp v44, v32, v33 row_ror:4 row_mask:0xf bank_mask:0x2
    s_nop 0
    v_add_f32_dpp v45, v40, v41 row_ror:4 row_mask:0xf bank_mask:0x2
    v_add_f32_dpp v44, v31, v30 row_ror:12 row_mask:0xf bank_mask:0x4
    s_nop 0
    v_add_f32_dpp v45, v39, v38 row_ror:12 row_mask:0xf bank_mask:0x4
    v_add_f32_dpp v44, v34, v35 row_ror:4 row_mask:0xf bank_mask:0x8
    s_nop 0
    v_add_f32_dpp v45, v42, v43 row_ror:4 row_mask:0xf bank_mask:0x8
    v_add_f32_dpp v8, v44, v44 row_ror:8 row_mask:0xf bank_mask:0x3
    s_nop 1
    v_add_f32_dpp v8, v45, v45 row_ror:8 row_mask:0xf bank_mask:0xc
    v_mfma_f32_16x16x32_bf16 v[28:31], v[80:83], v[4:7], 0
    v_mfma_f32_16x16x32_bf16 v[32:35], v[84:87], v[4:7], 0
    v_mfma_f32_16x16x32_bf16 v[36:39], v[88:91], v[4:7], 0
    v_mfma_f32_16x16x32_bf16 v[40:43], v[92:95], v[4:7], 0
    s_nop 4
    v_add_f32_dpp v44, v29, v28 row_ror:12 row_mask:0xf bank_mask:0x1
    s_nop 0
    v_add_f32_dpp v45, v37, v36 row_ror:12 row_mask:0xf bank_mask:0x1
    v_add_f32_dpp v44, v32, v33 row_ror:4 row_mask:0xf bank_mask:0x2
    s_nop 0
    v_add_f32_dpp v45, v40, v41 row_ror:4 row_mask:0xf bank_mask:0x2
    v_add_f32_dpp v44, v31, v30 row_ror:12 row_mask:0xf bank_mask:0x4
    s_nop 0
    v_add_f32_dpp v45, v39, v38 row_ror:12 row_mask:0xf bank_mask:0x4
    v_add_f32_dpp v44, v34, v35 row_ror:4 row_mask:0xf bank_mask:0x8
    s_nop 0
    v_add_f32_dpp v45, v42, v43 row_ror:4 row_mask:0xf bank_mask:0x8
    v_add_f32_dpp v9, v44, v44 row_ror:8 row_mask:0xf bank_mask:0x3
    s_nop 1
    v_add_f32_dpp v9, v45, v45 row_ror:8 row_mask:0xf bank_mask:0xc
    s_waitcnt vmcnt(4)
    buffer_load_dwordx4 v[64:67], v1, s[8:11], s56 offen nt
    s_add_u32 s56, s56, 4096
    v_cvt_pk_bf16_f32 v49, v8, v9
    v_lshlrev_b32 v8, 16, v49
    v_and_b32 v9, s60, v49
    v_mul_f32 v8, s58, v8
    v_mul_f32 v9, s58, v9
    v_cvt_pk_bf16_f32 v49, v8, v9
    v_lshlrev_b32 v8, 16, v49
    v_and_b32 v9, s60, v49
    v_max_f32 v46, v8, v9
    v_mfma_f32_16x16x32_bf16 v[28:31], v[96:99], v[4:7], 0
    v_mfma_f32_16x16x32_bf16 v[32:35], v[100:103], v[4:7], 0
    v_mfma_f32_16x16x32_bf16 v[36:39], v[104:107], v[4:7], 0
    v_mfma_f32_16x16x32_bf16 v[40:43], v[108:111], v[4:7], 0
    s_nop 4
    v_add_f32_dpp v44, v29, v28 row_ror:12 row_mask:0xf bank_mask:0x1
    s_nop 0
    v_add_f32_dpp v45, v37, v36 row_ror:12 row_mask:0xf bank_mask:0x1
    v_add_f32_dpp v44, v32, v33 row_ror:4 row_mask:0xf bank_mask:0x2
    s_nop 0
    v_add_f32_dpp v45, v40, v41 row_ror:4 row_mask:0xf bank_mask:0x2
    v_add_f32_dpp v44, v31, v30 row_ror:12 row_mask:0xf bank_mask:0x4
    s_nop 0
    v_add_f32_dpp v45, v39, v38 row_ror:12 row_mask:0xf bank_mask:0x4
    v_add_f32_dpp v44, v34, v35 row_ror:4 row_mask:0xf bank_mask:0x8
    s_nop 0
    v_add_f32_dpp v45, v42, v43 row_ror:4 row_mask:0xf bank_mask:0x8
    v_add_f32_dpp v10, v44, v44 row_ror:8 row_mask:0xf bank_mask:0x3
    s_nop 1
    v_add_f32_dpp v10, v45, v45 row_ror:8 row_mask:0xf bank_mask:0xc
    v_mfma_f32_16x16x32_bf16 v[28:31], v[112:115], v[4:7], 0
    v_mfma_f32_16x16x32_bf16 v[32:35], v[116:119], v[4:7], 0
    v_mfma_f32_16x16x32_bf16 v[36:39], v[120:123], v[4:7], 0
    v_mfma_f32_16x16x32_bf16 v[40:43], v[124:127], v[4:7], 0
    s_nop 4
    v_add_f32_dpp v44, v29, v28 row_ror:12 row_mask:0xf bank_mask:0x1
    s_nop 0
    v_add_f32_dpp v45, v37, v36 row_ror:12 row_mask:0xf bank_mask:0x1
    v_add_f32_dpp v44, v32, v33 row_ror:4 row_mask:0xf bank_mask:0x2
    s_nop 0
    v_add_f32_dpp v45, v40, v41 row_ror:4 row_mask:0xf bank_mask:0x2
    v_add_f32_dpp v44, v31, v30 row_ror:12 row_mask:0xf bank_mask:0x4
    s_nop 0
    v_add_f32_dpp v45, v39, v38 row_ror:12 row_mask:0xf bank_mask:0x4
    v_add_f32_dpp v44, v34, v35 row_ror:4 row_mask:0xf bank_mask:0x8
    s_nop 0
    v_add_f32_dpp v45, v42, v43 row_ror:4 row_mask:0xf bank_mask:0x8
    v_add_f32_dpp v11, v44, v44 row_ror:8 row_mask:0xf bank_mask:0x3
    s_nop 1
    v_add_f32_dpp v11, v45, v45 row_ror:8 row_mask:0xf bank_mask:0xc
    s_waitcnt vmcnt(4)
    buffer_load_dwordx4 v[68:71], v1, s[8:11], s56 offen nt
    s_add_u32 s56, s56, 4096
    v_cvt_pk_bf16_f32 v49, v10, v11
    v_lshlrev_b32 v10, 16, v49
    v_and_b32 v11, s60, v49
    v_mul_f32 v10, s58, v10
    v_mul_f32 v11, s58, v11
    v_cvt_pk_bf16_f32 v49, v10, v11
    v_lshlrev_b32 v10, 16, v49
    v_and_b32 v11, s60, v49
    v_max3_f32 v46, v46, v10, v11
    v_mfma_f32_16x16x32_bf16 v[28:31], v[128:131], v[4:7], 0
    v_mfma_f32_16x16x32_bf16 v[32:35], v[132:135], v[4:7], 0
    v_mfma_f32_16x16x32_bf16 v[36:39], v[136:139], v[4:7], 0
    v_mfma_f32_16x16x32_bf16 v[40:43], v[140:143], v[4:7], 0
    s_nop 4
    v_add_f32_dpp v44, v29, v28 row_ror:12 row_mask:0xf bank_mask:0x1
    s_nop 0
    v_add_f32_dpp v45, v37, v36 row_ror:12 row_mask:0xf bank_mask:0x1
    v_add_f32_dpp v44, v32, v33 row_ror:4 row_mask:0xf bank_mask:0x2
    s_nop 0
    v_add_f32_dpp v45, v40, v41 row_ror:4 row_mask:0xf bank_mask:0x2
    v_add_f32_dpp v44, v31, v30 row_ror:12 row_mask:0xf bank_mask:0x4
    s_nop 0
    v_add_f32_dpp v45, v39, v38 row_ror:12 row_mask:0xf bank_mask:0x4
    v_add_f32_dpp v44, v34, v35 row_ror:4 row_mask:0xf bank_mask:0x8
    s_nop 0
    v_add_f32_dpp v45, v42, v43 row_ror:4 row_mask:0xf bank_mask:0x8
    v_add_f32_dpp v12, v44, v44 row_ror:8 row_mask:0xf bank_mask:0x3
    s_nop 1
    v_add_f32_dpp v12, v45, v45 row_ror:8 row_mask:0xf bank_mask:0xc
    v_mfma_f32_16x16x32_bf16 v[28:31], v[144:147], v[4:7], 0
    v_mfma_f32_16x16x32_bf16 v[32:35], v[148:151], v[4:7], 0
    v_mfma_f32_16x16x32_bf16 v[36:39], v[152:155], v[4:7], 0
    v_mfma_f32_16x16x32_bf16 v[40:43], v[156:159], v[4:7], 0
    s_nop 4
    v_add_f32_dpp v44, v29, v28 row_ror:12 row_mask:0xf bank_mask:0x1
    s_nop 0
    v_add_f32_dpp v45, v37, v36 row_ror:12 row_mask:0xf bank_mask:0x1
    v_add_f32_dpp v44, v32, v33 row_ror:4 row_mask:0xf bank_mask:0x2
    s_nop 0
    v_add_f32_dpp v45, v40, v41 row_ror:4 row_mask:0xf bank_mask:0x2
    v_add_f32_dpp v44, v31, v30 row_ror:12 row_mask:0xf bank_mask:0x4
    s_nop 0
    v_add_f32_dpp v45, v39, v38 row_ror:12 row_mask:0xf bank_mask:0x4
    v_add_f32_dpp v44, v34, v35 row_ror:4 row_mask:0xf bank_mask:0x8
    s_nop 0
    v_add_f32_dpp v45, v42, v43 row_ror:4 row_mask:0xf bank_mask:0x8
    v_add_f32_dpp v13, v44, v44 row_ror:8 row_mask:0xf bank_mask:0x3
    s_nop 1
    v_add_f32_dpp v13, v45, v45 row_ror:8 row_mask:0xf bank_mask:0xc
    s_waitcnt vmcnt(4)
    buffer_load_dwordx4 v[72:75], v1, s[8:11], s56 offen nt
    s_add_u32 s56, s56, 4096
    v_cvt_pk_bf16_f32 v49, v12, v13
    v_lshlrev_b32 v12, 16, v49
    v_and_b32 v13, s60, v49
    v_mul_f32 v12, s58, v12
    v_mul_f32 v13, s58, v13
    v_cvt_pk_bf16_f32 v49, v12, v13
    v_lshlrev_b32 v12, 16, v49
    v_and_b32 v13, s60, v49
    v_max3_f32 v46, v46, v12, v13
    v_mfma_f32_16x16x32_bf16 v[28:31], v[160:163], v[4:7], 0
    v_mfma_f32_16x16x32_bf16 v[32:35], v[164:167], v[4:7], 0
    v_mfma_f32_16x16x32_bf16 v[36:39], v[168:171], v[4:7], 0
    v_mfma_f32_16x16x32_bf16 v[40:43], v[172:175], v[4:7], 0
    s_nop 4
    v_add_f32_dpp v44, v29, v28 row_ror:12 row_mask:0xf bank_mask:0x1
    s_nop 0
    v_add_f32_dpp v45, v37, v36 row_ror:12 row_mask:0xf bank_mask:0x1
    v_add_f32_dpp v44, v32, v33 row_ror:4 row_mask:0xf bank_mask:0x2
    s_nop 0
    v_add_f32_dpp v45, v40, v41 row_ror:4 row_mask:0xf bank_mask:0x2
    v_add_f32_dpp v44, v31, v30 row_ror:12 row_mask:0xf bank_mask:0x4
    s_nop 0
    v_add_f32_dpp v45, v39, v38 row_ror:12 row_mask:0xf bank_mask:0x4
    v_add_f32_dpp v44, v34, v35 row_ror:4 row_mask:0xf bank_mask:0x8
    s_nop 0
    v_add_f32_dpp v45, v42, v43 row_ror:4 row_mask:0xf bank_mask:0x8
    v_add_f32_dpp v14, v44, v44 row_ror:8 row_mask:0xf bank_mask:0x3
    s_nop 1
    v_add_f32_dpp v14, v45, v45 row_ror:8 row_mask:0xf bank_mask:0xc
    v_mfma_f32_16x16x32_bf16 v[28:31], v[176:179], v[4:7], 0
    v_mfma_f32_16x16x32_bf16 v[32:35], v[180:183], v[4:7], 0
    v_mfma_f32_16x16x32_bf16 v[36:39], v[184:187], v[4:7], 0
    v_mfma_f32_16x16x32_bf16 v[40:43], v[188:191], v[4:7], 0
    s_nop 4
    v_add_f32_dpp v44, v29, v28 row_ror:12 row_mask:0xf bank_mask:0x1
    s_nop 0
    v_add_f32_dpp v45, v37, v36 row_ror:12 row_mask:0xf bank_mask:0x1
    v_add_f32_dpp v44, v32, v33 row_ror:4 row_mask:0xf bank_mask:0x2
    s_nop 0
    v_add_f32_dpp v45, v40, v41 row_ror:4 row_mask:0xf bank_mask:0x2
    v_add_f32_dpp v44, v31, v30 row_ror:12 row_mask:0xf bank_mask:0x4
    s_nop 0
    v_add_f32_dpp v45, v39, v38 row_ror:12 row_mask:0xf bank_mask:0x4
    v_add_f32_dpp v44, v34, v35 row_ror:4 row_mask:0xf bank_mask:0x8
    s_nop 0
    v_add_f32_dpp v45, v42, v43 row_ror:4 row_mask:0xf bank_mask:0x8
    v_add_f32_dpp v15, v44, v44 row_ror:8 row_mask:0xf bank_mask:0x3
    s_nop 1
    v_add_f32_dpp v15, v45, v45 row_ror:8 row_mask:0xf bank_mask:0xc
    s_waitcnt vmcnt(4)
    buffer_load_dwordx4 v[76:79], v1, s[8:11], s56 offen nt
    s_add_u32 s56, s56, 4096
    v_cvt_pk_bf16_f32 v49, v14, v15
    v_lshlrev_b32 v14, 16, v49
    v_and_b32 v15, s60, v49
    v_mul_f32 v14, s58, v14
    v_mul_f32 v15, s58, v15
    v_cvt_pk_bf16_f32 v49, v14, v15
    v_lshlrev_b32 v14, 16, v49
    v_and_b32 v15, s60, v49
    v_max3_f32 v46, v46, v14, v15
    v_mfma_f32_16x16x32_bf16 v[28:31], v[192:195], v[4:7], 0
    v_mfma_f32_16x16x32_bf16 v[32:35], v[196:199], v[4:7], 0
    v_mfma_f32_16x16x32_bf16 v[36:39], v[200:203], v[4:7], 0
    v_mfma_f32_16x16x32_bf16 v[40:43], v[204:207], v[4:7], 0
    s_nop 4
    v_add_f32_dpp v44, v29, v28 row_ror:12 row_mask:0xf bank_mask:0x1
    s_nop 0
    v_add_f32_dpp v45, v37, v36 row_ror:12 row_mask:0xf bank_mask:0x1
    v_add_f32_dpp v44, v32, v33 row_ror:4 row_mask:0xf bank_mask:0x2
    s_nop 0
    v_add_f32_dpp v45, v40, v41 row_ror:4 row_mask:0xf bank_mask:0x2
    v_add_f32_dpp v44, v31, v30 row_ror:12 row_mask:0xf bank_mask:0x4
    s_nop 0
    v_add_f32_dpp v45, v39, v38 row_ror:12 row_mask:0xf bank_mask:0x4
    v_add_f32_dpp v44, v34, v35 row_ror:4 row_mask:0xf bank_mask:0x8
    s_nop 0
    v_add_f32_dpp v45, v42, v43 row_ror:4 row_mask:0xf bank_mask:0x8
    v_add_f32_dpp v16, v44, v44 row_ror:8 row_mask:0xf bank_mask:0x3
    s_nop 1
    v_add_f32_dpp v16, v45, v45 row_ror:8 row_mask:0xf bank_mask:0xc
    v_mfma_f32_16x16x32_bf16 v[28:31], v[208:211], v[4:7], 0
    v_mfma_f32_16x16x32_bf16 v[32:35], v[212:215], v[4:7], 0
    v_mfma_f32_16x16x32_bf16 v[36:39], v[216:219], v[4:7], 0
    v_mfma_f32_16x16x32_bf16 v[40:43], v[220:223], v[4:7], 0
    s_nop 4
    v_add_f32_dpp v44, v29, v28 row_ror:12 row_mask:0xf bank_mask:0x1
    s_nop 0
    v_add_f32_dpp v45, v37, v36 row_ror:12 row_mask:0xf bank_mask:0x1
    v_add_f32_dpp v44, v32, v33 row_ror:4 row_mask:0xf bank_mask:0x2
    s_nop 0
    v_add_f32_dpp v45, v40, v41 row_ror:4 row_mask:0xf bank_mask:0x2
    v_add_f32_dpp v44, v31, v30 row_ror:12 row_mask:0xf bank_mask:0x4
    s_nop 0
    v_add_f32_dpp v45, v39, v38 row_ror:12 row_mask:0xf bank_mask:0x4
    v_add_f32_dpp v44, v34, v35 row_ror:4 row_mask:0xf bank_mask:0x8
    s_nop 0
    v_add_f32_dpp v45, v42, v43 row_ror:4 row_mask:0xf bank_mask:0x8
    v_add_f32_dpp v17, v44, v44 row_ror:8 row_mask:0xf bank_mask:0x3
    s_nop 1
    v_add_f32_dpp v17, v45, v45 row_ror:8 row_mask:0xf bank_mask:0xc
    s_waitcnt vmcnt(4)
    buffer_load_dwordx4 v[80:83], v1, s[8:11], s56 offen nt
    s_add_u32 s56, s56, 4096
    v_cvt_pk_bf16_f32 v49, v16, v17
    v_lshlrev_b32 v16, 16, v49
    v_and_b32 v17, s60, v49
    v_mul_f32 v16, s58, v16
    v_mul_f32 v17, s58, v17
    v_cvt_pk_bf16_f32 v49, v16, v17
    v_lshlrev_b32 v16, 16, v49
    v_and_b32 v17, s60, v49
    v_max3_f32 v46, v46, v16, v17
    v_mfma_f32_16x16x32_bf16 v[28:31], v[224:227], v[4:7], 0
    v_mfma_f32_16x16x32_bf16 v[32:35], v[228:231], v[4:7], 0
    v_mfma_f32_16x16x32_bf16 v[36:39], v[232:235], v[4:7], 0
    v_mfma_f32_16x16x32_bf16 v[40:43], v[236:239], v[4:7], 0
    s_nop 4
    v_add_f32_dpp v44, v29, v28 row_ror:12 row_mask:0xf bank_mask:0x1
    s_nop 0
    v_add_f32_dpp v45, v37, v36 row_ror:12 row_mask:0xf bank_mask:0x1
    v_add_f32_dpp v44, v32, v33 row_ror:4 row_mask:0xf bank_mask:0x2
    s_nop 0
    v_add_f32_dpp v45, v40, v41 row_ror:4 row_mask:0xf bank_mask:0x2
    v_add_f32_dpp v44, v31, v30 row_ror:12 row_mask:0xf bank_mask:0x4
    s_nop 0
    v_add_f32_dpp v45, v39, v38 row_ror:12 row_mask:0xf bank_mask:0x4
    v_add_f32_dpp v44, v34, v35 row_ror:4 row_mask:0xf bank_mask:0x8
    s_nop 0
    v_add_f32_dpp v45, v42, v43 row_ror:4 row_mask:0xf bank_mask:0x8
    v_add_f32_dpp v18, v44, v44 row_ror:8 row_mask:0xf bank_mask:0x3
    s_nop 1
    v_add_f32_dpp v18, v45, v45 row_ror:8 row_mask:0xf bank_mask:0xc
    v_mfma_f32_16x16x32_bf16 v[28:31], v[240:243], v[4:7], 0
    v_mfma_f32_16x16x32_bf16 v[32:35], v[244:247], v[4:7], 0
    v_mfma_f32_16x16x32_bf16 v[36:39], v[248:251], v[4:7], 0
    v_mfma_f32_16x16x32_bf16 v[40:43], v[252:255], v[4:7], 0
    s_nop 4
    v_add_f32_dpp v44, v29, v28 row_ror:12 row_mask:0xf bank_mask:0x1
    s_nop 0
    v_add_f32_dpp v45, v37, v36 row_ror:12 row_mask:0xf bank_mask:0x1
    v_add_f32_dpp v44, v32, v33 row_ror:4 row_mask:0xf bank_mask:0x2
    s_nop 0
    v_add_f32_dpp v45, v40, v41 row_ror:4 row_mask:0xf bank_mask:0x2
    v_add_f32_dpp v44, v31, v30 row_ror:12 row_mask:0xf bank_mask:0x4
    s_nop 0
    v_add_f32_dpp v45, v39, v38 row_ror:12 row_mask:0xf bank_mask:0x4
    v_add_f32_dpp v44, v34, v35 row_ror:4 row_mask:0xf bank_mask:0x8
    s_nop 0
    v_add_f32_dpp v45, v42, v43 row_ror:4 row_mask:0xf bank_mask:0x8
    v_add_f32_dpp v19, v44, v44 row_ror:8 row_mask:0xf bank_mask:0x3
    s_nop 1
    v_add_f32_dpp v19, v45, v45 row_ror:8 row_mask:0xf bank_mask:0xc
    s_waitcnt vmcnt(4)
    buffer_load_dwordx4 v[84:87], v1, s[8:11], s56 offen nt
    s_add_u32 s56, s56, 4096
    v_cvt_pk_bf16_f32 v49, v18, v19
    v_lshlrev_b32 v18, 16, v49
    v_and_b32 v19, s60, v49
    v_mul_f32 v18, s58, v18
    v_mul_f32 v19, s58, v19
    v_cvt_pk_bf16_f32 v49, v18, v19
    v_lshlrev_b32 v18, 16, v49
    v_and_b32 v19, s60, v49
    v_max3_f32 v46, v46, v18, v19
    s_waitcnt vmcnt(4)
    buffer_load_dwordx4 v[88:91], v1, s[8:11], s56 offen nt
    s_add_u32 s56, s56, 4096
    s_waitcnt vmcnt(4)
    buffer_load_dwordx4 v[92:95], v1, s[8:11], s56 offen nt
    s_add_u32 s56, s56, 4096
    s_waitcnt vmcnt(4)
    buffer_load_dwordx4 v[96:99], v1, s[8:11], s56 offen nt
    s_add_u32 s56, s56, 4096
    v_mfma_f32_16x16x32_bf16 v[28:31], v[64:67], v[4:7], 0
    v_mfma_f32_16x16x32_bf16 v[32:35], v[68:71], v[4:7], 0
    v_mfma_f32_16x16x32_bf16 v[36:39], v[72:75], v[4:7], 0
    v_mfma_f32_16x16x32_bf16 v[40:43], v[76:79], v[4:7], 0
    s_nop 4
    v_add_f32_dpp v44, v29, v28 row_ror:12 row_mask:0xf bank_mask:0x1
    s_nop 0
    v_add_f32_dpp v45, v37, v36 row_ror:12 row_mask:0xf bank_mask:0x1
    v_add_f32_dpp v44, v32, v33 row_ror:4 row_mask:0xf bank_mask:0x2
    s_nop 0
    v_add_f32_dpp v45, v40, v41 row_ror:4 row_mask:0xf bank_mask:0x2
    v_add_f32_dpp v44, v31, v30 row_ror:12 row_mask:0xf bank_mask:0x4
    s_nop 0
    v_add_f32_dpp v45, v39, v38 row_ror:12 row_mask:0xf bank_mask:0x4
    v_add_f32_dpp v44, v34, v35 row_ror:4 row_mask:0xf bank_mask:0x8
    s_nop 0
    v_add_f32_dpp v45, v42, v43 row_ror:4 row_mask:0xf bank_mask:0x8
    v_add_f32_dpp v20, v44, v44 row_ror:8 row_mask:0xf bank_mask:0x3
    s_nop 1
    v_add_f32_dpp v20, v45, v45 row_ror:8 row_mask:0xf bank_mask:0xc
    s_waitcnt vmcnt(4)
    buffer_load_dwordx4 v[100:103], v1, s[8:11], s56 offen nt
    s_add_u32 s56, s56, 4096
    s_waitcnt vmcnt(4)
    buffer_load_dwordx4 v[104:107], v1, s[8:11], s56 offen nt
    s_add_u32 s56, s56, 4096
    s_waitcnt vmcnt(4)
    buffer_load_dwordx4 v[108:111], v1, s[8:11], s56 offen nt
    s_add_u32 s56, s56, 4096
    s_waitcnt vmcnt(4)
    buffer_load_dwordx4 v[112:115], v1, s[8:11], s56 offen nt
    s_add_u32 s56, s56, 4096
    v_mfma_f32_16x16x32_bf16 v[28:31], v[80:83], v[4:7], 0
    v_mfma_f32_16x16x32_bf16 v[32:35], v[84:87], v[4:7], 0
    v_mfma_f32_16x16x32_bf16 v[36:39], v[88:91], v[4:7], 0
    v_mfma_f32_16x16x32_bf16 v[40:43], v[92:95], v[4:7], 0
    s_nop 4
    v_add_f32_dpp v44, v29, v28 row_ror:12 row_mask:0xf bank_mask:0x1
    s_nop 0
    v_add_f32_dpp v45, v37, v36 row_ror:12 row_mask:0xf bank_mask:0x1
    v_add_f32_dpp v44, v32, v33 row_ror:4 row_mask:0xf bank_mask:0x2
    s_nop 0
    v_add_f32_dpp v45, v40, v41 row_ror:4 row_mask:0xf bank_mask:0x2
    v_add_f32_dpp v44, v31, v30 row_ror:12 row_mask:0xf bank_mask:0x4
    s_nop 0
    v_add_f32_dpp v45, v39, v38 row_ror:12 row_mask:0xf bank_mask:0x4
    v_add_f32_dpp v44, v34, v35 row_ror:4 row_mask:0xf bank_mask:0x8
    s_nop 0
    v_add_f32_dpp v45, v42, v43 row_ror:4 row_mask:0xf bank_mask:0x8
    v_add_f32_dpp v21, v44, v44 row_ror:8 row_mask:0xf bank_mask:0x3
    s_nop 1
    v_add_f32_dpp v21, v45, v45 row_ror:8 row_mask:0xf bank_mask:0xc
    v_cvt_pk_bf16_f32 v49, v20, v21
    v_lshlrev_b32 v20, 16, v49
    v_and_b32 v21, s60, v49
    v_mul_f32 v20, s58, v20
    v_mul_f32 v21, s58, v21
    v_cvt_pk_bf16_f32 v49, v20, v21
    v_lshlrev_b32 v20, 16, v49
    v_and_b32 v21, s60, v49
    v_max3_f32 v46, v46, v20, v21
    s_waitcnt vmcnt(4)
    buffer_load_dwordx4 v[116:119], v1, s[8:11], s56 offen nt
    s_add_u32 s56, s56, 4096
    s_waitcnt vmcnt(4)
    buffer_load_dwordx4 v[120:123], v1, s[8:11], s56 offen nt
    s_add_u32 s56, s56, 4096
    s_waitcnt vmcnt(4)
    buffer_load_dwordx4 v[124:127], v1, s[8:11], s56 offen nt
    s_add_u32 s56, s56, 4096
    s_waitcnt vmcnt(4)
    buffer_load_dwordx4 v[128:131], v1, s[8:11], s56 offen nt
    v_mfma_f32_16x16x32_bf16 v[28:31], v[96:99], v[4:7], 0
    v_mfma_f32_16x16x32_bf16 v[32:35], v[100:103], v[4:7], 0
    v_mfma_f32_16x16x32_bf16 v[36:39], v[104:107], v[4:7], 0
    v_mfma_f32_16x16x32_bf16 v[40:43], v[108:111], v[4:7], 0
    s_nop 4
    v_add_f32_dpp v44, v29, v28 row_ror:12 row_mask:0xf bank_mask:0x1
    s_nop 0
    v_add_f32_dpp v45, v37, v36 row_ror:12 row_mask:0xf bank_mask:0x1
    v_add_f32_dpp v44, v32, v33 row_ror:4 row_mask:0xf bank_mask:0x2
    s_nop 0
    v_add_f32_dpp v45, v40, v41 row_ror:4 row_mask:0xf bank_mask:0x2
    v_add_f32_dpp v44, v31, v30 row_ror:12 row_mask:0xf bank_mask:0x4
    s_nop 0
    v_add_f32_dpp v45, v39, v38 row_ror:12 row_mask:0xf bank_mask:0x4
    v_add_f32_dpp v44, v34, v35 row_ror:4 row_mask:0xf bank_mask:0x8
    s_nop 0
    v_add_f32_dpp v45, v42, v43 row_ror:4 row_mask:0xf bank_mask:0x8
    v_add_f32_dpp v22, v44, v44 row_ror:8 row_mask:0xf bank_mask:0x3
    s_nop 1
    v_add_f32_dpp v22, v45, v45 row_ror:8 row_mask:0xf bank_mask:0xc
    s_waitcnt vmcnt(4)
    buffer_load_dwordx4 v[132:135], v2, s[12:15], s57 offen nt
    s_add_u32 s57, s57, 4096
    s_waitcnt vmcnt(4)
    buffer_load_dwordx4 v[136:139], v2, s[12:15], s57 offen nt
    s_add_u32 s57, s57, 4096
    s_waitcnt vmcnt(4)
    buffer_load_dwordx4 v[140:143], v2, s[12:15], s57 offen nt
    s_add_u32 s57, s57, 4096
    s_waitcnt vmcnt(4)
    buffer_load_dwordx4 v[144:147], v2, s[12:15], s57 offen nt
    s_add_u32 s57, s57, 4096
    v_mfma_f32_16x16x32_bf16 v[28:31], v[112:115], v[4:7], 0
    v_mfma_f32_16x16x32_bf16 v[32:35], v[116:119], v[4:7], 0
    v_mfma_f32_16x16x32_bf16 v[36:39], v[120:123], v[4:7], 0
    v_mfma_f32_16x16x32_bf16 v[40:43], v[124:127], v[4:7], 0
    s_nop 4
    v_add_f32_dpp v44, v29, v28 row_ror:12 row_mask:0xf bank_mask:0x1
    s_nop 0
    v_add_f32_dpp v45, v37, v36 row_ror:12 row_mask:0xf bank_mask:0x1
    v_add_f32_dpp v44, v32, v33 row_ror:4 row_mask:0xf bank_mask:0x2
    s_nop 0
    v_add_f32_dpp v45, v40, v41 row_ror:4 row_mask:0xf bank_mask:0x2
    v_add_f32_dpp v44, v31, v30 row_ror:12 row_mask:0xf bank_mask:0x4
    s_nop 0
    v_add_f32_dpp v45, v39, v38 row_ror:12 row_mask:0xf bank_mask:0x4
    v_add_f32_dpp v44, v34, v35 row_ror:4 row_mask:0xf bank_mask:0x8
    s_nop 0
    v_add_f32_dpp v45, v42, v43 row_ror:4 row_mask:0xf bank_mask:0x8
    v_add_f32_dpp v23, v44, v44 row_ror:8 row_mask:0xf bank_mask:0x3
    s_nop 1
    v_add_f32_dpp v23, v45, v45 row_ror:8 row_mask:0xf bank_mask:0xc
    v_cvt_pk_bf16_f32 v49, v22, v23
    v_lshlrev_b32 v22, 16, v49
    v_and_b32 v23, s60, v49
    v_mul_f32 v22, s58, v22
    v_mul_f32 v23, s58, v23
    v_cvt_pk_bf16_f32 v49, v22, v23
    v_lshlrev_b32 v22, 16, v49
    v_and_b32 v23, s60, v49
    v_max3_f32 v46, v46, v22, v23
    s_waitcnt vmcnt(4)
    buffer_load_dwordx4 v[148:151], v2, s[12:15], s57 offen nt
    s_add_u32 s57, s57, 4096
    v_mfma_f32_16x16x32_bf16 v[28:31], v[128:131], v[4:7], 0
    s_nop 7
    v_add_f32_dpp v44, v29, v28 row_ror:12 row_mask:0xf bank_mask:0x1
    v_add_f32_dpp v45, v37, v36 row_ror:12 row_mask:0xf bank_mask:0x1
    s_nop 0
    v_add_f32_dpp v44, v32, v33 row_ror:4 row_mask:0xf bank_mask:0x2
    v_add_f32_dpp v45, v40, v41 row_ror:4 row_mask:0xf bank_mask:0x2
    s_nop 0
    v_add_f32_dpp v44, v31, v30 row_ror:12 row_mask:0xf bank_mask:0x4
    v_add_f32_dpp v45, v39, v38 row_ror:12 row_mask:0xf bank_mask:0x4
    s_nop 0
    v_add_f32_dpp v44, v34, v35 row_ror:4 row_mask:0xf bank_mask:0x8
    v_add_f32_dpp v45, v42, v43 row_ror:4 row_mask:0xf bank_mask:0x8
    s_nop 0
    v_add_f32_dpp v24, v44, v44 row_ror:8 row_mask:0xf bank_mask:0x3
    s_nop 1
    v_add_f32_dpp v24, v45, v45 row_ror:8 row_mask:0xf bank_mask:0xc
    v_mov_b32 v49, 0xff800000
    s_nop 1
    v_mov_b32_dpp v24, v49 quad_perm:[0,1,2,3] row_mask:0xf bank_mask:0xe
    v_cvt_pk_bf16_f32 v49, v24, v24
    v_and_b32 v24, s60, v49
    v_mul_f32 v24, s58, v24
    v_cvt_pk_bf16_f32 v49, v24, v24
    v_and_b32 v24, s60, v49
    v_max3_f32 v46, v46, v24, v24
    s_nop 1
    v_max_f32_dpp v46, v46, v46 row_ror:4 row_mask:0xf bank_mask:0xf
    s_nop 1
    v_max_f32_dpp v46, v46, v46 row_ror:8 row_mask:0xf bank_mask:0xf
    v_mov_b32 v49, v46
    s_nop 1
    v_permlane16_swap_b32 v46, v49
    v_max_f32 v46, v46, v49
    v_mov_b32 v49, v46
    s_nop 1
    v_permlane32_swap_b32 v46, v49
    v_max_f32 v46, v46, v49
    v_mul_f32 v50, s59, v46
    s_waitcnt vmcnt(4)
    buffer_load_dwordx4 v[152:155], v2, s[12:15], s57 offen nt
    s_add_u32 s57, s57, 4096
    v_fma_f32 v8, v8, s59, -v50
    v_fma_f32 v9, v9, s59, -v50
    v_fma_f32 v10, v10, s59, -v50
    v_fma_f32 v11, v11, s59, -v50
    v_fma_f32 v12, v12, s59, -v50
    v_fma_f32 v13, v13, s59, -v50
    v_fma_f32 v14, v14, s59, -v50
    v_fma_f32 v15, v15, s59, -v50
    v_exp_f32 v8, v8
    v_exp_f32 v9, v9
    v_exp_f32 v10, v10
    v_exp_f32 v11, v11
    v_exp_f32 v12, v12
    v_exp_f32 v13, v13
    v_exp_f32 v14, v14
    v_exp_f32 v15, v15
    v_add_f32 v47, v8, v9
    v_add_f32 v47, v47, v10
    v_add_f32 v47, v47, v11
    v_add_f32 v47, v47, v12
    v_add_f32 v47, v47, v13
    v_add_f32 v47, v47, v14
    v_add_f32 v47, v47, v15
    v_fma_f32 v16, v16, s59, -v50
    v_fma_f32 v17, v17, s59, -v50
    v_fma_f32 v18, v18, s59, -v50
    v_fma_f32 v19, v19, s59, -v50
    v_fma_f32 v20, v20, s59, -v50
    v_fma_f32 v21, v21, s59, -v50
    v_fma_f32 v22, v22, s59, -v50
    v_fma_f32 v23, v23, s59, -v50
    v_fma_f32 v24, v24, s59, -v50
    v_exp_f32 v16, v16
    v_exp_f32 v17, v17
    v_exp_f32 v18, v18
    v_exp_f32 v19, v19
    v_exp_f32 v20, v20
    v_exp_f32 v21, v21
    v_exp_f32 v22, v22
    v_exp_f32 v23, v23
    v_exp_f32 v24, v24
    v_add_f32 v47, v47, v16
    v_add_f32 v47, v47, v17
    v_add_f32 v47, v47, v18
    v_add_f32 v47, v47, v19
    v_add_f32 v47, v47, v20
    v_add_f32 v47, v47, v21
    v_add_f32 v47, v47, v22
    v_add_f32 v47, v47, v23
    v_add_f32 v47, v47, v24
    s_waitcnt vmcnt(4)
    buffer_load_dwordx4 v[156:159], v2, s[12:15], s57 offen nt
    s_add_u32 s57, s57, 4096
    v_add_f32_dpp v47, v47, v47 row_ror:4 row_mask:0xf bank_mask:0xf
    s_nop 1
    v_add_f32_dpp v47, v47, v47 row_ror:8 row_mask:0xf bank_mask:0xf
    v_mov_b32 v49, v47
    s_nop 1
    v_permlane16_swap_b32 v47, v49
    v_add_f32 v47, v47, v49
    v_mov_b32 v49, v47
    s_nop 1
    v_permlane32_swap_b32 v47, v49
    v_add_f32 v47, v47, v49
    v_and_b32 v3, 3, v0
    v_lshlrev_b32 v3, 4, v3
    v_add_u32 v3, 143872, v3
    s_lshl_b32 s6, s3, 2
    v_add_u32 v4, s6, v3
    s_mov_b64 exec, 15
    ds_write_b32 v4, v46
    ds_write_b32 v4, v47 offset:64
    s_mov_b64 exec, 1
    ds_add_u32 v25, v26 offset:4
    s_mov_b64 exec, -1
    v_mov_b32 v28, 0
    v_mov_b32 v29, 0
    v_mov_b32 v30, 0
    v_mov_b32 v31, 0
    v_mov_b32 v32, 0
    v_mov_b32 v33, 0
    v_mov_b32 v34, 0
    v_mov_b32 v35, 0
    v_mov_b32 v56, 0
    v_mov_b32 v57, 0
    v_mov_b32 v58, 0
    v_mov_b32 v59, 0
    v_mov_b32 v60, 0
    v_mov_b32 v61, 0
    v_mov_b32 v62, 0
    v_mov_b32 v63, 0
    s_lshl_b32 s6, s3, 10
    s_add_u32 s6, s6, 131072
    v_add_u32 v51, s6, v2
    s_lshl_b32 s61, s4, 16
    s_lshl_b32 s7, s5, 11
    s_add_u32 s61, s61, s7
    s_lshl_b32 s7, s3, 10
    s_add_u32 s61, s61, s7
    s_add_u32 s61, s61, 262144
    s_waitcnt vmcnt(4)
    buffer_load_dwordx4 v[160:163], v2, s[12:15], s57 offen nt
    s_add_u32 s57, s57, 4096
    s_waitcnt vmcnt(4)
    buffer_load_dwordx4 v[164:167], v2, s[12:15], s57 offen nt
    s_add_u32 s57, s57, 4096
    s_waitcnt vmcnt(4)
    buffer_load_dwordx4 v[168:171], v2, s[12:15], s57 offen nt
    s_add_u32 s57, s57, 4096
    s_mov_b32 s7, 0
L_fl_71:
    ds_read_b32 v27, v25 offset:4
    ds_read_b128 v[52:55], v3
    s_add_u32 s7, s7, 1
    s_cmp_gt_u32 s7, 33554432
    s_cbranch_scc1 L_flok_72
    s_waitcnt lgkmcnt(1)
    v_cmp_le_u32 vcc, 4, v27
    s_cbranch_vccnz L_flok_72
    s_waitcnt lgkmcnt(0)
    s_branch L_fl_71
L_flok_72:
    s_waitcnt lgkmcnt(0)
    v_max3_f32 v48, v52, v53, v54
    v_max_f32 v48, v48, v55
    v_sub_f32 v48, v46, v48
    v_mul_f32 v48, s59, v48
    v_exp_f32 v48, v48
    s_lshl_b32 s6, s3, 11
    s_add_u32 s6, s6, 131072
    v_add_u32 v3, s6, v2
    v_mul_f32 v49, v8, v48
    v_cvt_pk_bf16_f32 v36, v49, 0
    v_cvt_pk_bf16_f32 v37, 0, v49
    s_nop 0
    v_mov_b32_dpp v28, v36 quad_perm:[0,1,2,3] row_mask:0xf bank_mask:0x1
    v_mov_b32_dpp v29, v36 row_ror:8 row_mask:0xf bank_mask:0x4
    v_mov_b32_dpp v30, v36 row_ror:12 row_mask:0xf bank_mask:0x1
    v_mov_b32_dpp v31, v36 row_ror:4 row_mask:0xf bank_mask:0x4
    v_mov_b32_dpp v28, v37 row_ror:4 row_mask:0xf bank_mask:0x2
    v_mov_b32_dpp v29, v37 row_ror:12 row_mask:0xf bank_mask:0x8
    v_mov_b32_dpp v30, v37 quad_perm:[0,1,2,3] row_mask:0xf bank_mask:0x2
    v_mov_b32_dpp v31, v37 row_ror:8 row_mask:0xf bank_mask:0x8
    v_mfma_f32_16x16x16_bf16 v[56:59], v[28:29], v[132:133], v[56:59]
    v_mfma_f32_16x16x16_bf16 v[60:63], v[28:29], v[134:135], v[60:63]
    v_mfma_f32_16x16x16_bf16 v[56:59], v[30:31], v[136:137], v[56:59]
    v_mfma_f32_16x16x16_bf16 v[60:63], v[30:31], v[138:139], v[60:63]
    v_mov_b32_dpp v32, v36 row_ror:8 row_mask:0xf bank_mask:0x1
    v_mov_b32_dpp v33, v36 quad_perm:[0,1,2,3] row_mask:0xf bank_mask:0x4
    v_mov_b32_dpp v34, v36 row_ror:4 row_mask:0xf bank_mask:0x1
    v_mov_b32_dpp v35, v36 row_ror:12 row_mask:0xf bank_mask:0x4
    v_mov_b32_dpp v32, v37 row_ror:12 row_mask:0xf bank_mask:0x2
    v_mov_b32_dpp v33, v37 row_ror:4 row_mask:0xf bank_mask:0x8
    v_mov_b32_dpp v34, v37 row_ror:8 row_mask:0xf bank_mask:0x2
    v_mov_b32_dpp v35, v37 quad_perm:[0,1,2,3] row_mask:0xf bank_mask:0x8
    s_waitcnt vmcnt(4)
    buffer_load_dwordx4 v[172:175], v2, s[12:15], s57 offen nt
    s_add_u32 s57, s57, 4096
    v_mfma_f32_16x16x16_bf16 v[56:59], v[32:33], v[140:141], v[56:59]
    v_mfma_f32_16x16x16_bf16 v[60:63], v[32:33], v[142:143], v[60:63]
    v_mfma_f32_16x16x16_bf16 v[56:59], v[34:35], v[144:145], v[56:59]
    v_mfma_f32_16x16x16_bf16 v[60:63], v[34:35], v[146:147], v[60:63]
    v_mul_f32 v49, v9, v48
    v_cvt_pk_bf16_f32 v36, v49, 0
    v_cvt_pk_bf16_f32 v37, 0, v49
    s_nop 0
    v_mov_b32_dpp v28, v36 quad_perm:[0,1,2,3] row_mask:0xf bank_mask:0x1
    v_mov_b32_dpp v29, v36 row_ror:8 row_mask:0xf bank_mask:0x4
    v_mov_b32_dpp v30, v36 row_ror:12 row_mask:0xf bank_mask:0x1
    v_mov_b32_dpp v31, v36 row_ror:4 row_mask:0xf bank_mask:0x4
    v_mov_b32_dpp v28, v37 row_ror:4 row_mask:0xf bank_mask:0x2
    v_mov_b32_dpp v29, v37 row_ror:12 row_mask:0xf bank_mask:0x8
    v_mov_b32_dpp v30, v37 quad_perm:[0,1,2,3] row_mask:0xf bank_mask:0x2
    v_mov_b32_dpp v31, v37 row_ror:8 row_mask:0xf bank_mask:0x8
    v_mfma_f32_16x16x16_bf16 v[56:59], v[28:29], v[148:149], v[56:59]
    v_mfma_f32_16x16x16_bf16 v[60:63], v[28:29], v[150:151], v[60:63]
    s_waitcnt vmcnt(4)
    buffer_load_dwordx4 v[176:179], v2, s[12:15], s57 offen nt
    s_add_u32 s57, s57, 4096
    v_mfma_f32_16x16x16_bf16 v[56:59], v[30:31], v[152:153], v[56:59]
    v_mfma_f32_16x16x16_bf16 v[60:63], v[30:31], v[154:155], v[60:63]
    v_mov_b32_dpp v32, v36 row_ror:8 row_mask:0xf bank_mask:0x1
    v_mov_b32_dpp v33, v36 quad_perm:[0,1,2,3] row_mask:0xf bank_mask:0x4
    v_mov_b32_dpp v34, v36 row_ror:4 row_mask:0xf bank_mask:0x1
    v_mov_b32_dpp v35, v36 row_ror:12 row_mask:0xf bank_mask:0x4
    v_mov_b32_dpp v32, v37 row_ror:12 row_mask:0xf bank_mask:0x2
    v_mov_b32_dpp v33, v37 row_ror:4 row_mask:0xf bank_mask:0x8
    v_mov_b32_dpp v34, v37 row_ror:8 row_mask:0xf bank_mask:0x2
    v_mov_b32_dpp v35, v37 quad_perm:[0,1,2,3] row_mask:0xf bank_mask:0x8
    v_mfma_f32_16x16x16_bf16 v[56:59], v[32:33], v[156:157], v[56:59]
    v_mfma_f32_16x16x16_bf16 v[60:63], v[32:33], v[158:159], v[60:63]
    s_waitcnt vmcnt(4)
    buffer_load_dwordx4 v[180:183], v2, s[12:15], s57 offen nt
    s_add_u32 s57, s57, 4096
    v_mfma_f32_16x16x16_bf16 v[56:59], v[34:35], v[160:161], v[56:59]
    v_mfma_f32_16x16x16_bf16 v[60:63], v[34:35], v[162:163], v[60:63]
    v_mul_f32 v49, v10, v48
    v_cvt_pk_bf16_f32 v36, v49, 0
    v_cvt_pk_bf16_f32 v37, 0, v49
    s_nop 0
    v_mov_b32_dpp v28, v36 quad_perm:[0,1,2,3] row_mask:0xf bank_mask:0x1
    v_mov_b32_dpp v29, v36 row_ror:8 row_mask:0xf bank_mask:0x4
    v_mov_b32_dpp v30, v36 row_ror:12 row_mask:0xf bank_mask:0x1
    v_mov_b32_dpp v31, v36 row_ror:4 row_mask:0xf bank_mask:0x4
    v_mov_b32_dpp v28, v37 row_ror:4 row_mask:0xf bank_mask:0x2
    v_mov_b32_dpp v29, v37 row_ror:12 row_mask:0xf bank_mask:0x8
    v_mov_b32_dpp v30, v37 quad_perm:[0,1,2,3] row_mask:0xf bank_mask:0x2
    v_mov_b32_dpp v31, v37 row_ror:8 row_mask:0xf bank_mask:0x8
    s_waitcnt vmcnt(4)
    buffer_load_dwordx4 v[184:187], v2, s[12:15], s57 offen nt
    s_add_u32 s57, s57, 4096
    v_mfma_f32_16x16x16_bf16 v[56:59], v[28:29], v[164:165], v[56:59]
    v_mfma_f32_16x16x16_bf16 v[60:63], v[28:29], v[166:167], v[60:63]
    s_waitcnt vmcnt(4)
    buffer_load_dwordx4 v[188:191], v2, s[12:15], s57 offen nt
    s_add_u32 s57, s57, 4096
    v_mfma_f32_16x16x16_bf16 v[56:59], v[30:31], v[168:169], v[56:59]
    v_mfma_f32_16x16x16_bf16 v[60:63], v[30:31], v[170:171], v[60:63]
    v_mov_b32_dpp v32, v36 row_ror:8 row_mask:0xf bank_mask:0x1
    v_mov_b32_dpp v33, v36 quad_perm:[0,1,2,3] row_mask:0xf bank_mask:0x4
    v_mov_b32_dpp v34, v36 row_ror:4 row_mask:0xf bank_mask:0x1
    v_mov_b32_dpp v35, v36 row_ror:12 row_mask:0xf bank_mask:0x4
    v_mov_b32_dpp v32, v37 row_ror:12 row_mask:0xf bank_mask:0x2
    v_mov_b32_dpp v33, v37 row_ror:4 row_mask:0xf bank_mask:0x8
    v_mov_b32_dpp v34, v37 row_ror:8 row_mask:0xf bank_mask:0x2
    v_mov_b32_dpp v35, v37 quad_perm:[0,1,2,3] row_mask:0xf bank_mask:0x8
    s_waitcnt vmcnt(4)
    buffer_load_dwordx4 v[192:195], v2, s[12:15], s57 offen nt
    s_add_u32 s57, s57, 4096
    v_mfma_f32_16x16x16_bf16 v[56:59], v[32:33], v[172:173], v[56:59]
    v_mfma_f32_16x16x16_bf16 v[60:63], v[32:33], v[174:175], v[60:63]
    s_waitcnt vmcnt(4)
    buffer_load_dwordx4 v[196:199], v2, s[12:15], s57 offen nt
    s_add_u32 s57, s57, 4096
    v_mfma_f32_16x16x16_bf16 v[56:59], v[34:35], v[176:177], v[56:59]
    v_mfma_f32_16x16x16_bf16 v[60:63], v[34:35], v[178:179], v[60:63]
    v_mul_f32 v49, v11, v48
    v_cvt_pk_bf16_f32 v36, v49, 0
    v_cvt_pk_bf16_f32 v37, 0, v49
    s_nop 0
    v_mov_b32_dpp v28, v36 quad_perm:[0,1,2,3] row_mask:0xf bank_mask:0x1
    v_mov_b32_dpp v29, v36 row_ror:8 row_mask:0xf bank_mask:0x4
    v_mov_b32_dpp v30, v36 row_ror:12 row_mask:0xf bank_mask:0x1
    v_mov_b32_dpp v31, v36 row_ror:4 row_mask:0xf bank_mask:0x4
    v_mov_b32_dpp v28, v37 row_ror:4 row_mask:0xf bank_mask:0x2
    v_mov_b32_dpp v29, v37 row_ror:12 row_mask:0xf bank_mask:0x8
    v_mov_b32_dpp v30, v37 quad_perm:[0,1,2,3] row_mask:0xf bank_mask:0x2
    v_mov_b32_dpp v31, v37 row_ror:8 row_mask:0xf bank_mask:0x8
    ds_read_b32 v27, v25 offset:52
    s_waitcnt lgkmcnt(0)
    v_readfirstlane_b32 s76, v27
    s_nop 0
    s_lshr_b32 s77, s76, 8
    s_and_b32 s76, s76, 0xff
    s_cmp_gt_u32 s76, 0
    s_cbranch_scc1 L_bo_73
    s_cmp_le_u32 s77, 0
    s_cbranch_scc1 L_th_74
    s_waitcnt vmcnt(3)
L_th_74:
    s_waitcnt vmcnt(4)
L_bo_73:
    s_waitcnt vmcnt(5)
    buffer_load_dwordx4 v[200:203], v2, s[12:15], s57 offen nt
    s_add_u32 s57, s57, 4096
    s_cmp_gt_u32 s76, 1
    s_cbranch_scc1 L_bo_75
    s_cmp_le_u32 s77, 1
    s_cbranch_scc1 L_th_76
    s_waitcnt vmcnt(3)
L_th_76:
    s_waitcnt vmcnt(4)
L_bo_75:
    s_waitcnt vmcnt(5)
    buffer_load_dwordx4 v[204:207], v2, s[12:15], s57 offen nt
    s_add_u32 s57, s57, 4096
    v_mfma_f32_16x16x16_bf16 v[56:59], v[28:29], v[180:181], v[56:59]
    v_mfma_f32_16x16x16_bf16 v[60:63], v[28:29], v[182:183], v[60:63]
    s_cmp_gt_u32 s76, 2
    s_cbranch_scc1 L_bo_77
    s_cmp_le_u32 s77, 2
    s_cbranch_scc1 L_th_78
    s_waitcnt vmcnt(3)
L_th_78:
    s_waitcnt vmcnt(4)
L_bo_77:
    s_waitcnt vmcnt(5)
    buffer_load_dwordx4 v[208:211], v2, s[12:15], s57 offen nt
    s_add_u32 s57, s57, 4096
    v_mfma_f32_16x16x16_bf16 v[56:59], v[30:31], v[184:185], v[56:59]
    v_mfma_f32_16x16x16_bf16 v[60:63], v[30:31], v[186:187], v[60:63]
    v_mov_b32_dpp v32, v36 row_ror:8 row_mask:0xf bank_mask:0x1
    v_mov_b32_dpp v33, v36 quad_perm:[0,1,2,3] row_mask:0xf bank_mask:0x4
    v_mov_b32_dpp v34, v36 row_ror:4 row_mask:0xf bank_mask:0x1
    v_mov_b32_dpp v35, v36 row_ror:12 row_mask:0xf bank_mask:0x4
    v_mov_b32_dpp v32, v37 row_ror:12 row_mask:0xf bank_mask:0x2
    v_mov_b32_dpp v33, v37 row_ror:4 row_mask:0xf bank_mask:0x8
    v_mov_b32_dpp v34, v37 row_ror:8 row_mask:0xf bank_mask:0x2
    v_mov_b32_dpp v35, v37 quad_perm:[0,1,2,3] row_mask:0xf bank_mask:0x8
    s_cmp_gt_u32 s76, 3
    s_cbranch_scc1 L_bo_79
    s_cmp_le_u32 s77, 3
    s_cbranch_scc1 L_th_80
    s_waitcnt vmcnt(3)
L_th_80:
    s_waitcnt vmcnt(4)
L_bo_79:
    s_waitcnt vmcnt(5)
    buffer_load_dwordx4 v[212:215], v2, s[12:15], s57 offen nt
    s_add_u32 s57, s57, 4096
    v_mfma_f32_16x16x16_bf16 v[56:59], v[32:33], v[188:189], v[56:59]
    v_mfma_f32_16x16x16_bf16 v[60:63], v[32:33], v[190:191], v[60:63]
    s_cmp_gt_u32 s76, 4
    s_cbranch_scc1 L_bo_81
    s_cmp_le_u32 s77, 4
    s_cbranch_scc1 L_th_82
    s_waitcnt vmcnt(3)
L_th_82:
    s_waitcnt vmcnt(4)
L_bo_81:
    s_waitcnt vmcnt(5)
    buffer_load_dwordx4 v[216:219], v2, s[12:15], s57 offen nt
    s_add_u32 s57, s57, 4096
    v_mfma_f32_16x16x16_bf16 v[56:59], v[34:35], v[192:193], v[56:59]
    v_mfma_f32_16x16x16_bf16 v[60:63], v[34:35], v[194:195], v[60:63]
    v_mul_f32 v49, v12, v48
    v_cvt_pk_bf16_f32 v36, v49, 0
    v_cvt_pk_bf16_f32 v37, 0, v49
    s_nop 0
    v_mov_b32_dpp v28, v36 quad_perm:[0,1,2,3] row_mask:0xf bank_mask:0x1
    v_mov_b32_dpp v29, v36 row_ror:8 row_mask:0xf bank_mask:0x4
    v_mov_b32_dpp v30, v36 row_ror:12 row_mask:0xf bank_mask:0x1
    v_mov_b32_dpp v31, v36 row_ror:4 row_mask:0xf bank_mask:0x4
    v_mov_b32_dpp v28, v37 row_ror:4 row_mask:0xf bank_mask:0x2
    v_mov_b32_dpp v29, v37 row_ror:12 row_mask:0xf bank_mask:0x8
    v_mov_b32_dpp v30, v37 quad_perm:[0,1,2,3] row_mask:0xf bank_mask:0x2
    v_mov_b32_dpp v31, v37 row_ror:8 row_mask:0xf bank_mask:0x8
    s_cmp_gt_u32 s76, 5
    s_cbranch_scc1 L_bo_83
    s_cmp_le_u32 s77, 5
    s_cbranch_scc1 L_th_84
    s_waitcnt vmcnt(3)
L_th_84:
    s_waitcnt vmcnt(4)
L_bo_83:
    s_waitcnt vmcnt(5)
    buffer_load_dwordx4 v[220:223], v2, s[12:15], s57 offen nt
    s_add_u32 s57, s57, 4096
    v_mfma_f32_16x16x16_bf16 v[56:59], v[28:29], v[196:197], v[56:59]
    v_mfma_f32_16x16x16_bf16 v[60:63], v[28:29], v[198:199], v[60:63]
    s_cmp_gt_u32 s76, 6
    s_cbranch_scc1 L_bo_85
    s_cmp_le_u32 s77, 6
    s_cbranch_scc1 L_th_86
    s_waitcnt vmcnt(3)
L_th_86:
    s_waitcnt vmcnt(4)
L_bo_85:
    s_waitcnt vmcnt(5)
    buffer_load_dwordx4 v[224:227], v2, s[12:15], s57 offen nt
    s_add_u32 s57, s57, 4096
    v_mfma_f32_16x16x16_bf16 v[56:59], v[30:31], v[200:201], v[56:59]
    v_mfma_f32_16x16x16_bf16 v[60:63], v[30:31], v[202:203], v[60:63]
    v_mov_b32_dpp v32, v36 row_ror:8 row_mask:0xf bank_mask:0x1
    v_mov_b32_dpp v33, v36 quad_perm:[0,1,2,3] row_mask:0xf bank_mask:0x4
    v_mov_b32_dpp v34, v36 row_ror:4 row_mask:0xf bank_mask:0x1
    v_mov_b32_dpp v35, v36 row_ror:12 row_mask:0xf bank_mask:0x4
    v_mov_b32_dpp v32, v37 row_ror:12 row_mask:0xf bank_mask:0x2
    v_mov_b32_dpp v33, v37 row_ror:4 row_mask:0xf bank_mask:0x8
    v_mov_b32_dpp v34, v37 row_ror:8 row_mask:0xf bank_mask:0x2
    v_mov_b32_dpp v35, v37 quad_perm:[0,1,2,3] row_mask:0xf bank_mask:0x8
    s_cmp_gt_u32 s76, 7
    s_cbranch_scc1 L_bo_87
    s_cmp_le_u32 s77, 7
    s_cbranch_scc1 L_th_88
    s_waitcnt vmcnt(3)
L_th_88:
    s_waitcnt vmcnt(4)
L_bo_87:
    s_waitcnt vmcnt(5)
    buffer_load_dwordx4 v[228:231], v2, s[12:15], s57 offen nt
    s_add_u32 s57, s57, 4096
    v_mfma_f32_16x16x16_bf16 v[56:59], v[32:33], v[204:205], v[56:59]
    v_mfma_f32_16x16x16_bf16 v[60:63], v[32:33], v[206:207], v[60:63]
    s_cmp_gt_u32 s76, 8
    s_cbranch_scc1 L_bo_89
    s_cmp_le_u32 s77, 8
    s_cbranch_scc1 L_th_90
    s_waitcnt vmcnt(3)
L_th_90:
    s_waitcnt vmcnt(4)
L_bo_89:
    s_waitcnt vmcnt(5)
    buffer_load_dwordx4 v[232:235], v2, s[12:15], s57 offen nt
    s_add_u32 s57, s57, 4096
    v_mfma_f32_16x16x16_bf16 v[56:59], v[34:35], v[208:209], v[56:59]
    v_mfma_f32_16x16x16_bf16 v[60:63], v[34:35], v[210:211], v[60:63]
    v_mul_f32 v49, v13, v48
    v_cvt_pk_bf16_f32 v36, v49, 0
    v_cvt_pk_bf16_f32 v37, 0, v49
    s_nop 0
    v_mov_b32_dpp v28, v36 quad_perm:[0,1,2,3] row_mask:0xf bank_mask:0x1
    v_mov_b32_dpp v29, v36 row_ror:8 row_mask:0xf bank_mask:0x4
    v_mov_b32_dpp v30, v36 row_ror:12 row_mask:0xf bank_mask:0x1
    v_mov_b32_dpp v31, v36 row_ror:4 row_mask:0xf bank_mask:0x4
    v_mov_b32_dpp v28, v37 row_ror:4 row_mask:0xf bank_mask:0x2
    v_mov_b32_dpp v29, v37 row_ror:12 row_mask:0xf bank_mask:0x8
    v_mov_b32_dpp v30, v37 quad_perm:[0,1,2,3] row_mask:0xf bank_mask:0x2
    v_mov_b32_dpp v31, v37 row_ror:8 row_mask:0xf bank_mask:0x8
    s_cmp_gt_u32 s76, 9
    s_cbranch_scc1 L_bo_91
    s_cmp_le_u32 s77, 9
    s_cbranch_scc1 L_th_92
    s_waitcnt vmcnt(3)
L_th_92:
    s_waitcnt vmcnt(4)
L_bo_91:
    s_waitcnt vmcnt(5)
    buffer_load_dwordx4 v[236:239], v2, s[12:15], s57 offen nt
    s_add_u32 s57, s57, 4096
    v_mfma_f32_16x16x16_bf16 v[56:59], v[28:29], v[212:213], v[56:59]
    v_mfma_f32_16x16x16_bf16 v[60:63], v[28:29], v[214:215], v[60:63]
    s_cmp_gt_u32 s76, 10
    s_cbranch_scc1 L_bo_93
    s_cmp_le_u32 s77, 10
    s_cbranch_scc1 L_th_94
    s_waitcnt vmcnt(3)
L_th_94:
    s_waitcnt vmcnt(4)
L_bo_93:
    s_waitcnt vmcnt(5)
    buffer_load_dwordx4 v[240:243], v2, s[12:15], s57 offen nt
    s_add_u32 s57, s57, 4096
    v_mfma_f32_16x16x16_bf16 v[56:59], v[30:31], v[216:217], v[56:59]
    v_mfma_f32_16x16x16_bf16 v[60:63], v[30:31], v[218:219], v[60:63]
    v_mov_b32_dpp v32, v36 row_ror:8 row_mask:0xf bank_mask:0x1
    v_mov_b32_dpp v33, v36 quad_perm:[0,1,2,3] row_mask:0xf bank_mask:0x4
    v_mov_b32_dpp v34, v36 row_ror:4 row_mask:0xf bank_mask:0x1
    v_mov_b32_dpp v35, v36 row_ror:12 row_mask:0xf bank_mask:0x4
    v_mov_b32_dpp v32, v37 row_ror:12 row_mask:0xf bank_mask:0x2
    v_mov_b32_dpp v33, v37 row_ror:4 row_mask:0xf bank_mask:0x8
    v_mov_b32_dpp v34, v37 row_ror:8 row_mask:0xf bank_mask:0x2
    v_mov_b32_dpp v35, v37 quad_perm:[0,1,2,3] row_mask:0xf bank_mask:0x8
    s_cmp_gt_u32 s76, 11
    s_cbranch_scc1 L_bo_95
    s_cmp_le_u32 s77, 11
    s_cbranch_scc1 L_th_96
    s_waitcnt vmcnt(3)
L_th_96:
    s_waitcnt vmcnt(4)
L_bo_95:
    s_waitcnt vmcnt(5)
    buffer_load_dwordx4 v[244:247], v2, s[12:15], s57 offen nt
    s_add_u32 s57, s57, 4096
    v_mfma_f32_16x16x16_bf16 v[56:59], v[32:33], v[220:221], v[56:59]
    v_mfma_f32_16x16x16_bf16 v[60:63], v[32:33], v[222:223], v[60:63]
    s_cmp_gt_u32 s76, 12
    s_cbranch_scc1 L_bo_97
    s_waitcnt vmcnt(4)
L_bo_97:
    s_waitcnt vmcnt(5)
    buffer_load_dwordx4 v[248:251], v2, s[12:15], s57 offen nt
    s_add_u32 s57, s57, 4096
    v_mfma_f32_16x16x16_bf16 v[56:59], v[34:35], v[224:225], v[56:59]
    v_mfma_f32_16x16x16_bf16 v[60:63], v[34:35], v[226:227], v[60:63]
    v_mul_f32 v49, v14, v48
    v_cvt_pk_bf16_f32 v36, v49, 0
    v_cvt_pk_bf16_f32 v37, 0, v49
    s_nop 0
    v_mov_b32_dpp v28, v36 quad_perm:[0,1,2,3] row_mask:0xf bank_mask:0x1
    v_mov_b32_dpp v29, v36 row_ror:8 row_mask:0xf bank_mask:0x4
    v_mov_b32_dpp v30, v36 row_ror:12 row_mask:0xf bank_mask:0x1
    v_mov_b32_dpp v31, v36 row_ror:4 row_mask:0xf bank_mask:0x4
    v_mov_b32_dpp v28, v37 row_ror:4 row_mask:0xf bank_mask:0x2
    v_mov_b32_dpp v29, v37 row_ror:12 row_mask:0xf bank_mask:0x8
    v_mov_b32_dpp v30, v37 quad_perm:[0,1,2,3] row_mask:0xf bank_mask:0x2
    v_mov_b32_dpp v31, v37 row_ror:8 row_mask:0xf bank_mask:0x8
    s_cmp_gt_u32 s76, 13
    s_cbranch_scc1 L_bo_99
    s_waitcnt vmcnt(4)
L_bo_99:
    s_waitcnt vmcnt(5)
    buffer_load_dwordx4 v[252:255], v2, s[12:15], s57 offen nt
    s_add_u32 s57, s57, 4096
    v_mfma_f32_16x16x16_bf16 v[56:59], v[28:29], v[228:229], v[56:59]
    v_mfma_f32_16x16x16_bf16 v[60:63], v[28:29], v[230:231], v[60:63]
    s_cmp_gt_u32 s76, 14
    s_cbranch_scc1 L_bo_101
    s_waitcnt vmcnt(4)
L_bo_101:
    s_waitcnt vmcnt(5)
    buffer_load_dwordx4 v[64:67], v2, s[12:15], s57 offen nt
    s_add_u32 s57, s57, 4096
    v_mfma_f32_16x16x16_bf16 v[56:59], v[30:31], v[232:233], v[56:59]
    v_mfma_f32_16x16x16_bf16 v[60:63], v[30:31], v[234:235], v[60:63]
    v_mov_b32_dpp v32, v36 row_ror:8 row_mask:0xf bank_mask:0x1
    v_mov_b32_dpp v33, v36 quad_perm:[0,1,2,3] row_mask:0xf bank_mask:0x4
    v_mov_b32_dpp v34, v36 row_ror:4 row_mask:0xf bank_mask:0x1
    v_mov_b32_dpp v35, v36 row_ror:12 row_mask:0xf bank_mask:0x4
    v_mov_b32_dpp v32, v37 row_ror:12 row_mask:0xf bank_mask:0x2
    v_mov_b32_dpp v33, v37 row_ror:4 row_mask:0xf bank_mask:0x8
    v_mov_b32_dpp v34, v37 row_ror:8 row_mask:0xf bank_mask:0x2
    v_mov_b32_dpp v35, v37 quad_perm:[0,1,2,3] row_mask:0xf bank_mask:0x8
    s_cmp_gt_u32 s76, 15
    s_cbranch_scc1 L_bo_103
    s_waitcnt vmcnt(4)
L_bo_103:
    s_waitcnt vmcnt(5)
    buffer_load_dwordx4 v[68:71], v2, s[12:15], s57 offen nt
    s_add_u32 s57, s57, 4096
    v_mfma_f32_16x16x16_bf16 v[56:59], v[32:33], v[236:237], v[56:59]
    v_mfma_f32_16x16x16_bf16 v[60:63], v[32:33], v[238:239], v[60:63]
    s_cmp_gt_u32 s76, 16
    s_cbranch_scc1 L_bo_105
    s_waitcnt vmcnt(4)
L_bo_105:
    s_waitcnt vmcnt(5)
    buffer_load_dwordx4 v[72:75], v2, s[12:15], s57 offen nt
    s_add_u32 s57, s57, 4096
    v_mfma_f32_16x16x16_bf16 v[56:59], v[34:35], v[240:241], v[56:59]
    v_mfma_f32_16x16x16_bf16 v[60:63], v[34:35], v[242:243], v[60:63]
    v_mul_f32 v49, v15, v48
    v_cvt_pk_bf16_f32 v36, v49, 0
    v_cvt_pk_bf16_f32 v37, 0, v49
    s_nop 0
    v_mov_b32_dpp v28, v36 quad_perm:[0,1,2,3] row_mask:0xf bank_mask:0x1
    v_mov_b32_dpp v29, v36 row_ror:8 row_mask:0xf bank_mask:0x4
    v_mov_b32_dpp v30, v36 row_ror:12 row_mask:0xf bank_mask:0x1
    v_mov_b32_dpp v31, v36 row_ror:4 row_mask:0xf bank_mask:0x4
    v_mov_b32_dpp v28, v37 row_ror:4 row_mask:0xf bank_mask:0x2
    v_mov_b32_dpp v29, v37 row_ror:12 row_mask:0xf bank_mask:0x8
    v_mov_b32_dpp v30, v37 quad_perm:[0,1,2,3] row_mask:0xf bank_mask:0x2
    v_mov_b32_dpp v31, v37 row_ror:8 row_mask:0xf bank_mask:0x8
    s_cmp_gt_u32 s76, 17
    s_cbranch_scc1 L_bo_107
    s_waitcnt vmcnt(4)
L_bo_107:
    s_waitcnt vmcnt(5)
    buffer_load_dwordx4 v[76:79], v2, s[12:15], s57 offen nt
    s_add_u32 s57, s57, 4096
    v_mfma_f32_16x16x16_bf16 v[56:59], v[28:29], v[244:245], v[56:59]
    v_mfma_f32_16x16x16_bf16 v[60:63], v[28:29], v[246:247], v[60:63]
    s_cmp_gt_u32 s76, 18
    s_cbranch_scc1 L_bo_109
    s_waitcnt vmcnt(4)
L_bo_109:
    s_waitcnt vmcnt(5)
    buffer_load_dwordx4 v[80:83], v2, s[12:15], s57 offen nt
    s_add_u32 s57, s57, 4096
    v_mfma_f32_16x16x16_bf16 v[56:59], v[30:31], v[248:249], v[56:59]
    v_mfma_f32_16x16x16_bf16 v[60:63], v[30:31], v[250:251], v[60:63]
    v_mov_b32_dpp v32, v36 row_ror:8 row_mask:0xf bank_mask:0x1
    v_mov_b32_dpp v33, v36 quad_perm:[0,1,2,3] row_mask:0xf bank_mask:0x4
    v_mov_b32_dpp v34, v36 row_ror:4 row_mask:0xf bank_mask:0x1
    v_mov_b32_dpp v35, v36 row_ror:12 row_mask:0xf bank_mask:0x4
    v_mov_b32_dpp v32, v37 row_ror:12 row_mask:0xf bank_mask:0x2
    v_mov_b32_dpp v33, v37 row_ror:4 row_mask:0xf bank_mask:0x8
    v_mov_b32_dpp v34, v37 row_ror:8 row_mask:0xf bank_mask:0x2
    v_mov_b32_dpp v35, v37 quad_perm:[0,1,2,3] row_mask:0xf bank_mask:0x8
    s_cmp_gt_u32 s76, 19
    s_cbranch_scc1 L_bo_111
    s_waitcnt vmcnt(4)
L_bo_111:
    s_waitcnt vmcnt(5)
    buffer_load_dwordx4 v[84:87], v2, s[12:15], s57 offen nt
    s_add_u32 s57, s57, 4096
    v_mfma_f32_16x16x16_bf16 v[56:59], v[32:33], v[252:253], v[56:59]
    v_mfma_f32_16x16x16_bf16 v[60:63], v[32:33], v[254:255], v[60:63]
    s_cmp_gt_u32 s76, 20
    s_cbranch_scc1 L_bo_113
    s_waitcnt vmcnt(4)
L_bo_113:
    s_waitcnt vmcnt(5)
    buffer_load_dwordx4 v[88:91], v2, s[12:15], s57 offen nt
    s_add_u32 s57, s57, 4096
    v_mfma_f32_16x16x16_bf16 v[56:59], v[34:35], v[64:65], v[56:59]
    v_mfma_f32_16x16x16_bf16 v[60:63], v[34:35], v[66:67], v[60:63]
    v_mul_f32 v49, v16, v48
    v_cvt_pk_bf16_f32 v36, v49, 0
    v_cvt_pk_bf16_f32 v37, 0, v49
    s_nop 0
    v_mov_b32_dpp v28, v36 quad_perm:[0,1,2,3] row_mask:0xf bank_mask:0x1
    v_mov_b32_dpp v29, v36 row_ror:8 row_mask:0xf bank_mask:0x4
    v_mov_b32_dpp v30, v36 row_ror:12 row_mask:0xf bank_mask:0x1
    v_mov_b32_dpp v31, v36 row_ror:4 row_mask:0xf bank_mask:0x4
    v_mov_b32_dpp v28, v37 row_ror:4 row_mask:0xf bank_mask:0x2
    v_mov_b32_dpp v29, v37 row_ror:12 row_mask:0xf bank_mask:0x8
    v_mov_b32_dpp v30, v37 quad_perm:[0,1,2,3] row_mask:0xf bank_mask:0x2
    v_mov_b32_dpp v31, v37 row_ror:8 row_mask:0xf bank_mask:0x8
    s_cmp_gt_u32 s76, 21
    s_cbranch_scc1 L_bo_115
    s_waitcnt vmcnt(4)
L_bo_115:
    s_waitcnt vmcnt(5)
    buffer_load_dwordx4 v[92:95], v2, s[12:15], s57 offen nt
    s_add_u32 s57, s57, 4096
    v_mfma_f32_16x16x16_bf16 v[56:59], v[28:29], v[68:69], v[56:59]
    v_mfma_f32_16x16x16_bf16 v[60:63], v[28:29], v[70:71], v[60:63]
    s_cmp_gt_u32 s76, 22
    s_cbranch_scc1 L_bo_117
    s_waitcnt vmcnt(4)
L_bo_117:
    s_waitcnt vmcnt(5)
    buffer_load_dwordx4 v[96:99], v2, s[12:15], s57 offen nt
    s_add_u32 s57, s57, 4096
    s_mov_b64 exec, 1
    ds_add_u32 v25, v26 offset:16
    s_mov_b64 exec, -1
    v_mfma_f32_16x16x16_bf16 v[56:59], v[30:31], v[72:73], v[56:59]
    v_mfma_f32_16x16x16_bf16 v[60:63], v[30:31], v[74:75], v[60:63]
    v_mov_b32_dpp v32, v36 row_ror:8 row_mask:0xf bank_mask:0x1
    v_mov_b32_dpp v33, v36 quad_perm:[0,1,2,3] row_mask:0xf bank_mask:0x4
    v_mov_b32_dpp v34, v36 row_ror:4 row_mask:0xf bank_mask:0x1
    v_mov_b32_dpp v35, v36 row_ror:12 row_mask:0xf bank_mask:0x4
    v_mov_b32_dpp v32, v37 row_ror:12 row_mask:0xf bank_mask:0x2
    v_mov_b32_dpp v33, v37 row_ror:4 row_mask:0xf bank_mask:0x8
    v_mov_b32_dpp v34, v37 row_ror:8 row_mask:0xf bank_mask:0x2
    v_mov_b32_dpp v35, v37 quad_perm:[0,1,2,3] row_mask:0xf bank_mask:0x8
    s_cmp_gt_u32 s76, 23
    s_cbranch_scc1 L_bo_119
    s_waitcnt vmcnt(4)
L_bo_119:
    s_waitcnt vmcnt(5)
    buffer_load_dwordx4 v[100:103], v2, s[12:15], s57 offen nt
    s_add_u32 s57, s57, 4096
    v_mfma_f32_16x16x16_bf16 v[56:59], v[32:33], v[76:77], v[56:59]
    v_mfma_f32_16x16x16_bf16 v[60:63], v[32:33], v[78:79], v[60:63]
    s_cmp_gt_u32 s76, 24
    s_cbranch_scc1 L_bo_121
    s_waitcnt vmcnt(4)
L_bo_121:
    s_waitcnt vmcnt(5)
    buffer_load_dwordx4 v[104:107], v2, s[12:15], s57 offen nt
    s_add_u32 s57, s57, 4096
    v_mfma_f32_16x16x16_bf16 v[56:59], v[34:35], v[80:81], v[56:59]
    v_mfma_f32_16x16x16_bf16 v[60:63], v[34:35], v[82:83], v[60:63]
    v_mul_f32 v49, v17, v48
    v_cvt_pk_bf16_f32 v36, v49, 0
    v_cvt_pk_bf16_f32 v37, 0, v49
    s_nop 0
    v_mov_b32_dpp v28, v36 quad_perm:[0,1,2,3] row_mask:0xf bank_mask:0x1
    v_mov_b32_dpp v29, v36 row_ror:8 row_mask:0xf bank_mask:0x4
    v_mov_b32_dpp v30, v36 row_ror:12 row_mask:0xf bank_mask:0x1
    v_mov_b32_dpp v31, v36 row_ror:4 row_mask:0xf bank_mask:0x4
    v_mov_b32_dpp v28, v37 row_ror:4 row_mask:0xf bank_mask:0x2
    v_mov_b32_dpp v29, v37 row_ror:12 row_mask:0xf bank_mask:0x8
    v_mov_b32_dpp v30, v37 quad_perm:[0,1,2,3] row_mask:0xf bank_mask:0x2
    v_mov_b32_dpp v31, v37 row_ror:8 row_mask:0xf bank_mask:0x8
    s_cmp_gt_u32 s76, 25
    s_cbranch_scc1 L_bo_123
    s_waitcnt vmcnt(4)
L_bo_123:
    s_waitcnt vmcnt(5)
    buffer_load_dwordx4 v[108:111], v2, s[12:15], s57 offen nt
    s_add_u32 s57, s57, 4096
    v_mfma_f32_16x16x16_bf16 v[56:59], v[28:29], v[84:85], v[56:59]
    v_mfma_f32_16x16x16_bf16 v[60:63], v[28:29], v[86:87], v[60:63]
    s_cmp_gt_u32 s76, 26
    s_cbranch_scc1 L_bo_125
    s_waitcnt vmcnt(4)
L_bo_125:
    s_waitcnt vmcnt(5)
    buffer_load_dwordx4 v[112:115], v2, s[12:15], s57 offen nt
    s_add_u32 s57, s57, 4096
    v_mfma_f32_16x16x16_bf16 v[56:59], v[30:31], v[88:89], v[56:59]
    v_mfma_f32_16x16x16_bf16 v[60:63], v[30:31], v[90:91], v[60:63]
    v_mov_b32_dpp v32, v36 row_ror:8 row_mask:0xf bank_mask:0x1
    v_mov_b32_dpp v33, v36 quad_perm:[0,1,2,3] row_mask:0xf bank_mask:0x4
    v_mov_b32_dpp v34, v36 row_ror:4 row_mask:0xf bank_mask:0x1
    v_mov_b32_dpp v35, v36 row_ror:12 row_mask:0xf bank_mask:0x4
    v_mov_b32_dpp v32, v37 row_ror:12 row_mask:0xf bank_mask:0x2
    v_mov_b32_dpp v33, v37 row_ror:4 row_mask:0xf bank_mask:0x8
    v_mov_b32_dpp v34, v37 row_ror:8 row_mask:0xf bank_mask:0x2
    v_mov_b32_dpp v35, v37 quad_perm:[0,1,2,3] row_mask:0xf bank_mask:0x8
    s_cmp_gt_u32 s76, 27
    s_cbranch_scc1 L_bo_127
    s_waitcnt vmcnt(4)
L_bo_127:
    s_waitcnt vmcnt(5)
    buffer_load_dwordx4 v[116:119], v2, s[12:15], s57 offen nt
    s_add_u32 s57, s57, 4096
    v_mfma_f32_16x16x16_bf16 v[56:59], v[32:33], v[92:93], v[56:59]
    v_mfma_f32_16x16x16_bf16 v[60:63], v[32:33], v[94:95], v[60:63]
    s_cmp_gt_u32 s76, 28
    s_cbranch_scc1 L_bo_129
    s_waitcnt vmcnt(4)
L_bo_129:
    s_waitcnt vmcnt(5)
    buffer_load_dwordx4 v[120:123], v2, s[12:15], s57 offen nt
    s_add_u32 s57, s57, 4096
    v_mfma_f32_16x16x16_bf16 v[56:59], v[34:35], v[96:97], v[56:59]
    v_mfma_f32_16x16x16_bf16 v[60:63], v[34:35], v[98:99], v[60:63]
    v_mul_f32 v49, v18, v48
    v_cvt_pk_bf16_f32 v36, v49, 0
    v_cvt_pk_bf16_f32 v37, 0, v49
    s_nop 0
    v_mov_b32_dpp v28, v36 quad_perm:[0,1,2,3] row_mask:0xf bank_mask:0x1
    v_mov_b32_dpp v29, v36 row_ror:8 row_mask:0xf bank_mask:0x4
    v_mov_b32_dpp v30, v36 row_ror:12 row_mask:0xf bank_mask:0x1
    v_mov_b32_dpp v31, v36 row_ror:4 row_mask:0xf bank_mask:0x4
    v_mov_b32_dpp v28, v37 row_ror:4 row_mask:0xf bank_mask:0x2
    v_mov_b32_dpp v29, v37 row_ror:12 row_mask:0xf bank_mask:0x8
    v_mov_b32_dpp v30, v37 quad_perm:[0,1,2,3] row_mask:0xf bank_mask:0x2
    v_mov_b32_dpp v31, v37 row_ror:8 row_mask:0xf bank_mask:0x8
    s_cmp_gt_u32 s76, 29
    s_cbranch_scc1 L_bo_131
    s_waitcnt vmcnt(4)
L_bo_131:
    s_waitcnt vmcnt(5)
    buffer_load_dwordx4 v[124:127], v2, s[12:15], s57 offen nt
    s_add_u32 s57, s57, 4096
    v_mfma_f32_16x16x16_bf16 v[56:59], v[28:29], v[100:101], v[56:59]
    v_mfma_f32_16x16x16_bf16 v[60:63], v[28:29], v[102:103], v[60:63]
    s_cmp_gt_u32 s76, 30
    s_cbranch_scc1 L_bo_133
    s_waitcnt vmcnt(4)
L_bo_133:
    s_waitcnt vmcnt(5)
    buffer_load_dwordx4 v[128:131], v2, s[12:15], s57 offen nt
    s_add_u32 s57, s57, 4096
    v_mfma_f32_16x16x16_bf16 v[56:59], v[30:31], v[104:105], v[56:59]
    v_mfma_f32_16x16x16_bf16 v[60:63], v[30:31], v[106:107], v[60:63]
    v_mov_b32_dpp v32, v36 row_ror:8 row_mask:0xf bank_mask:0x1
    v_mov_b32_dpp v33, v36 quad_perm:[0,1,2,3] row_mask:0xf bank_mask:0x4
    v_mov_b32_dpp v34, v36 row_ror:4 row_mask:0xf bank_mask:0x1
    v_mov_b32_dpp v35, v36 row_ror:12 row_mask:0xf bank_mask:0x4
    v_mov_b32_dpp v32, v37 row_ror:12 row_mask:0xf bank_mask:0x2
    v_mov_b32_dpp v33, v37 row_ror:4 row_mask:0xf bank_mask:0x8
    v_mov_b32_dpp v34, v37 row_ror:8 row_mask:0xf bank_mask:0x2
    v_mov_b32_dpp v35, v37 quad_perm:[0,1,2,3] row_mask:0xf bank_mask:0x8
    s_cmp_gt_u32 s76, 31
    s_cbranch_scc1 L_bo_135
    s_waitcnt vmcnt(4)
L_bo_135:
    s_waitcnt vmcnt(5)
    buffer_load_dwordx4 v[132:135], v2, s[12:15], s57 offen nt
    s_add_u32 s57, s57, 4096
    v_mfma_f32_16x16x16_bf16 v[56:59], v[32:33], v[108:109], v[56:59]
    v_mfma_f32_16x16x16_bf16 v[60:63], v[32:33], v[110:111], v[60:63]
    s_waitcnt vmcnt(4)
    buffer_load_dwordx4 v[136:139], v2, s[12:15], s57 offen nt
    s_add_u32 s57, s57, 4096
    v_mfma_f32_16x16x16_bf16 v[56:59], v[34:35], v[112:113], v[56:59]
    v_mfma_f32_16x16x16_bf16 v[60:63], v[34:35], v[114:115], v[60:63]
    v_mul_f32 v49, v19, v48
    v_cvt_pk_bf16_f32 v36, v49, 0
    v_cvt_pk_bf16_f32 v37, 0, v49
    s_nop 0
    v_mov_b32_dpp v28, v36 quad_perm:[0,1,2,3] row_mask:0xf bank_mask:0x1
    v_mov_b32_dpp v29, v36 row_ror:8 row_mask:0xf bank_mask:0x4
    v_mov_b32_dpp v30, v36 row_ror:12 row_mask:0xf bank_mask:0x1
    v_mov_b32_dpp v31, v36 row_ror:4 row_mask:0xf bank_mask:0x4
    v_mov_b32_dpp v28, v37 row_ror:4 row_mask:0xf bank_mask:0x2
    v_mov_b32_dpp v29, v37 row_ror:12 row_mask:0xf bank_mask:0x8
    v_mov_b32_dpp v30, v37 quad_perm:[0,1,2,3] row_mask:0xf bank_mask:0x2
    v_mov_b32_dpp v31, v37 row_ror:8 row_mask:0xf bank_mask:0x8
    v_mfma_f32_16x16x16_bf16 v[56:59], v[28:29], v[116:117], v[56:59]
    v_mfma_f32_16x16x16_bf16 v[60:63], v[28:29], v[118:119], v[60:63]
    s_waitcnt vmcnt(4)
    buffer_load_dwordx4 v[140:143], v2, s[12:15], s57 offen nt
    s_add_u32 s57, s57, 4096
    v_mfma_f32_16x16x16_bf16 v[56:59], v[30:31], v[120:121], v[56:59]
    v_mfma_f32_16x16x16_bf16 v[60:63], v[30:31], v[122:123], v[60:63]
    v_mov_b32_dpp v32, v36 row_ror:8 row_mask:0xf bank_mask:0x1
    v_mov_b32_dpp v33, v36 quad_perm:[0,1,2,3] row_mask:0xf bank_mask:0x4
    v_mov_b32_dpp v34, v36 row_ror:4 row_mask:0xf bank_mask:0x1
    v_mov_b32_dpp v35, v36 row_ror:12 row_mask:0xf bank_mask:0x4
    v_mov_b32_dpp v32, v37 row_ror:12 row_mask:0xf bank_mask:0x2
    v_mov_b32_dpp v33, v37 row_ror:4 row_mask:0xf bank_mask:0x8
    v_mov_b32_dpp v34, v37 row_ror:8 row_mask:0xf bank_mask:0x2
    v_mov_b32_dpp v35, v37 quad_perm:[0,1,2,3] row_mask:0xf bank_mask:0x8
    s_waitcnt vmcnt(4)
    buffer_load_dwordx4 v[144:147], v2, s[12:15], s57 offen nt
    s_add_u32 s57, s57, 4096
    v_mfma_f32_16x16x16_bf16 v[56:59], v[32:33], v[124:125], v[56:59]
    v_mfma_f32_16x16x16_bf16 v[60:63], v[32:33], v[126:127], v[60:63]
    s_waitcnt vmcnt(4)
    buffer_load_dwordx4 v[148:151], v2, s[12:15], s57 offen nt
    s_add_u32 s57, s57, 4096
    v_mfma_f32_16x16x16_bf16 v[56:59], v[34:35], v[128:129], v[56:59]
    v_mfma_f32_16x16x16_bf16 v[60:63], v[34:35], v[130:131], v[60:63]
    v_mul_f32 v49, v20, v48
    v_cvt_pk_bf16_f32 v36, v49, 0
    v_cvt_pk_bf16_f32 v37, 0, v49
    s_nop 0
    v_mov_b32_dpp v28, v36 quad_perm:[0,1,2,3] row_mask:0xf bank_mask:0x1
    v_mov_b32_dpp v29, v36 row_ror:8 row_mask:0xf bank_mask:0x4
    v_mov_b32_dpp v30, v36 row_ror:12 row_mask:0xf bank_mask:0x1
    v_mov_b32_dpp v31, v36 row_ror:4 row_mask:0xf bank_mask:0x4
    v_mov_b32_dpp v28, v37 row_ror:4 row_mask:0xf bank_mask:0x2
    v_mov_b32_dpp v29, v37 row_ror:12 row_mask:0xf bank_mask:0x8
    v_mov_b32_dpp v30, v37 quad_perm:[0,1,2,3] row_mask:0xf bank_mask:0x2
    v_mov_b32_dpp v31, v37 row_ror:8 row_mask:0xf bank_mask:0x8
    buffer_load_dwordx4 v[152:155], v2, s[12:15], s57 offen nt
    s_add_u32 s57, s57, 4096
    buffer_load_dwordx4 v[156:159], v2, s[12:15], s57 offen nt
    s_add_u32 s57, s57, 4096
    buffer_load_dwordx4 v[160:163], v2, s[12:15], s57 offen nt
    s_add_u32 s57, s57, 4096
    buffer_load_dwordx4 v[164:167], v2, s[12:15], s57 offen nt
    s_add_u32 s57, s57, 4096
    buffer_load_dwordx4 v[168:171], v2, s[12:15], s57 offen nt
    s_add_u32 s57, s57, 4096
    buffer_load_dwordx4 v[172:175], v2, s[12:15], s57 offen nt
    s_add_u32 s57, s57, 4096
    buffer_load_dwordx4 v[176:179], v2, s[12:15], s57 offen nt
    s_add_u32 s57, s57, 4096
    s_waitcnt vmcnt(11)
    buffer_load_dwordx4 v[180:183], v2, s[12:15], s57 offen nt
    s_add_u32 s57, s57, 4096
    v_mfma_f32_16x16x16_bf16 v[56:59], v[28:29], v[132:133], v[56:59]
    v_mfma_f32_16x16x16_bf16 v[60:63], v[28:29], v[134:135], v[60:63]
    s_waitcnt vmcnt(11)
    buffer_load_dwordx4 v[184:187], v2, s[12:15], s57 offen nt
    s_add_u32 s57, s57, 4096
    v_mfma_f32_16x16x16_bf16 v[56:59], v[30:31], v[136:137], v[56:59]
    v_mfma_f32_16x16x16_bf16 v[60:63], v[30:31], v[138:139], v[60:63]
    v_mov_b32_dpp v32, v36 row_ror:8 row_mask:0xf bank_mask:0x1
    v_mov_b32_dpp v33, v36 quad_perm:[0,1,2,3] row_mask:0xf bank_mask:0x4
    v_mov_b32_dpp v34, v36 row_ror:4 row_mask:0xf bank_mask:0x1
    v_mov_b32_dpp v35, v36 row_ror:12 row_mask:0xf bank_mask:0x4
    v_mov_b32_dpp v32, v37 row_ror:12 row_mask:0xf bank_mask:0x2
    v_mov_b32_dpp v33, v37 row_ror:4 row_mask:0xf bank_mask:0x8
    v_mov_b32_dpp v34, v37 row_ror:8 row_mask:0xf bank_mask:0x2
    v_mov_b32_dpp v35, v37 quad_perm:[0,1,2,3] row_mask:0xf bank_mask:0x8
    s_waitcnt vmcnt(11)
    buffer_load_dwordx4 v[188:191], v2, s[12:15], s57 offen nt
    s_add_u32 s57, s57, 4096
    v_mfma_f32_16x16x16_bf16 v[56:59], v[32:33], v[140:141], v[56:59]
    v_mfma_f32_16x16x16_bf16 v[60:63], v[32:33], v[142:143], v[60:63]
    s_waitcnt vmcnt(11)
    buffer_load_dwordx4 v[192:195], v2, s[12:15], s57 offen nt
    s_add_u32 s57, s57, 4096
    v_mfma_f32_16x16x16_bf16 v[56:59], v[34:35], v[144:145], v[56:59]
    v_mfma_f32_16x16x16_bf16 v[60:63], v[34:35], v[146:147], v[60:63]
    v_mul_f32 v49, v21, v48
    v_cvt_pk_bf16_f32 v36, v49, 0
    v_cvt_pk_bf16_f32 v37, 0, v49
    s_nop 0
    v_mov_b32_dpp v28, v36 quad_perm:[0,1,2,3] row_mask:0xf bank_mask:0x1
    v_mov_b32_dpp v29, v36 row_ror:8 row_mask:0xf bank_mask:0x4
    v_mov_b32_dpp v30, v36 row_ror:12 row_mask:0xf bank_mask:0x1
    v_mov_b32_dpp v31, v36 row_ror:4 row_mask:0xf bank_mask:0x4
    v_mov_b32_dpp v28, v37 row_ror:4 row_mask:0xf bank_mask:0x2
    v_mov_b32_dpp v29, v37 row_ror:12 row_mask:0xf bank_mask:0x8
    v_mov_b32_dpp v30, v37 quad_perm:[0,1,2,3] row_mask:0xf bank_mask:0x2
    v_mov_b32_dpp v31, v37 row_ror:8 row_mask:0xf bank_mask:0x8
    s_waitcnt vmcnt(11)
    buffer_load_dwordx4 v[196:199], v2, s[12:15], s57 offen nt
    s_mov_b64 exec, 1
    ds_add_u32 v25, v26 offset:20
    s_mov_b64 exec, -1
    v_mfma_f32_16x16x16_bf16 v[56:59], v[28:29], v[148:149], v[56:59]
    v_mfma_f32_16x16x16_bf16 v[60:63], v[28:29], v[150:151], v[60:63]
    s_waitcnt vmcnt(11)
    v_mfma_f32_16x16x16_bf16 v[56:59], v[30:31], v[152:153], v[56:59]
    v_mfma_f32_16x16x16_bf16 v[60:63], v[30:31], v[154:155], v[60:63]
    v_mov_b32_dpp v32, v36 row_ror:8 row_mask:0xf bank_mask:0x1
    v_mov_b32_dpp v33, v36 quad_perm:[0,1,2,3] row_mask:0xf bank_mask:0x4
    v_mov_b32_dpp v34, v36 row_ror:4 row_mask:0xf bank_mask:0x1
    v_mov_b32_dpp v35, v36 row_ror:12 row_mask:0xf bank_mask:0x4
    v_mov_b32_dpp v32, v37 row_ror:12 row_mask:0xf bank_mask:0x2
    v_mov_b32_dpp v33, v37 row_ror:4 row_mask:0xf bank_mask:0x8
    v_mov_b32_dpp v34, v37 row_ror:8 row_mask:0xf bank_mask:0x2
    v_mov_b32_dpp v35, v37 quad_perm:[0,1,2,3] row_mask:0xf bank_mask:0x8
    s_waitcnt vmcnt(10)
    v_mfma_f32_16x16x16_bf16 v[56:59], v[32:33], v[156:157], v[56:59]
    v_mfma_f32_16x16x16_bf16 v[60:63], v[32:33], v[158:159], v[60:63]
    s_waitcnt vmcnt(9)
    v_mfma_f32_16x16x16_bf16 v[56:59], v[34:35], v[160:161], v[56:59]
    v_mfma_f32_16x16x16_bf16 v[60:63], v[34:35], v[162:163], v[60:63]
    v_mul_f32 v49, v22, v48
    v_cvt_pk_bf16_f32 v36, v49, 0
    v_cvt_pk_bf16_f32 v37, 0, v49
    s_nop 0
    v_mov_b32_dpp v28, v36 quad_perm:[0,1,2,3] row_mask:0xf bank_mask:0x1
    v_mov_b32_dpp v29, v36 row_ror:8 row_mask:0xf bank_mask:0x4
    v_mov_b32_dpp v30, v36 row_ror:12 row_mask:0xf bank_mask:0x1
    v_mov_b32_dpp v31, v36 row_ror:4 row_mask:0xf bank_mask:0x4
    v_mov_b32_dpp v28, v37 row_ror:4 row_mask:0xf bank_mask:0x2
    v_mov_b32_dpp v29, v37 row_ror:12 row_mask:0xf bank_mask:0x8
    v_mov_b32_dpp v30, v37 quad_perm:[0,1,2,3] row_mask:0xf bank_mask:0x2
    v_mov_b32_dpp v31, v37 row_ror:8 row_mask:0xf bank_mask:0x8
    s_waitcnt vmcnt(8)
    v_mfma_f32_16x16x16_bf16 v[56:59], v[28:29], v[164:165], v[56:59]
    v_mfma_f32_16x16x16_bf16 v[60:63], v[28:29], v[166:167], v[60:63]
    s_waitcnt vmcnt(7)
    v_mfma_f32_16x16x16_bf16 v[56:59], v[30:31], v[168:169], v[56:59]
    v_mfma_f32_16x16x16_bf16 v[60:63], v[30:31], v[170:171], v[60:63]
    v_mov_b32_dpp v32, v36 row_ror:8 row_mask:0xf bank_mask:0x1
    v_mov_b32_dpp v33, v36 quad_perm:[0,1,2,3] row_mask:0xf bank_mask:0x4
    v_mov_b32_dpp v34, v36 row_ror:4 row_mask:0xf bank_mask:0x1
    v_mov_b32_dpp v35, v36 row_ror:12 row_mask:0xf bank_mask:0x4
    v_mov_b32_dpp v32, v37 row_ror:12 row_mask:0xf bank_mask:0x2
    v_mov_b32_dpp v33, v37 row_ror:4 row_mask:0xf bank_mask:0x8
    v_mov_b32_dpp v34, v37 row_ror:8 row_mask:0xf bank_mask:0x2
    v_mov_b32_dpp v35, v37 quad_perm:[0,1,2,3] row_mask:0xf bank_mask:0x8
    s_waitcnt vmcnt(6)
    v_mfma_f32_16x16x16_bf16 v[56:59], v[32:33], v[172:173], v[56:59]
    v_mfma_f32_16x16x16_bf16 v[60:63], v[32:33], v[174:175], v[60:63]
    s_waitcnt vmcnt(5)
    v_mfma_f32_16x16x16_bf16 v[56:59], v[34:35], v[176:177], v[56:59]
    v_mfma_f32_16x16x16_bf16 v[60:63], v[34:35], v[178:179], v[60:63]
    v_mul_f32 v49, v23, v48
    v_cvt_pk_bf16_f32 v36, v49, 0
    v_cvt_pk_bf16_f32 v37, 0, v49
    s_nop 0
    v_mov_b32_dpp v28, v36 quad_perm:[0,1,2,3] row_mask:0xf bank_mask:0x1
    v_mov_b32_dpp v29, v36 row_ror:8 row_mask:0xf bank_mask:0x4
    v_mov_b32_dpp v30, v36 row_ror:12 row_mask:0xf bank_mask:0x1
    v_mov_b32_dpp v31, v36 row_ror:4 row_mask:0xf bank_mask:0x4
    v_mov_b32_dpp v28, v37 row_ror:4 row_mask:0xf bank_mask:0x2
    v_mov_b32_dpp v29, v37 row_ror:12 row_mask:0xf bank_mask:0x8
    v_mov_b32_dpp v30, v37 quad_perm:[0,1,2,3] row_mask:0xf bank_mask:0x2
    v_mov_b32_dpp v31, v37 row_ror:8 row_mask:0xf bank_mask:0x8
    s_waitcnt vmcnt(4)
    v_mfma_f32_16x16x16_bf16 v[56:59], v[28:29], v[180:181], v[56:59]
    v_mfma_f32_16x16x16_bf16 v[60:63], v[28:29], v[182:183], v[60:63]
    s_waitcnt vmcnt(3)
    v_mfma_f32_16x16x16_bf16 v[56:59], v[30:31], v[184:185], v[56:59]
    v_mfma_f32_16x16x16_bf16 v[60:63], v[30:31], v[186:187], v[60:63]
    v_mov_b32_dpp v32, v36 row_ror:8 row_mask:0xf bank_mask:0x1
    v_mov_b32_dpp v33, v36 quad_perm:[0,1,2,3] row_mask:0xf bank_mask:0x4
    v_mov_b32_dpp v34, v36 row_ror:4 row_mask:0xf bank_mask:0x1
    v_mov_b32_dpp v35, v36 row_ror:12 row_mask:0xf bank_mask:0x4
    v_mov_b32_dpp v32, v37 row_ror:12 row_mask:0xf bank_mask:0x2
    v_mov_b32_dpp v33, v37 row_ror:4 row_mask:0xf bank_mask:0x8
    v_mov_b32_dpp v34, v37 row_ror:8 row_mask:0xf bank_mask:0x2
    v_mov_b32_dpp v35, v37 quad_perm:[0,1,2,3] row_mask:0xf bank_mask:0x8
    s_waitcnt vmcnt(2)
    v_mfma_f32_16x16x16_bf16 v[56:59], v[32:33], v[188:189], v[56:59]
    v_mfma_f32_16x16x16_bf16 v[60:63], v[32:33], v[190:191], v[60:63]
    s_waitcnt vmcnt(1)
    v_mfma_f32_16x16x16_bf16 v[56:59], v[34:35], v[192:193], v[56:59]
    v_mfma_f32_16x16x16_bf16 v[60:63], v[34:35], v[194:195], v[60:63]
    v_mul_f32 v49, v24, v48
    v_cvt_pk_bf16_f32 v36, v49, 0
    v_cvt_pk_bf16_f32 v37, 0, v49
    s_nop 0
    v_mov_b32_dpp v28, v36 quad_perm:[0,1,2,3] row_mask:0xf bank_mask:0x1
    v_mov_b32_dpp v29, v36 row_ror:8 row_mask:0xf bank_mask:0x4
    s_nop 0
    v_mov_b32_dpp v28, v37 row_ror:4 row_mask:0xf bank_mask:0x2
    v_mov_b32_dpp v29, v37 row_ror:12 row_mask:0xf bank_mask:0x8
    s_waitcnt vmcnt(0)
    s_nop 0
    v_mfma_f32_16x16x16_bf16 v[56:59], v[28:29], v[196:197], v[56:59]
    v_mfma_f32_16x16x16_bf16 v[60:63], v[28:29], v[198:199], v[60:63]
    s_cmp_ge_u32 s3, 2
    s_nop 5
    ds_write_b128 v3, v[56:59]
    ds_write_b128 v3, v[60:63] offset:1024
    s_mov_b64 exec, 1
    ds_add_u32 v25, v26 offset:28
    s_mov_b64 exec, -1
    s_branch L_stail
L_stream_2:
    s_mov_b32 s57, s56
    s_waitcnt lgkmcnt(0)
    buffer_load_dwordx4 v[64:67], v1, s[8:11], s56 offen nt
    s_add_u32 s56, s56, 4096
    buffer_load_dwordx4 v[68:71], v1, s[8:11], s56 offen nt
    s_add_u32 s56, s56, 4096
    buffer_load_dwordx4 v[72:75], v1, s[8:11], s56 offen nt
    s_add_u32 s56, s56, 4096
    buffer_load_dwordx4 v[76:79], v1, s[8:11], s56 offen nt
    s_add_u32 s56, s56, 4096
    buffer_load_dwordx4 v[80:83], v1, s[8:11], s56 offen nt
    s_add_u32 s56, s56, 4096
    v_mov_b32 v25, 144000
    v_mov_b32 v26, 1
    s_mov_b32 s58, 0x3db504f3
    s_mov_b32 s59, 0x3fb8aa3b
    s_mov_b32 s60, 0xffff0000
    v_and_b32 v3, 3, v0
    v_lshlrev_b32 v3, 8, v3
    v_bfe_u32 v4, v0, 2, 2
    v_lshl_add_u32 v3, v4, 4, v3
    v_lshrrev_b32 v4, 4, v0
    v_lshl_add_u32 v3, v4, 6, v3
    v_add_u32 v3, 140288, v3
    s_barrier
    s_waitcnt vmcnt(4)
    buffer_load_dwordx4 v[84:87], v1, s[8:11], s56 offen nt
    s_add_u32 s56, s56, 4096
    s_waitcnt vmcnt(4)
    buffer_load_dwordx4 v[88:91], v1, s[8:11], s56 offen nt
    s_add_u32 s56, s56, 4096
    s_waitcnt vmcnt(4)
    buffer_load_dwordx4 v[92:95], v1, s[8:11], s56 offen nt
    s_add_u32 s56, s56, 4096
    s_waitcnt vmcnt(4)
    buffer_load_dwordx4 v[96:99], v1, s[8:11], s56 offen nt
    s_add_u32 s56, s56, 4096
    s_waitcnt vmcnt(4)
    buffer_load_dwordx4 v[100:103], v1, s[8:11], s56 offen nt
    s_add_u32 s56, s56, 4096
    s_waitcnt vmcnt(4)
    buffer_load_dwordx4 v[104:107], v1, s[8:11], s56 offen nt
    s_add_u32 s56, s56, 4096
    s_waitcnt vmcnt(4)
    buffer_load_dwordx4 v[108:111], v1, s[8:11], s56 offen nt
    s_add_u32 s56, s56, 4096
    s_waitcnt vmcnt(4)
    buffer_load_dwordx4 v[112:115], v1, s[8:11], s56 offen nt
    s_add_u32 s56, s56, 4096
    s_waitcnt vmcnt(4)
    buffer_load_dwordx4 v[116:119], v1, s[8:11], s56 offen nt
    s_add_u32 s56, s56, 4096
    s_waitcnt vmcnt(4)
    buffer_load_dwordx4 v[120:123], v1, s[8:11], s56 offen nt
    s_add_u32 s56, s56, 4096
    s_waitcnt vmcnt(4)
    buffer_load_dwordx4 v[124:127], v1, s[8:11], s56 offen nt
    s_add_u32 s56, s56, 4096
    s_waitcnt vmcnt(4)
    buffer_load_dwordx4 v[128:131], v1, s[8:11], s56 offen nt
    s_add_u32 s56, s56, 4096
    s_waitcnt vmcnt(4)
    buffer_load_dwordx4 v[132:135], v1, s[8:11], s56 offen nt
    s_add_u32 s56, s56, 4096
    s_waitcnt vmcnt(4)
    buffer_load_dwordx4 v[136:139], v1, s[8:11], s56 offen nt
    s_add_u32 s56, s56, 4096
    s_mov_b64 exec, 1
    ds_add_u32 v25, v26 offset:12
    s_mov_b64 exec, -1
    s_waitcnt vmcnt(4)
    buffer_load_dwordx4 v[140:143], v1, s[8:11], s56 offen nt
    s_add_u32 s56, s56, 4096
    s_waitcnt vmcnt(4)
    buffer_load_dwordx4 v[144:147], v1, s[8:11], s56 offen nt
    s_add_u32 s56, s56, 4096
    s_waitcnt vmcnt(4)
    buffer_load_dwordx4 v[148:151], v1, s[8:11], s56 offen nt
    s_add_u32 s56, s56, 4096
    s_waitcnt vmcnt(4)
    buffer_load_dwordx4 v[152:155], v1, s[8:11], s56 offen nt
    s_add_u32 s56, s56, 4096
    s_waitcnt vmcnt(4)
    buffer_load_dwordx4 v[156:159], v1, s[8:11], s56 offen nt
    s_add_u32 s56, s56, 4096
    s_waitcnt vmcnt(4)
    buffer_load_dwordx4 v[160:163], v1, s[8:11], s56 offen nt
    s_add_u32 s56, s56, 4096
    s_waitcnt vmcnt(4)
    buffer_load_dwordx4 v[164:167], v1, s[8:11], s56 offen nt
    s_add_u32 s56, s56, 4096
    s_waitcnt vmcnt(4)
    buffer_load_dwordx4 v[168:171], v1, s[8:11], s56 offen nt
    s_add_u32 s56, s56, 4096
    s_waitcnt vmcnt(4)
    buffer_load_dwordx4 v[172:175], v1, s[8:11], s56 offen nt
    s_add_u32 s56, s56, 4096
    s_waitcnt vmcnt(4)
    buffer_load_dwordx4 v[176:179], v1, s[8:11], s56 offen nt
    s_add_u32 s56, s56, 4096
    s_waitcnt vmcnt(4)
    buffer_load_dwordx4 v[180:183], v1, s[8:11], s56 offen nt
    s_add_u32 s56, s56, 4096
    s_waitcnt vmcnt(4)
    buffer_load_dwordx4 v[184:187], v1, s[8:11], s56 offen nt
    s_add_u32 s56, s56, 4096
    s_waitcnt vmcnt(4)
    buffer_load_dwordx4 v[188:191], v1, s[8:11], s56 offen nt
    s_add_u32 s56, s56, 4096
    s_waitcnt vmcnt(4)
    buffer_load_dwordx4 v[192:195], v1, s[8:11], s56 offen nt
    s_add_u32 s56, s56, 4096
    s_waitcnt vmcnt(4)
    buffer_load_dwordx4 v[196:199], v1, s[8:11], s56 offen nt
    s_add_u32 s56, s56, 4096
    s_waitcnt vmcnt(4)
    buffer_load_dwordx4 v[200:203], v1, s[8:11], s56 offen nt
    s_add_u32 s56, s56, 4096
    s_waitcnt vmcnt(4)
    buffer_load_dwordx4 v[204:207], v1, s[8:11], s56 offen nt
    s_add_u32 s56, s56, 4096
    s_waitcnt vmcnt(4)
    buffer_load_dwordx4 v[208:211], v1, s[8:11], s56 offen nt
    s_add_u32 s56, s56, 4096
    s_waitcnt vmcnt(4)
    buffer_load_dwordx4 v[212:215], v1, s[8:11], s56 offen nt
    s_add_u32 s56, s56, 4096
    s_waitcnt vmcnt(4)
    buffer_load_dwordx4 v[216:219], v1, s[8:11], s56 offen nt
    s_add_u32 s56, s56, 4096
    s_waitcnt vmcnt(4)
    buffer_load_dwordx4 v[220:223], v1, s[8:11], s56 offen nt
    s_add_u32 s56, s56, 4096
    s_waitcnt vmcnt(4)
    buffer_load_dwordx4 v[224:227], v1, s[8:11], s56 offen nt
    s_add_u32 s56, s56, 4096
    s_waitcnt vmcnt(4)
    buffer_load_dwordx4 v[228:231], v1, s[8:11], s56 offen nt
    s_add_u32 s56, s56, 4096
    s_waitcnt vmcnt(4)
    buffer_load_dwordx4 v[232:235], v1, s[8:11], s56 offen nt
    s_add_u32 s56, s56, 4096
    s_waitcnt vmcnt(4)
    buffer_load_dwordx4 v[236:239], v1, s[8:11], s56 offen nt
    s_add_u32 s56, s56, 4096
    s_waitcnt vmcnt(4)
    buffer_load_dwordx4 v[240:243], v1, s[8:11], s56 offen nt
    s_add_u32 s56, s56, 4096
    s_waitcnt vmcnt(4)
    buffer_load_dwordx4 v[244:247], v1, s[8:11], s56 offen nt
    s_add_u32 s56, s56, 4096
    s_waitcnt vmcnt(4)
    buffer_load_dwordx4 v[248:251], v1, s[8:11], s56 offen nt
    s_add_u32 s56, s56, 4096
    s_waitcnt vmcnt(4)
    buffer_load_dwordx4 v[252:255], v1, s[8:11], s56 offen nt
    s_add_u32 s56, s56, 4096
    s_mov_b32 s7, 0
L_fl_137:
    ds_read_b32 v27, v25 offset:0
    ds_read_b128 v[4:7], v3
    ds_read_b32 v49, v25 offset:24
    s_add_u32 s7, s7, 1
    s_cmp_gt_u32 s7, 33554432
    s_cbranch_scc1 L_flok_138
    s_waitcnt lgkmcnt(2)
    v_cmp_le_u32 vcc, 1, v27
    s_cbranch_vccnz L_flok_138
    s_waitcnt lgkmcnt(0)
    s_branch L_fl_137
L_flok_138:
    s_waitcnt lgkmcnt(0)
    v_readfirstlane_b32 s63, v49
    v_mfma_f32_16x16x32_bf16 v[28:31], v[64:67], v[4:7], 0
    v_mfma_f32_16x16x32_bf16 v[32:35], v[68:71], v[4:7], 0
    v_mfma_f32_16x16x32_bf16 v[36:39], v[72:75], v[4:7], 0
    v_mfma_f32_16x16x32_bf16 v[40:43], v[76:79], v[4:7], 0
    s_nop 4
    v_add_f32_dpp v44, v29, v28 row_ror:12 row_mask:0xf bank_mask:0x1
    s_nop 0
    v_add_f32_dpp v45, v37, v36 row_ror:12 row_mask:0xf bank_mask:0x1
    v_add_f32_dpp v44, v32, v33 row_ror:4 row_mask:0xf bank_mask:0x2
    s_nop 0
    v_add_f32_dpp v45, v40, v41 row_ror:4 row_mask:0xf bank_mask:0x2
    v_add_f32_dpp v44, v31, v30 row_ror:12 row_mask:0xf bank_mask:0x4
    s_nop 0
    v_add_f32_dpp v45, v39, v38 row_ror:12 row_mask:0xf bank_mask:0x4
    v_add_f32_dpp v44, v34, v35 row_ror:4 row_mask:0xf bank_mask:0x8
    s_nop 0
    v_add_f32_dpp v45, v42, v43 row_ror:4 row_mask:0xf bank_mask:0x8
    v_add_f32_dpp v8, v44, v44 row_ror:8 row_mask:0xf bank_mask:0x3
    s_nop 1
    v_add_f32_dpp v8, v45, v45 row_ror:8 row_mask:0xf bank_mask:0xc
    v_mfma_f32_16x16x32_bf16 v[28:31], v[80:83], v[4:7], 0
    v_mfma_f32_16x16x32_bf16 v[32:35], v[84:87], v[4:7], 0
    v_mfma_f32_16x16x32_bf16 v[36:39], v[88:91], v[4:7], 0
    v_mfma_f32_16x16x32_bf16 v[40:43], v[92:95], v[4:7], 0
    s_nop 4
    v_add_f32_dpp v44, v29, v28 row_ror:12 row_mask:0xf bank_mask:0x1
    s_nop 0
    v_add_f32_dpp v45, v37, v36 row_ror:12 row_mask:0xf bank_mask:0x1
    v_add_f32_dpp v44, v32, v33 row_ror:4 row_mask:0xf bank_mask:0x2
    s_nop 0
    v_add_f32_dpp v45, v40, v41 row_ror:4 row_mask:0xf bank_mask:0x2
    v_add_f32_dpp v44, v31, v30 row_ror:12 row_mask:0xf bank_mask:0x4
    s_nop 0
    v_add_f32_dpp v45, v39, v38 row_ror:12 row_mask:0xf bank_mask:0x4
    v_add_f32_dpp v44, v34, v35 row_ror:4 row_mask:0xf bank_mask:0x8
    s_nop 0
    v_add_f32_dpp v45, v42, v43 row_ror:4 row_mask:0xf bank_mask:0x8
    v_add_f32_dpp v9, v44, v44 row_ror:8 row_mask:0xf bank_mask:0x3
    s_nop 1
    v_add_f32_dpp v9, v45, v45 row_ror:8 row_mask:0xf bank_mask:0xc
    s_waitcnt vmcnt(4)
    buffer_load_dwordx4 v[64:67], v1, s[8:11], s56 offen nt
    s_add_u32 s56, s56, 4096
    v_cvt_pk_bf16_f32 v49, v8, v9
    v_lshlrev_b32 v8, 16, v49
    v_and_b32 v9, s60, v49
    v_mul_f32 v8, s58, v8
    v_mul_f32 v9, s58, v9
    v_cvt_pk_bf16_f32 v49, v8, v9
    v_lshlrev_b32 v8, 16, v49
    v_and_b32 v9, s60, v49
    v_max_f32 v46, v8, v9
    v_mfma_f32_16x16x32_bf16 v[28:31], v[96:99], v[4:7], 0
    v_mfma_f32_16x16x32_bf16 v[32:35], v[100:103], v[4:7], 0
    v_mfma_f32_16x16x32_bf16 v[36:39], v[104:107], v[4:7], 0
    v_mfma_f32_16x16x32_bf16 v[40:43], v[108:111], v[4:7], 0
    s_nop 4
    v_add_f32_dpp v44, v29, v28 row_ror:12 row_mask:0xf bank_mask:0x1
    s_nop 0
    v_add_f32_dpp v45, v37, v36 row_ror:12 row_mask:0xf bank_mask:0x1
    v_add_f32_dpp v44, v32, v33 row_ror:4 row_mask:0xf bank_mask:0x2
    s_nop 0
    v_add_f32_dpp v45, v40, v41 row_ror:4 row_mask:0xf bank_mask:0x2
    v_add_f32_dpp v44, v31, v30 row_ror:12 row_mask:0xf bank_mask:0x4
    s_nop 0
    v_add_f32_dpp v45, v39, v38 row_ror:12 row_mask:0xf bank_mask:0x4
    v_add_f32_dpp v44, v34, v35 row_ror:4 row_mask:0xf bank_mask:0x8
    s_nop 0
    v_add_f32_dpp v45, v42, v43 row_ror:4 row_mask:0xf bank_mask:0x8
    v_add_f32_dpp v10, v44, v44 row_ror:8 row_mask:0xf bank_mask:0x3
    s_nop 1
    v_add_f32_dpp v10, v45, v45 row_ror:8 row_mask:0xf bank_mask:0xc
    v_mfma_f32_16x16x32_bf16 v[28:31], v[112:115], v[4:7], 0
    v_mfma_f32_16x16x32_bf16 v[32:35], v[116:119], v[4:7], 0
    v_mfma_f32_16x16x32_bf16 v[36:39], v[120:123], v[4:7], 0
    v_mfma_f32_16x16x32_bf16 v[40:43], v[124:127], v[4:7], 0
    s_nop 4
    v_add_f32_dpp v44, v29, v28 row_ror:12 row_mask:0xf bank_mask:0x1
    s_nop 0
    v_add_f32_dpp v45, v37, v36 row_ror:12 row_mask:0xf bank_mask:0x1
    v_add_f32_dpp v44, v32, v33 row_ror:4 row_mask:0xf bank_mask:0x2
    s_nop 0
    v_add_f32_dpp v45, v40, v41 row_ror:4 row_mask:0xf bank_mask:0x2
    v_add_f32_dpp v44, v31, v30 row_ror:12 row_mask:0xf bank_mask:0x4
    s_nop 0
    v_add_f32_dpp v45, v39, v38 row_ror:12 row_mask:0xf bank_mask:0x4
    v_add_f32_dpp v44, v34, v35 row_ror:4 row_mask:0xf bank_mask:0x8
    s_nop 0
    v_add_f32_dpp v45, v42, v43 row_ror:4 row_mask:0xf bank_mask:0x8
    v_add_f32_dpp v11, v44, v44 row_ror:8 row_mask:0xf bank_mask:0x3
    s_nop 1
    v_add_f32_dpp v11, v45, v45 row_ror:8 row_mask:0xf bank_mask:0xc
    s_waitcnt vmcnt(4)
    buffer_load_dwordx4 v[68:71], v1, s[8:11], s56 offen nt
    s_add_u32 s56, s56, 4096
    v_cvt_pk_bf16_f32 v49, v10, v11
    v_lshlrev_b32 v10, 16, v49
    v_and_b32 v11, s60, v49
    v_mul_f32 v10, s58, v10
    v_mul_f32 v11, s58, v11
    v_cvt_pk_bf16_f32 v49, v10, v11
    v_lshlrev_b32 v10, 16, v49
    v_and_b32 v11, s60, v49
    v_max3_f32 v46, v46, v10, v11
    v_mfma_f32_16x16x32_bf16 v[28:31], v[128:131], v[4:7], 0
    v_mfma_f32_16x16x32_bf16 v[32:35], v[132:135], v[4:7], 0
    v_mfma_f32_16x16x32_bf16 v[36:39], v[136:139], v[4:7], 0
    v_mfma_f32_16x16x32_bf16 v[40:43], v[140:143], v[4:7], 0
    s_nop 4
    v_add_f32_dpp v44, v29, v28 row_ror:12 row_mask:0xf bank_mask:0x1
    s_nop 0
    v_add_f32_dpp v45, v37, v36 row_ror:12 row_mask:0xf bank_mask:0x1
    v_add_f32_dpp v44, v32, v33 row_ror:4 row_mask:0xf bank_mask:0x2
    s_nop 0
    v_add_f32_dpp v45, v40, v41 row_ror:4 row_mask:0xf bank_mask:0x2
    v_add_f32_dpp v44, v31, v30 row_ror:12 row_mask:0xf bank_mask:0x4
    s_nop 0
    v_add_f32_dpp v45, v39, v38 row_ror:12 row_mask:0xf bank_mask:0x4
    v_add_f32_dpp v44, v34, v35 row_ror:4 row_mask:0xf bank_mask:0x8
    s_nop 0
    v_add_f32_dpp v45, v42, v43 row_ror:4 row_mask:0xf bank_mask:0x8
    v_add_f32_dpp v12, v44, v44 row_ror:8 row_mask:0xf bank_mask:0x3
    s_nop 1
    v_add_f32_dpp v12, v45, v45 row_ror:8 row_mask:0xf bank_mask:0xc
    v_mfma_f32_16x16x32_bf16 v[28:31], v[144:147], v[4:7], 0
    v_mfma_f32_16x16x32_bf16 v[32:35], v[148:151], v[4:7], 0
    v_mfma_f32_16x16x32_bf16 v[36:39], v[152:155], v[4:7], 0
    v_mfma_f32_16x16x32_bf16 v[40:43], v[156:159], v[4:7], 0
    s_nop 4
    v_add_f32_dpp v44, v29, v28 row_ror:12 row_mask:0xf bank_mask:0x1
    s_nop 0
    v_add_f32_dpp v45, v37, v36 row_ror:12 row_mask:0xf bank_mask:0x1
    v_add_f32_dpp v44, v32, v33 row_ror:4 row_mask:0xf bank_mask:0x2
    s_nop 0
    v_add_f32_dpp v45, v40, v41 row_ror:4 row_mask:0xf bank_mask:0x2
    v_add_f32_dpp v44, v31, v30 row_ror:12 row_mask:0xf bank_mask:0x4
    s_nop 0
    v_add_f32_dpp v45, v39, v38 row_ror:12 row_mask:0xf bank_mask:0x4
    v_add_f32_dpp v44, v34, v35 row_ror:4 row_mask:0xf bank_mask:0x8
    s_nop 0
    v_add_f32_dpp v45, v42, v43 row_ror:4 row_mask:0xf bank_mask:0x8
    v_add_f32_dpp v13, v44, v44 row_ror:8 row_mask:0xf bank_mask:0x3
    s_nop 1
    v_add_f32_dpp v13, v45, v45 row_ror:8 row_mask:0xf bank_mask:0xc
    s_waitcnt vmcnt(4)
    buffer_load_dwordx4 v[72:75], v1, s[8:11], s56 offen nt
    s_add_u32 s56, s56, 4096
    v_cvt_pk_bf16_f32 v49, v12, v13
    v_lshlrev_b32 v12, 16, v49
    v_and_b32 v13, s60, v49
    v_mul_f32 v12, s58, v12
    v_mul_f32 v13, s58, v13
    v_cvt_pk_bf16_f32 v49, v12, v13
    v_lshlrev_b32 v12, 16, v49
    v_and_b32 v13, s60, v49
    v_max3_f32 v46, v46, v12, v13
    v_mfma_f32_16x16x32_bf16 v[28:31], v[160:163], v[4:7], 0
    v_mfma_f32_16x16x32_bf16 v[32:35], v[164:167], v[4:7], 0
    v_mfma_f32_16x16x32_bf16 v[36:39], v[168:171], v[4:7], 0
    v_mfma_f32_16x16x32_bf16 v[40:43], v[172:175], v[4:7], 0
    s_nop 4
    v_add_f32_dpp v44, v29, v28 row_ror:12 row_mask:0xf bank_mask:0x1
    s_nop 0
    v_add_f32_dpp v45, v37, v36 row_ror:12 row_mask:0xf bank_mask:0x1
    v_add_f32_dpp v44, v32, v33 row_ror:4 row_mask:0xf bank_mask:0x2
    s_nop 0
    v_add_f32_dpp v45, v40, v41 row_ror:4 row_mask:0xf bank_mask:0x2
    v_add_f32_dpp v44, v31, v30 row_ror:12 row_mask:0xf bank_mask:0x4
    s_nop 0
    v_add_f32_dpp v45, v39, v38 row_ror:12 row_mask:0xf bank_mask:0x4
    v_add_f32_dpp v44, v34, v35 row_ror:4 row_mask:0xf bank_mask:0x8
    s_nop 0
    v_add_f32_dpp v45, v42, v43 row_ror:4 row_mask:0xf bank_mask:0x8
    v_add_f32_dpp v14, v44, v44 row_ror:8 row_mask:0xf bank_mask:0x3
    s_nop 1
    v_add_f32_dpp v14, v45, v45 row_ror:8 row_mask:0xf bank_mask:0xc
    v_mfma_f32_16x16x32_bf16 v[28:31], v[176:179], v[4:7], 0
    v_mfma_f32_16x16x32_bf16 v[32:35], v[180:183], v[4:7], 0
    v_mfma_f32_16x16x32_bf16 v[36:39], v[184:187], v[4:7], 0
    v_mfma_f32_16x16x32_bf16 v[40:43], v[188:191], v[4:7], 0
    s_nop 4
    v_add_f32_dpp v44, v29, v28 row_ror:12 row_mask:0xf bank_mask:0x1
    s_nop 0
    v_add_f32_dpp v45, v37, v36 row_ror:12 row_mask:0xf bank_mask:0x1
    v_add_f32_dpp v44, v32, v33 row_ror:4 row_mask:0xf bank_mask:0x2
    s_nop 0
    v_add_f32_dpp v45, v40, v41 row_ror:4 row_mask:0xf bank_mask:0x2
    v_add_f32_dpp v44, v31, v30 row_ror:12 row_mask:0xf bank_mask:0x4
    s_nop 0
    v_add_f32_dpp v45, v39, v38 row_ror:12 row_mask:0xf bank_mask:0x4
    v_add_f32_dpp v44, v34, v35 row_ror:4 row_mask:0xf bank_mask:0x8
    s_nop 0
    v_add_f32_dpp v45, v42, v43 row_ror:4 row_mask:0xf bank_mask:0x8
    v_add_f32_dpp v15, v44, v44 row_ror:8 row_mask:0xf bank_mask:0x3
    s_nop 1
    v_add_f32_dpp v15, v45, v45 row_ror:8 row_mask:0xf bank_mask:0xc
    s_waitcnt vmcnt(4)
    buffer_load_dwordx4 v[76:79], v1, s[8:11], s56 offen nt
    s_add_u32 s56, s56, 4096
    v_cvt_pk_bf16_f32 v49, v14, v15
    v_lshlrev_b32 v14, 16, v49
    v_and_b32 v15, s60, v49
    v_mul_f32 v14, s58, v14
    v_mul_f32 v15, s58, v15
    v_cvt_pk_bf16_f32 v49, v14, v15
    v_lshlrev_b32 v14, 16, v49
    v_and_b32 v15, s60, v49
    v_max3_f32 v46, v46, v14, v15
    v_mfma_f32_16x16x32_bf16 v[28:31], v[192:195], v[4:7], 0
    v_mfma_f32_16x16x32_bf16 v[32:35], v[196:199], v[4:7], 0
    v_mfma_f32_16x16x32_bf16 v[36:39], v[200:203], v[4:7], 0
    v_mfma_f32_16x16x32_bf16 v[40:43], v[204:207], v[4:7], 0
    s_nop 4
    v_add_f32_dpp v44, v29, v28 row_ror:12 row_mask:0xf bank_mask:0x1
    s_nop 0
    v_add_f32_dpp v45, v37, v36 row_ror:12 row_mask:0xf bank_mask:0x1
    v_add_f32_dpp v44, v32, v33 row_ror:4 row_mask:0xf bank_mask:0x2
    s_nop 0
    v_add_f32_dpp v45, v40, v41 row_ror:4 row_mask:0xf bank_mask:0x2
    v_add_f32_dpp v44, v31, v30 row_ror:12 row_mask:0xf bank_mask:0x4
    s_nop 0
    v_add_f32_dpp v45, v39, v38 row_ror:12 row_mask:0xf bank_mask:0x4
    v_add_f32_dpp v44, v34, v35 row_ror:4 row_mask:0xf bank_mask:0x8
    s_nop 0
    v_add_f32_dpp v45, v42, v43 row_ror:4 row_mask:0xf bank_mask:0x8
    v_add_f32_dpp v16, v44, v44 row_ror:8 row_mask:0xf bank_mask:0x3
    s_nop 1
    v_add_f32_dpp v16, v45, v45 row_ror:8 row_mask:0xf bank_mask:0xc
    v_mfma_f32_16x16x32_bf16 v[28:31], v[208:211], v[4:7], 0
    v_mfma_f32_16x16x32_bf16 v[32:35], v[212:215], v[4:7], 0
    v_mfma_f32_16x16x32_bf16 v[36:39], v[216:219], v[4:7], 0
    v_mfma_f32_16x16x32_bf16 v[40:43], v[220:223], v[4:7], 0
    s_nop 4
    v_add_f32_dpp v44, v29, v28 row_ror:12 row_mask:0xf bank_mask:0x1
    s_nop 0
    v_add_f32_dpp v45, v37, v36 row_ror:12 row_mask:0xf bank_mask:0x1
    v_add_f32_dpp v44, v32, v33 row_ror:4 row_mask:0xf bank_mask:0x2
    s_nop 0
    v_add_f32_dpp v45, v40, v41 row_ror:4 row_mask:0xf bank_mask:0x2
    v_add_f32_dpp v44, v31, v30 row_ror:12 row_mask:0xf bank_mask:0x4
    s_nop 0
    v_add_f32_dpp v45, v39, v38 row_ror:12 row_mask:0xf bank_mask:0x4
    v_add_f32_dpp v44, v34, v35 row_ror:4 row_mask:0xf bank_mask:0x8
    s_nop 0
    v_add_f32_dpp v45, v42, v43 row_ror:4 row_mask:0xf bank_mask:0x8
    v_add_f32_dpp v17, v44, v44 row_ror:8 row_mask:0xf bank_mask:0x3
    s_nop 1
    v_add_f32_dpp v17, v45, v45 row_ror:8 row_mask:0xf bank_mask:0xc
    s_waitcnt vmcnt(4)
    buffer_load_dwordx4 v[80:83], v1, s[8:11], s56 offen nt
    s_add_u32 s56, s56, 4096
    v_cvt_pk_bf16_f32 v49, v16, v17
    v_lshlrev_b32 v16, 16, v49
    v_and_b32 v17, s60, v49
    v_mul_f32 v16, s58, v16
    v_mul_f32 v17, s58, v17
    v_cvt_pk_bf16_f32 v49, v16, v17
    v_lshlrev_b32 v16, 16, v49
    v_and_b32 v17, s60, v49
    v_max3_f32 v46, v46, v16, v17
    v_mfma_f32_16x16x32_bf16 v[28:31], v[224:227], v[4:7], 0
    v_mfma_f32_16x16x32_bf16 v[32:35], v[228:231], v[4:7], 0
    v_mfma_f32_16x16x32_bf16 v[36:39], v[232:235], v[4:7], 0
    v_mfma_f32_16x16x32_bf16 v[40:43], v[236:239], v[4:7], 0
    s_nop 4
    v_add_f32_dpp v44, v29, v28 row_ror:12 row_mask:0xf bank_mask:0x1
    s_nop 0
    v_add_f32_dpp v45, v37, v36 row_ror:12 row_mask:0xf bank_mask:0x1
    v_add_f32_dpp v44, v32, v33 row_ror:4 row_mask:0xf bank_mask:0x2
    s_nop 0
    v_add_f32_dpp v45, v40, v41 row_ror:4 row_mask:0xf bank_mask:0x2
    v_add_f32_dpp v44, v31, v30 row_ror:12 row_mask:0xf bank_mask:0x4
    s_nop 0
    v_add_f32_dpp v45, v39, v38 row_ror:12 row_mask:0xf bank_mask:0x4
    v_add_f32_dpp v44, v34, v35 row_ror:4 row_mask:0xf bank_mask:0x8
    s_nop 0
    v_add_f32_dpp v45, v42, v43 row_ror:4 row_mask:0xf bank_mask:0x8
    v_add_f32_dpp v18, v44, v44 row_ror:8 row_mask:0xf bank_mask:0x3
    s_nop 1
    v_add_f32_dpp v18, v45, v45 row_ror:8 row_mask:0xf bank_mask:0xc
    v_mfma_f32_16x16x32_bf16 v[28:31], v[240:243], v[4:7], 0
    v_mfma_f32_16x16x32_bf16 v[32:35], v[244:247], v[4:7], 0
    v_mfma_f32_16x16x32_bf16 v[36:39], v[248:251], v[4:7], 0
    v_mfma_f32_16x16x32_bf16 v[40:43], v[252:255], v[4:7], 0
    s_nop 4
    v_add_f32_dpp v44, v29, v28 row_ror:12 row_mask:0xf bank_mask:0x1
    s_nop 0
    v_add_f32_dpp v45, v37, v36 row_ror:12 row_mask:0xf bank_mask:0x1
    v_add_f32_dpp v44, v32, v33 row_ror:4 row_mask:0xf bank_mask:0x2
    s_nop 0
    v_add_f32_dpp v45, v40, v41 row_ror:4 row_mask:0xf bank_mask:0x2
    v_add_f32_dpp v44, v31, v30 row_ror:12 row_mask:0xf bank_mask:0x4
    s_nop 0
    v_add_f32_dpp v45, v39, v38 row_ror:12 row_mask:0xf bank_mask:0x4
    v_add_f32_dpp v44, v34, v35 row_ror:4 row_mask:0xf bank_mask:0x8
    s_nop 0
    v_add_f32_dpp v45, v42, v43 row_ror:4 row_mask:0xf bank_mask:0x8
    v_add_f32_dpp v19, v44, v44 row_ror:8 row_mask:0xf bank_mask:0x3
    s_nop 1
    v_add_f32_dpp v19, v45, v45 row_ror:8 row_mask:0xf bank_mask:0xc
    s_waitcnt vmcnt(4)
    buffer_load_dwordx4 v[84:87], v1, s[8:11], s56 offen nt
    s_add_u32 s56, s56, 4096
    v_cvt_pk_bf16_f32 v49, v18, v19
    v_lshlrev_b32 v18, 16, v49
    v_and_b32 v19, s60, v49
    v_mul_f32 v18, s58, v18
    v_mul_f32 v19, s58, v19
    v_cvt_pk_bf16_f32 v49, v18, v19
    v_lshlrev_b32 v18, 16, v49
    v_and_b32 v19, s60, v49
    v_max3_f32 v46, v46, v18, v19
    s_waitcnt vmcnt(4)
    buffer_load_dwordx4 v[88:91], v1, s[8:11], s56 offen nt
    s_add_u32 s56, s56, 4096
    s_waitcnt vmcnt(4)
    buffer_load_dwordx4 v[92:95], v1, s[8:11], s56 offen nt
    s_add_u32 s56, s56, 4096
    s_waitcnt vmcnt(4)
    buffer_load_dwordx4 v[96:99], v1, s[8:11], s56 offen nt
    s_add_u32 s56, s56, 4096
    v_mfma_f32_16x16x32_bf16 v[28:31], v[64:67], v[4:7], 0
    v_mfma_f32_16x16x32_bf16 v[32:35], v[68:71], v[4:7], 0
    v_mfma_f32_16x16x32_bf16 v[36:39], v[72:75], v[4:7], 0
    v_mfma_f32_16x16x32_bf16 v[40:43], v[76:79], v[4:7], 0
    s_nop 4
    v_add_f32_dpp v44, v29, v28 row_ror:12 row_mask:0xf bank_mask:0x1
    s_nop 0
    v_add_f32_dpp v45, v37, v36 row_ror:12 row_mask:0xf bank_mask:0x1
    v_add_f32_dpp v44, v32, v33 row_ror:4 row_mask:0xf bank_mask:0x2
    s_nop 0
    v_add_f32_dpp v45, v40, v41 row_ror:4 row_mask:0xf bank_mask:0x2
    v_add_f32_dpp v44, v31, v30 row_ror:12 row_mask:0xf bank_mask:0x4
    s_nop 0
    v_add_f32_dpp v45, v39, v38 row_ror:12 row_mask:0xf bank_mask:0x4
    v_add_f32_dpp v44, v34, v35 row_ror:4 row_mask:0xf bank_mask:0x8
    s_nop 0
    v_add_f32_dpp v45, v42, v43 row_ror:4 row_mask:0xf bank_mask:0x8
    v_add_f32_dpp v20, v44, v44 row_ror:8 row_mask:0xf bank_mask:0x3
    s_nop 1
    v_add_f32_dpp v20, v45, v45 row_ror:8 row_mask:0xf bank_mask:0xc
    s_waitcnt vmcnt(4)
    buffer_load_dwordx4 v[100:103], v1, s[8:11], s56 offen nt
    s_add_u32 s56, s56, 4096
    s_waitcnt vmcnt(4)
    buffer_load_dwordx4 v[104:107], v1, s[8:11], s56 offen nt
    s_add_u32 s56, s56, 4096
    s_waitcnt vmcnt(4)
    buffer_load_dwordx4 v[108:111], v1, s[8:11], s56 offen nt
    s_add_u32 s56, s56, 4096
    s_waitcnt vmcnt(4)
    buffer_load_dwordx4 v[112:115], v1, s[8:11], s56 offen nt
    s_add_u32 s56, s56, 4096
    v_mfma_f32_16x16x32_bf16 v[28:31], v[80:83], v[4:7], 0
    v_mfma_f32_16x16x32_bf16 v[32:35], v[84:87], v[4:7], 0
    v_mfma_f32_16x16x32_bf16 v[36:39], v[88:91], v[4:7], 0
    v_mfma_f32_16x16x32_bf16 v[40:43], v[92:95], v[4:7], 0
    s_nop 4
    v_add_f32_dpp v44, v29, v28 row_ror:12 row_mask:0xf bank_mask:0x1
    s_nop 0
    v_add_f32_dpp v45, v37, v36 row_ror:12 row_mask:0xf bank_mask:0x1
    v_add_f32_dpp v44, v32, v33 row_ror:4 row_mask:0xf bank_mask:0x2
    s_nop 0
    v_add_f32_dpp v45, v40, v41 row_ror:4 row_mask:0xf bank_mask:0x2
    v_add_f32_dpp v44, v31, v30 row_ror:12 row_mask:0xf bank_mask:0x4
    s_nop 0
    v_add_f32_dpp v45, v39, v38 row_ror:12 row_mask:0xf bank_mask:0x4
    v_add_f32_dpp v44, v34, v35 row_ror:4 row_mask:0xf bank_mask:0x8
    s_nop 0
    v_add_f32_dpp v45, v42, v43 row_ror:4 row_mask:0xf bank_mask:0x8
    v_add_f32_dpp v21, v44, v44 row_ror:8 row_mask:0xf bank_mask:0x3
    s_nop 1
    v_add_f32_dpp v21, v45, v45 row_ror:8 row_mask:0xf bank_mask:0xc
    v_cvt_pk_bf16_f32 v49, v20, v21
    v_lshlrev_b32 v20, 16, v49
    v_and_b32 v21, s60, v49
    v_mul_f32 v20, s58, v20
    v_mul_f32 v21, s58, v21
    v_cvt_pk_bf16_f32 v49, v20, v21
    v_lshlrev_b32 v20, 16, v49
    v_and_b32 v21, s60, v49
    v_max3_f32 v46, v46, v20, v21
    s_waitcnt vmcnt(4)
    buffer_load_dwordx4 v[116:119], v1, s[8:11], s56 offen nt
    s_add_u32 s56, s56, 4096
    s_waitcnt vmcnt(4)
    buffer_load_dwordx4 v[120:123], v1, s[8:11], s56 offen nt
    s_waitcnt vmcnt(4)
    buffer_load_dwordx4 v[124:127], v2, s[12:15], s57 offen nt
    s_add_u32 s57, s57, 4096
    s_waitcnt vmcnt(4)
    buffer_load_dwordx4 v[128:131], v2, s[12:15], s57 offen nt
    s_add_u32 s57, s57, 4096
    v_mfma_f32_16x16x32_bf16 v[28:31], v[96:99], v[4:7], 0
    v_mfma_f32_16x16x32_bf16 v[32:35], v[100:103], v[4:7], 0
    v_mfma_f32_16x16x32_bf16 v[36:39], v[104:107], v[4:7], 0
    v_mfma_f32_16x16x32_bf16 v[40:43], v[108:111], v[4:7], 0
    s_nop 4
    v_add_f32_dpp v44, v29, v28 row_ror:12 row_mask:0xf bank_mask:0x1
    s_nop 0
    v_add_f32_dpp v45, v37, v36 row_ror:12 row_mask:0xf bank_mask:0x1
    v_add_f32_dpp v44, v32, v33 row_ror:4 row_mask:0xf bank_mask:0x2
    s_nop 0
    v_add_f32_dpp v45, v40, v41 row_ror:4 row_mask:0xf bank_mask:0x2
    v_add_f32_dpp v44, v31, v30 row_ror:12 row_mask:0xf bank_mask:0x4
    s_nop 0
    v_add_f32_dpp v45, v39, v38 row_ror:12 row_mask:0xf bank_mask:0x4
    v_add_f32_dpp v44, v34, v35 row_ror:4 row_mask:0xf bank_mask:0x8
    s_nop 0
    v_add_f32_dpp v45, v42, v43 row_ror:4 row_mask:0xf bank_mask:0x8
    v_add_f32_dpp v22, v44, v44 row_ror:8 row_mask:0xf bank_mask:0x3
    s_nop 1
    v_add_f32_dpp v22, v45, v45 row_ror:8 row_mask:0xf bank_mask:0xc
    s_waitcnt vmcnt(4)
    buffer_load_dwordx4 v[132:135], v2, s[12:15], s57 offen nt
    s_add_u32 s57, s57, 4096
    s_waitcnt vmcnt(4)
    buffer_load_dwordx4 v[136:139], v2, s[12:15], s57 offen nt
    s_add_u32 s57, s57, 4096
    s_waitcnt vmcnt(4)
    buffer_load_dwordx4 v[140:143], v2, s[12:15], s57 offen nt
    s_add_u32 s57, s57, 4096
    v_mfma_f32_16x16x32_bf16 v[28:31], v[112:115], v[4:7], 0
    v_mfma_f32_16x16x32_bf16 v[32:35], v[116:119], v[4:7], 0
    v_mfma_f32_16x16x32_bf16 v[36:39], v[120:123], v[4:7], 0
    s_nop 5
    v_add_f32_dpp v44, v29, v28 row_ror:12 row_mask:0xf bank_mask:0x1
    s_nop 0
    v_add_f32_dpp v45, v37, v36 row_ror:12 row_mask:0xf bank_mask:0x1
    v_add_f32_dpp v44, v32, v33 row_ror:4 row_mask:0xf bank_mask:0x2
    s_nop 0
    v_add_f32_dpp v45, v40, v41 row_ror:4 row_mask:0xf bank_mask:0x2
    v_add_f32_dpp v44, v31, v30 row_ror:12 row_mask:0xf bank_mask:0x4
    s_nop 0
    v_add_f32_dpp v45, v39, v38 row_ror:12 row_mask:0xf bank_mask:0x4
    v_add_f32_dpp v44, v34, v35 row_ror:4 row_mask:0xf bank_mask:0x8
    s_nop 0
    v_add_f32_dpp v45, v42, v43 row_ror:4 row_mask:0xf bank_mask:0x8
    v_add_f32_dpp v23, v44, v44 row_ror:8 row_mask:0xf bank_mask:0x3
    s_nop 1
    v_add_f32_dpp v23, v45, v45 row_ror:8 row_mask:0xf bank_mask:0xc
    v_mov_b32 v49, 0xff800000
    s_nop 1
    v_mov_b32_dpp v23, v49 quad_perm:[0,1,2,3] row_mask:0xf bank_mask:0x8
    v_cvt_pk_bf16_f32 v49, v22, v23
    v_lshlrev_b32 v22, 16, v49
    v_and_b32 v23, s60, v49
    v_mul_f32 v22, s58, v22
    v_mul_f32 v23, s58, v23
    v_cvt_pk_bf16_f32 v49, v22, v23
    v_lshlrev_b32 v22, 16, v49
    v_and_b32 v23, s60, v49
    v_max3_f32 v46, v46, v22, v23
    s_nop 1
    v_max_f32_dpp v46, v46, v46 row_ror:4 row_mask:0xf bank_mask:0xf
    s_nop 1
    v_max_f32_dpp v46, v46, v46 row_ror:8 row_mask:0xf bank_mask:0xf
    v_mov_b32 v49, v46
    s_nop 1
    v_permlane16_swap_b32 v46, v49
    v_max_f32 v46, v46, v49
    v_mov_b32 v49, v46
    s_nop 1
    v_permlane32_swap_b32 v46, v49
    v_max_f32 v46, v46, v49
    v_mul_f32 v50, s59, v46
    s_waitcnt vmcnt(4)
    buffer_load_dwordx4 v[144:147], v2, s[12:15], s57 offen nt
    s_add_u32 s57, s57, 4096
    v_fma_f32 v8, v8, s59, -v50
    v_fma_f32 v9, v9, s59, -v50
    v_fma_f32 v10, v10, s59, -v50
    v_fma_f32 v11, v11, s59, -v50
    v_fma_f32 v12, v12, s59, -v50
    v_fma_f32 v13, v13, s59, -v50
    v_fma_f32 v14, v14, s59, -v50
    v_fma_f32 v15, v15, s59, -v50
    v_exp_f32 v8, v8
    v_exp_f32 v9, v9
    v_exp_f32 v10, v10
    v_exp_f32 v11, v11
    v_exp_f32 v12, v12
    v_exp_f32 v13, v13
    v_exp_f32 v14, v14
    v_exp_f32 v15, v15
    v_add_f32 v47, v8, v9
    v_add_f32 v47, v47, v10
    v_add_f32 v47, v47, v11
    v_add_f32 v47, v47, v12
    v_add_f32 v47, v47, v13
    v_add_f32 v47, v47, v14
    v_add_f32 v47, v47, v15
    v_fma_f32 v16, v16, s59, -v50
    v_fma_f32 v17, v17, s59, -v50
    v_fma_f32 v18, v18, s59, -v50
    v_fma_f32 v19, v19, s59, -v50
    v_fma_f32 v20, v20, s59, -v50
    v_fma_f32 v21, v21, s59, -v50
    v_fma_f32 v22, v22, s59, -v50
    v_fma_f32 v23, v23, s59, -v50
    v_exp_f32 v16, v16
    v_exp_f32 v17, v17
    v_exp_f32 v18, v18
    v_exp_f32 v19, v19
    v_exp_f32 v20, v20
    v_exp_f32 v21, v21
    v_exp_f32 v22, v22
    v_exp_f32 v23, v23
    v_add_f32 v47, v47, v16
    v_add_f32 v47, v47, v17
    v_add_f32 v47, v47, v18
    v_add_f32 v47, v47, v19
    v_add_f32 v47, v47, v20
    v_add_f32 v47, v47, v21
    v_add_f32 v47, v47, v22
    v_add_f32 v47, v47, v23
    s_waitcnt vmcnt(4)
    buffer_load_dwordx4 v[148:151], v2, s[12:15], s57 offen nt
    s_add_u32 s57, s57, 4096
    v_add_f32_dpp v47, v47, v47 row_ror:4 row_mask:0xf bank_mask:0xf
    s_nop 1
    v_add_f32_dpp v47, v47, v47 row_ror:8 row_mask:0xf bank_mask:0xf
    v_mov_b32 v49, v47
    s_nop 1
    v_permlane16_swap_b32 v47, v49
    v_add_f32 v47, v47, v49
    v_mov_b32 v49, v47
    s_nop 1
    v_permlane32_swap_b32 v47, v49
    v_add_f32 v47, v47, v49
    v_and_b32 v3, 3, v0
    v_lshlrev_b32 v3, 4, v3
    v_add_u32 v3, 143872, v3
    s_lshl_b32 s6, s3, 2
    v_add_u32 v4, s6, v3
    s_mov_b64 exec, 15
    ds_write_b32 v4, v46
    ds_write_b32 v4, v47 offset:64
    s_mov_b64 exec, 1
    ds_add_u32 v25, v26 offset:4
    s_mov_b64 exec, -1
    v_mov_b32 v28, 0
    v_mov_b32 v29, 0
    v_mov_b32 v30, 0
    v_mov_b32 v31, 0
    v_mov_b32 v32, 0
    v_mov_b32 v33, 0
    v_mov_b32 v34, 0
    v_mov_b32 v35, 0
    v_mov_b32 v56, 0
    v_mov_b32 v57, 0
    v_mov_b32 v58, 0
    v_mov_b32 v59, 0
    v_mov_b32 v60, 0
    v_mov_b32 v61, 0
    v_mov_b32 v62, 0
    v_mov_b32 v63, 0
    s_lshl_b32 s6, s3, 10
    s_add_u32 s6, s6, 131072
    v_add_u32 v51, s6, v2
    s_lshl_b32 s61, s4, 16
    s_lshl_b32 s7, s5, 11
    s_add_u32 s61, s61, s7
    s_lshl_b32 s7, s3, 10
    s_add_u32 s61, s61, s7
    s_add_u32 s61, s61, 262144
    s_waitcnt vmcnt(4)
    buffer_load_dwordx4 v[152:155], v2, s[12:15], s57 offen nt
    s_add_u32 s57, s57, 4096
    s_waitcnt vmcnt(4)
    buffer_load_dwordx4 v[156:159], v2, s[12:15], s57 offen nt
    s_add_u32 s57, s57, 4096
    s_waitcnt vmcnt(4)
    buffer_load_dwordx4 v[160:163], v2, s[12:15], s57 offen nt
    s_add_u32 s57, s57, 4096
    s_mov_b32 s7, 0
L_fl_139:
    ds_read_b32 v27, v25 offset:4
    ds_read_b128 v[52:55], v3
    s_add_u32 s7, s7, 1
    s_cmp_gt_u32 s7, 33554432
    s_cbranch_scc1 L_flok_140
    s_waitcnt lgkmcnt(1)
    v_cmp_le_u32 vcc, 4, v27
    s_cbranch_vccnz L_flok_140
    s_waitcnt lgkmcnt(0)
    s_branch L_fl_139
L_flok_140:
    s_waitcnt lgkmcnt(0)
    v_max3_f32 v48, v52, v53, v54
    v_max_f32 v48, v48, v55
    v_sub_f32 v48, v46, v48
    v_mul_f32 v48, s59, v48
    v_exp_f32 v48, v48
    s_lshl_b32 s6, s3, 11
    s_add_u32 s6, s6, 131072
    v_add_u32 v3, s6, v2
    v_mul_f32 v49, v8, v48
    v_cvt_pk_bf16_f32 v36, v49, 0
    v_cvt_pk_bf16_f32 v37, 0, v49
    s_nop 0
    v_mov_b32_dpp v28, v36 quad_perm:[0,1,2,3] row_mask:0xf bank_mask:0x1
    v_mov_b32_dpp v29, v36 row_ror:8 row_mask:0xf bank_mask:0x4
    v_mov_b32_dpp v30, v36 row_ror:12 row_mask:0xf bank_mask:0x1
    v_mov_b32_dpp v31, v36 row_ror:4 row_mask:0xf bank_mask:0x4
    v_mov_b32_dpp v28, v37 row_ror:4 row_mask:0xf bank_mask:0x2
    v_mov_b32_dpp v29, v37 row_ror:12 row_mask:0xf bank_mask:0x8
    v_mov_b32_dpp v30, v37 quad_perm:[0,1,2,3] row_mask:0xf bank_mask:0x2
    v_mov_b32_dpp v31, v37 row_ror:8 row_mask:0xf bank_mask:0x8
    v_mfma_f32_16x16x16_bf16 v[56:59], v[28:29], v[124:125], v[56:59]
    v_mfma_f32_16x16x16_bf16 v[60:63], v[28:29], v[126:127], v[60:63]
    v_mfma_f32_16x16x16_bf16 v[56:59], v[30:31], v[128:129], v[56:59]
    v_mfma_f32_16x16x16_bf16 v[60:63], v[30:31], v[130:131], v[60:63]
    v_mov_b32_dpp v32, v36 row_ror:8 row_mask:0xf bank_mask:0x1
    v_mov_b32_dpp v33, v36 quad_perm:[0,1,2,3] row_mask:0xf bank_mask:0x4
    v_mov_b32_dpp v34, v36 row_ror:4 row_mask:0xf bank_mask:0x1
    v_mov_b32_dpp v35, v36 row_ror:12 row_mask:0xf bank_mask:0x4
    v_mov_b32_dpp v32, v37 row_ror:12 row_mask:0xf bank_mask:0x2
    v_mov_b32_dpp v33, v37 row_ror:4 row_mask:0xf bank_mask:0x8
    v_mov_b32_dpp v34, v37 row_ror:8 row_mask:0xf bank_mask:0x2
    v_mov_b32_dpp v35, v37 quad_perm:[0,1,2,3] row_mask:0xf bank_mask:0x8
    s_waitcnt vmcnt(4)
    buffer_load_dwordx4 v[164:167], v2, s[12:15], s57 offen nt
    s_add_u32 s57, s57, 4096
    v_mfma_f32_16x16x16_bf16 v[56:59], v[32:33], v[132:133], v[56:59]
    v_mfma_f32_16x16x16_bf16 v[60:63], v[32:33], v[134:135], v[60:63]
    v_mfma_f32_16x16x16_bf16 v[56:59], v[34:35], v[136:137], v[56:59]
    v_mfma_f32_16x16x16_bf16 v[60:63], v[34:35], v[138:139], v[60:63]
    v_mul_f32 v49, v9, v48
    v_cvt_pk_bf16_f32 v36, v49, 0
    v_cvt_pk_bf16_f32 v37, 0, v49
    s_nop 0
    v_mov_b32_dpp v28, v36 quad_perm:[0,1,2,3] row_mask:0xf bank_mask:0x1
    v_mov_b32_dpp v29, v36 row_ror:8 row_mask:0xf bank_mask:0x4
    v_mov_b32_dpp v30, v36 row_ror:12 row_mask:0xf bank_mask:0x1
    v_mov_b32_dpp v31, v36 row_ror:4 row_mask:0xf bank_mask:0x4
    v_mov_b32_dpp v28, v37 row_ror:4 row_mask:0xf bank_mask:0x2
    v_mov_b32_dpp v29, v37 row_ror:12 row_mask:0xf bank_mask:0x8
    v_mov_b32_dpp v30, v37 quad_perm:[0,1,2,3] row_mask:0xf bank_mask:0x2
    v_mov_b32_dpp v31, v37 row_ror:8 row_mask:0xf bank_mask:0x8
    v_mfma_f32_16x16x16_bf16 v[56:59], v[28:29], v[140:141], v[56:59]
    v_mfma_f32_16x16x16_bf16 v[60:63], v[28:29], v[142:143], v[60:63]
    s_waitcnt vmcnt(4)
    buffer_load_dwordx4 v[168:171], v2, s[12:15], s57 offen nt
    s_add_u32 s57, s57, 4096
    v_mfma_f32_16x16x16_bf16 v[56:59], v[30:31], v[144:145], v[56:59]
    v_mfma_f32_16x16x16_bf16 v[60:63], v[30:31], v[146:147], v[60:63]
    v_mov_b32_dpp v32, v36 row_ror:8 row_mask:0xf bank_mask:0x1
    v_mov_b32_dpp v33, v36 quad_perm:[0,1,2,3] row_mask:0xf bank_mask:0x4
    v_mov_b32_dpp v34, v36 row_ror:4 row_mask:0xf bank_mask:0x1
    v_mov_b32_dpp v35, v36 row_ror:12 row_mask:0xf bank_mask:0x4
    v_mov_b32_dpp v32, v37 row_ror:12 row_mask:0xf bank_mask:0x2
    v_mov_b32_dpp v33, v37 row_ror:4 row_mask:0xf bank_mask:0x8
    v_mov_b32_dpp v34, v37 row_ror:8 row_mask:0xf bank_mask:0x2
    v_mov_b32_dpp v35, v37 quad_perm:[0,1,2,3] row_mask:0xf bank_mask:0x8
    v_mfma_f32_16x16x16_bf16 v[56:59], v[32:33], v[148:149], v[56:59]
    v_mfma_f32_16x16x16_bf16 v[60:63], v[32:33], v[150:151], v[60:63]
    s_waitcnt vmcnt(4)
    buffer_load_dwordx4 v[172:175], v2, s[12:15], s57 offen nt
    s_add_u32 s57, s57, 4096
    v_mfma_f32_16x16x16_bf16 v[56:59], v[34:35], v[152:153], v[56:59]
    v_mfma_f32_16x16x16_bf16 v[60:63], v[34:35], v[154:155], v[60:63]
    v_mul_f32 v49, v10, v48
    v_cvt_pk_bf16_f32 v36, v49, 0
    v_cvt_pk_bf16_f32 v37, 0, v49
    s_nop 0
    v_mov_b32_dpp v28, v36 quad_perm:[0,1,2,3] row_mask:0xf bank_mask:0x1
    v_mov_b32_dpp v29, v36 row_ror:8 row_mask:0xf bank_mask:0x4
    v_mov_b32_dpp v30, v36 row_ror:12 row_mask:0xf bank_mask:0x1
    v_mov_b32_dpp v31, v36 row_ror:4 row_mask:0xf bank_mask:0x4
    v_mov_b32_dpp v28, v37 row_ror:4 row_mask:0xf bank_mask:0x2
    v_mov_b32_dpp v29, v37 row_ror:12 row_mask:0xf bank_mask:0x8
    v_mov_b32_dpp v30, v37 quad_perm:[0,1,2,3] row_mask:0xf bank_mask:0x2
    v_mov_b32_dpp v31, v37 row_ror:8 row_mask:0xf bank_mask:0x8
    s_waitcnt vmcnt(4)
    buffer_load_dwordx4 v[176:179], v2, s[12:15], s57 offen nt
    s_add_u32 s57, s57, 4096
    v_mfma_f32_16x16x16_bf16 v[56:59], v[28:29], v[156:157], v[56:59]
    v_mfma_f32_16x16x16_bf16 v[60:63], v[28:29], v[158:159], v[60:63]
    s_waitcnt vmcnt(4)
    buffer_load_dwordx4 v[180:183], v2, s[12:15], s57 offen nt
    s_add_u32 s57, s57, 4096
    v_mfma_f32_16x16x16_bf16 v[56:59], v[30:31], v[160:161], v[56:59]
    v_mfma_f32_16x16x16_bf16 v[60:63], v[30:31], v[162:163], v[60:63]
    v_mov_b32_dpp v32, v36 row_ror:8 row_mask:0xf bank_mask:0x1
    v_mov_b32_dpp v33, v36 quad_perm:[0,1,2,3] row_mask:0xf bank_mask:0x4
    v_mov_b32_dpp v34, v36 row_ror:4 row_mask:0xf bank_mask:0x1
    v_mov_b32_dpp v35, v36 row_ror:12 row_mask:0xf bank_mask:0x4
    v_mov_b32_dpp v32, v37 row_ror:12 row_mask:0xf bank_mask:0x2
    v_mov_b32_dpp v33, v37 row_ror:4 row_mask:0xf bank_mask:0x8
    v_mov_b32_dpp v34, v37 row_ror:8 row_mask:0xf bank_mask:0x2
    v_mov_b32_dpp v35, v37 quad_perm:[0,1,2,3] row_mask:0xf bank_mask:0x8
    s_waitcnt vmcnt(4)
    buffer_load_dwordx4 v[184:187], v2, s[12:15], s57 offen nt
    s_add_u32 s57, s57, 4096
    v_mfma_f32_16x16x16_bf16 v[56:59], v[32:33], v[164:165], v[56:59]
    v_mfma_f32_16x16x16_bf16 v[60:63], v[32:33], v[166:167], v[60:63]
    s_waitcnt vmcnt(4)
    buffer_load_dwordx4 v[188:191], v2, s[12:15], s57 offen nt
    s_add_u32 s57, s57, 4096
    v_mfma_f32_16x16x16_bf16 v[56:59], v[34:35], v[168:169], v[56:59]
    v_mfma_f32_16x16x16_bf16 v[60:63], v[34:35], v[170:171], v[60:63]
    v_mul_f32 v49, v11, v48
    v_cvt_pk_bf16_f32 v36, v49, 0
    v_cvt_pk_bf16_f32 v37, 0, v49
    s_nop 0
    v_mov_b32_dpp v28, v36 quad_perm:[0,1,2,3] row_mask:0xf bank_mask:0x1
    v_mov_b32_dpp v29, v36 row_ror:8 row_mask:0xf bank_mask:0x4
    v_mov_b32_dpp v30, v36 row_ror:12 row_mask:0xf bank_mask:0x1
    v_mov_b32_dpp v31, v36 row_ror:4 row_mask:0xf bank_mask:0x4
    v_mov_b32_dpp v28, v37 row_ror:4 row_mask:0xf bank_mask:0x2
    v_mov_b32_dpp v29, v37 row_ror:12 row_mask:0xf bank_mask:0x8
    v_mov_b32_dpp v30, v37 quad_perm:[0,1,2,3] row_mask:0xf bank_mask:0x2
    v_mov_b32_dpp v31, v37 row_ror:8 row_mask:0xf bank_mask:0x8
    ds_read_b32 v27, v25 offset:52
    s_waitcnt lgkmcnt(0)
    v_readfirstlane_b32 s76, v27
    s_nop 0
    s_lshr_b32 s77, s76, 8
    s_and_b32 s76, s76, 0xff
    s_cmp_gt_u32 s76, 0
    s_cbranch_scc1 L_bo_141
    s_cmp_le_u32 s77, 0
    s_cbranch_scc1 L_th_142
    s_waitcnt vmcnt(3)
L_th_142:
    s_waitcnt vmcnt(4)
L_bo_141:
    s_waitcnt vmcnt(5)
    buffer_load_dwordx4 v[192:195], v2, s[12:15], s57 offen nt
    s_add_u32 s57, s57, 4096
    s_cmp_gt_u32 s76, 1
    s_cbranch_scc1 L_bo_143
    s_cmp_le_u32 s77, 1
    s_cbranch_scc1 L_th_144
    s_waitcnt vmcnt(3)
L_th_144:
    s_waitcnt vmcnt(4)
L_bo_143:
    s_waitcnt vmcnt(5)
    buffer_load_dwordx4 v[196:199], v2, s[12:15], s57 offen nt
    s_add_u32 s57, s57, 4096
    v_mfma_f32_16x16x16_bf16 v[56:59], v[28:29], v[172:173], v[56:59]
    v_mfma_f32_16x16x16_bf16 v[60:63], v[28:29], v[174:175], v[60:63]
    s_cmp_gt_u32 s76, 2
    s_cbranch_scc1 L_bo_145
    s_cmp_le_u32 s77, 2
    s_cbranch_scc1 L_th_146
    s_waitcnt vmcnt(3)
L_th_146:
    s_waitcnt vmcnt(4)
L_bo_145:
    s_waitcnt vmcnt(5)
    buffer_load_dwordx4 v[200:203], v2, s[12:15], s57 offen nt
    s_add_u32 s57, s57, 4096
    v_mfma_f32_16x16x16_bf16 v[56:59], v[30:31], v[176:177], v[56:59]
    v_mfma_f32_16x16x16_bf16 v[60:63], v[30:31], v[178:179], v[60:63]
    v_mov_b32_dpp v32, v36 row_ror:8 row_mask:0xf bank_mask:0x1
    v_mov_b32_dpp v33, v36 quad_perm:[0,1,2,3] row_mask:0xf bank_mask:0x4
    v_mov_b32_dpp v34, v36 row_ror:4 row_mask:0xf bank_mask:0x1
    v_mov_b32_dpp v35, v36 row_ror:12 row_mask:0xf bank_mask:0x4
    v_mov_b32_dpp v32, v37 row_ror:12 row_mask:0xf bank_mask:0x2
    v_mov_b32_dpp v33, v37 row_ror:4 row_mask:0xf bank_mask:0x8
    v_mov_b32_dpp v34, v37 row_ror:8 row_mask:0xf bank_mask:0x2
    v_mov_b32_dpp v35, v37 quad_perm:[0,1,2,3] row_mask:0xf bank_mask:0x8
    s_cmp_gt_u32 s76, 3
    s_cbranch_scc1 L_bo_147
    s_cmp_le_u32 s77, 3
    s_cbranch_scc1 L_th_148
    s_waitcnt vmcnt(3)
L_th_148:
    s_waitcnt vmcnt(4)
L_bo_147:
    s_waitcnt vmcnt(5)
    buffer_load_dwordx4 v[204:207], v2, s[12:15], s57 offen nt
    s_add_u32 s57, s57, 4096
    v_mfma_f32_16x16x16_bf16 v[56:59], v[32:33], v[180:181], v[56:59]
    v_mfma_f32_16x16x16_bf16 v[60:63], v[32:33], v[182:183], v[60:63]
    s_cmp_gt_u32 s76, 4
    s_cbranch_scc1 L_bo_149
    s_cmp_le_u32 s77, 4
    s_cbranch_scc1 L_th_150
    s_waitcnt vmcnt(3)
L_th_150:
    s_waitcnt vmcnt(4)
L_bo_149:
    s_waitcnt vmcnt(5)
    buffer_load_dwordx4 v[208:211], v2, s[12:15], s57 offen nt
    s_add_u32 s57, s57, 4096
    v_mfma_f32_16x16x16_bf16 v[56:59], v[34:35], v[184:185], v[56:59]
    v_mfma_f32_16x16x16_bf16 v[60:63], v[34:35], v[186:187], v[60:63]
    v_mul_f32 v49, v12, v48
    v_cvt_pk_bf16_f32 v36, v49, 0
    v_cvt_pk_bf16_f32 v37, 0, v49
    s_nop 0
    v_mov_b32_dpp v28, v36 quad_perm:[0,1,2,3] row_mask:0xf bank_mask:0x1
    v_mov_b32_dpp v29, v36 row_ror:8 row_mask:0xf bank_mask:0x4
    v_mov_b32_dpp v30, v36 row_ror:12 row_mask:0xf bank_mask:0x1
    v_mov_b32_dpp v31, v36 row_ror:4 row_mask:0xf bank_mask:0x4
    v_mov_b32_dpp v28, v37 row_ror:4 row_mask:0xf bank_mask:0x2
    v_mov_b32_dpp v29, v37 row_ror:12 row_mask:0xf bank_mask:0x8
    v_mov_b32_dpp v30, v37 quad_perm:[0,1,2,3] row_mask:0xf bank_mask:0x2
    v_mov_b32_dpp v31, v37 row_ror:8 row_mask:0xf bank_mask:0x8
    s_cmp_gt_u32 s76, 5
    s_cbranch_scc1 L_bo_151
    s_cmp_le_u32 s77, 5
    s_cbranch_scc1 L_th_152
    s_waitcnt vmcnt(3)
L_th_152:
    s_waitcnt vmcnt(4)
L_bo_151:
    s_waitcnt vmcnt(5)
    buffer_load_dwordx4 v[212:215], v2, s[12:15], s57 offen nt
    s_add_u32 s57, s57, 4096
    v_mfma_f32_16x16x16_bf16 v[56:59], v[28:29], v[188:189], v[56:59]
    v_mfma_f32_16x16x16_bf16 v[60:63], v[28:29], v[190:191], v[60:63]
    s_cmp_gt_u32 s76, 6
    s_cbranch_scc1 L_bo_153
    s_cmp_le_u32 s77, 6
    s_cbranch_scc1 L_th_154
    s_waitcnt vmcnt(3)
L_th_154:
    s_waitcnt vmcnt(4)
L_bo_153:
    s_waitcnt vmcnt(5)
    buffer_load_dwordx4 v[216:219], v2, s[12:15], s57 offen nt
    s_add_u32 s57, s57, 4096
    v_mfma_f32_16x16x16_bf16 v[56:59], v[30:31], v[192:193], v[56:59]
    v_mfma_f32_16x16x16_bf16 v[60:63], v[30:31], v[194:195], v[60:63]
    v_mov_b32_dpp v32, v36 row_ror:8 row_mask:0xf bank_mask:0x1
    v_mov_b32_dpp v33, v36 quad_perm:[0,1,2,3] row_mask:0xf bank_mask:0x4
    v_mov_b32_dpp v34, v36 row_ror:4 row_mask:0xf bank_mask:0x1
    v_mov_b32_dpp v35, v36 row_ror:12 row_mask:0xf bank_mask:0x4
    v_mov_b32_dpp v32, v37 row_ror:12 row_mask:0xf bank_mask:0x2
    v_mov_b32_dpp v33, v37 row_ror:4 row_mask:0xf bank_mask:0x8
    v_mov_b32_dpp v34, v37 row_ror:8 row_mask:0xf bank_mask:0x2
    v_mov_b32_dpp v35, v37 quad_perm:[0,1,2,3] row_mask:0xf bank_mask:0x8
    s_cmp_gt_u32 s76, 7
    s_cbranch_scc1 L_bo_155
    s_cmp_le_u32 s77, 7
    s_cbranch_scc1 L_th_156
    s_waitcnt vmcnt(3)
L_th_156:
    s_waitcnt vmcnt(4)
L_bo_155:
    s_waitcnt vmcnt(5)
    buffer_load_dwordx4 v[220:223], v2, s[12:15], s57 offen nt
    s_add_u32 s57, s57, 4096
    v_mfma_f32_16x16x16_bf16 v[56:59], v[32:33], v[196:197], v[56:59]
    v_mfma_f32_16x16x16_bf16 v[60:63], v[32:33], v[198:199], v[60:63]
    s_cmp_gt_u32 s76, 8
    s_cbranch_scc1 L_bo_157
    s_cmp_le_u32 s77, 8
    s_cbranch_scc1 L_th_158
    s_waitcnt vmcnt(3)
L_th_158:
    s_waitcnt vmcnt(4)
L_bo_157:
    s_waitcnt vmcnt(5)
    buffer_load_dwordx4 v[224:227], v2, s[12:15], s57 offen nt
    s_add_u32 s57, s57, 4096
    v_mfma_f32_16x16x16_bf16 v[56:59], v[34:35], v[200:201], v[56:59]
    v_mfma_f32_16x16x16_bf16 v[60:63], v[34:35], v[202:203], v[60:63]
    v_mul_f32 v49, v13, v48
    v_cvt_pk_bf16_f32 v36, v49, 0
    v_cvt_pk_bf16_f32 v37, 0, v49
    s_nop 0
    v_mov_b32_dpp v28, v36 quad_perm:[0,1,2,3] row_mask:0xf bank_mask:0x1
    v_mov_b32_dpp v29, v36 row_ror:8 row_mask:0xf bank_mask:0x4
    v_mov_b32_dpp v30, v36 row_ror:12 row_mask:0xf bank_mask:0x1
    v_mov_b32_dpp v31, v36 row_ror:4 row_mask:0xf bank_mask:0x4
    v_mov_b32_dpp v28, v37 row_ror:4 row_mask:0xf bank_mask:0x2
    v_mov_b32_dpp v29, v37 row_ror:12 row_mask:0xf bank_mask:0x8
    v_mov_b32_dpp v30, v37 quad_perm:[0,1,2,3] row_mask:0xf bank_mask:0x2
    v_mov_b32_dpp v31, v37 row_ror:8 row_mask:0xf bank_mask:0x8
    s_cmp_gt_u32 s76, 9
    s_cbranch_scc1 L_bo_159
    s_cmp_le_u32 s77, 9
    s_cbranch_scc1 L_th_160
    s_waitcnt vmcnt(3)
L_th_160:
    s_waitcnt vmcnt(4)
L_bo_159:
    s_waitcnt vmcnt(5)
    buffer_load_dwordx4 v[228:231], v2, s[12:15], s57 offen nt
    s_add_u32 s57, s57, 4096
    v_mfma_f32_16x16x16_bf16 v[56:59], v[28:29], v[204:205], v[56:59]
    v_mfma_f32_16x16x16_bf16 v[60:63], v[28:29], v[206:207], v[60:63]
    s_cmp_gt_u32 s76, 10
    s_cbranch_scc1 L_bo_161
    s_cmp_le_u32 s77, 10
    s_cbranch_scc1 L_th_162
    s_waitcnt vmcnt(3)
L_th_162:
    s_waitcnt vmcnt(4)
L_bo_161:
    s_waitcnt vmcnt(5)
    buffer_load_dwordx4 v[232:235], v2, s[12:15], s57 offen nt
    s_add_u32 s57, s57, 4096
    v_mfma_f32_16x16x16_bf16 v[56:59], v[30:31], v[208:209], v[56:59]
    v_mfma_f32_16x16x16_bf16 v[60:63], v[30:31], v[210:211], v[60:63]
    v_mov_b32_dpp v32, v36 row_ror:8 row_mask:0xf bank_mask:0x1
    v_mov_b32_dpp v33, v36 quad_perm:[0,1,2,3] row_mask:0xf bank_mask:0x4
    v_mov_b32_dpp v34, v36 row_ror:4 row_mask:0xf bank_mask:0x1
    v_mov_b32_dpp v35, v36 row_ror:12 row_mask:0xf bank_mask:0x4
    v_mov_b32_dpp v32, v37 row_ror:12 row_mask:0xf bank_mask:0x2
    v_mov_b32_dpp v33, v37 row_ror:4 row_mask:0xf bank_mask:0x8
    v_mov_b32_dpp v34, v37 row_ror:8 row_mask:0xf bank_mask:0x2
    v_mov_b32_dpp v35, v37 quad_perm:[0,1,2,3] row_mask:0xf bank_mask:0x8
    s_cmp_gt_u32 s76, 11
    s_cbranch_scc1 L_bo_163
    s_cmp_le_u32 s77, 11
    s_cbranch_scc1 L_th_164
    s_waitcnt vmcnt(3)
L_th_164:
    s_waitcnt vmcnt(4)
L_bo_163:
    s_waitcnt vmcnt(5)
    buffer_load_dwordx4 v[236:239], v2, s[12:15], s57 offen nt
    s_add_u32 s57, s57, 4096
    v_mfma_f32_16x16x16_bf16 v[56:59], v[32:33], v[212:213], v[56:59]
    v_mfma_f32_16x16x16_bf16 v[60:63], v[32:33], v[214:215], v[60:63]
    s_cmp_gt_u32 s76, 12
    s_cbranch_scc1 L_bo_165
    s_waitcnt vmcnt(4)
L_bo_165:
    s_waitcnt vmcnt(5)
    buffer_load_dwordx4 v[240:243], v2, s[12:15], s57 offen nt
    s_add_u32 s57, s57, 4096
    v_mfma_f32_16x16x16_bf16 v[56:59], v[34:35], v[216:217], v[56:59]
    v_mfma_f32_16x16x16_bf16 v[60:63], v[34:35], v[218:219], v[60:63]
    v_mul_f32 v49, v14, v48
    v_cvt_pk_bf16_f32 v36, v49, 0
    v_cvt_pk_bf16_f32 v37, 0, v49
    s_nop 0
    v_mov_b32_dpp v28, v36 quad_perm:[0,1,2,3] row_mask:0xf bank_mask:0x1
    v_mov_b32_dpp v29, v36 row_ror:8 row_mask:0xf bank_mask:0x4
    v_mov_b32_dpp v30, v36 row_ror:12 row_mask:0xf bank_mask:0x1
    v_mov_b32_dpp v31, v36 row_ror:4 row_mask:0xf bank_mask:0x4
    v_mov_b32_dpp v28, v37 row_ror:4 row_mask:0xf bank_mask:0x2
    v_mov_b32_dpp v29, v37 row_ror:12 row_mask:0xf bank_mask:0x8
    v_mov_b32_dpp v30, v37 quad_perm:[0,1,2,3] row_mask:0xf bank_mask:0x2
    v_mov_b32_dpp v31, v37 row_ror:8 row_mask:0xf bank_mask:0x8
    s_cmp_gt_u32 s76, 13
    s_cbranch_scc1 L_bo_167
    s_waitcnt vmcnt(4)
L_bo_167:
    s_waitcnt vmcnt(5)
    buffer_load_dwordx4 v[244:247], v2, s[12:15], s57 offen nt
    s_add_u32 s57, s57, 4096
    v_mfma_f32_16x16x16_bf16 v[56:59], v[28:29], v[220:221], v[56:59]
    v_mfma_f32_16x16x16_bf16 v[60:63], v[28:29], v[222:223], v[60:63]
    s_cmp_gt_u32 s76, 14
    s_cbranch_scc1 L_bo_169
    s_waitcnt vmcnt(4)
L_bo_169:
    s_waitcnt vmcnt(5)
    buffer_load_dwordx4 v[248:251], v2, s[12:15], s57 offen nt
    s_add_u32 s57, s57, 4096
    v_mfma_f32_16x16x16_bf16 v[56:59], v[30:31], v[224:225], v[56:59]
    v_mfma_f32_16x16x16_bf16 v[60:63], v[30:31], v[226:227], v[60:63]
    v_mov_b32_dpp v32, v36 row_ror:8 row_mask:0xf bank_mask:0x1
    v_mov_b32_dpp v33, v36 quad_perm:[0,1,2,3] row_mask:0xf bank_mask:0x4
    v_mov_b32_dpp v34, v36 row_ror:4 row_mask:0xf bank_mask:0x1
    v_mov_b32_dpp v35, v36 row_ror:12 row_mask:0xf bank_mask:0x4
    v_mov_b32_dpp v32, v37 row_ror:12 row_mask:0xf bank_mask:0x2
    v_mov_b32_dpp v33, v37 row_ror:4 row_mask:0xf bank_mask:0x8
    v_mov_b32_dpp v34, v37 row_ror:8 row_mask:0xf bank_mask:0x2
    v_mov_b32_dpp v35, v37 quad_perm:[0,1,2,3] row_mask:0xf bank_mask:0x8
    s_cmp_gt_u32 s76, 15
    s_cbranch_scc1 L_bo_171
    s_waitcnt vmcnt(4)
L_bo_171:
    s_waitcnt vmcnt(5)
    buffer_load_dwordx4 v[252:255], v2, s[12:15], s57 offen nt
    s_add_u32 s57, s57, 4096
    v_mfma_f32_16x16x16_bf16 v[56:59], v[32:33], v[228:229], v[56:59]
    v_mfma_f32_16x16x16_bf16 v[60:63], v[32:33], v[230:231], v[60:63]
    s_cmp_gt_u32 s76, 16
    s_cbranch_scc1 L_bo_173
    s_waitcnt vmcnt(4)
L_bo_173:
    s_waitcnt vmcnt(5)
    buffer_load_dwordx4 v[64:67], v2, s[12:15], s57 offen nt
    s_add_u32 s57, s57, 4096
    v_mfma_f32_16x16x16_bf16 v[56:59], v[34:35], v[232:233], v[56:59]
    v_mfma_f32_16x16x16_bf16 v[60:63], v[34:35], v[234:235], v[60:63]
    v_mul_f32 v49, v15, v48
    v_cvt_pk_bf16_f32 v36, v49, 0
    v_cvt_pk_bf16_f32 v37, 0, v49
    s_nop 0
    v_mov_b32_dpp v28, v36 quad_perm:[0,1,2,3] row_mask:0xf bank_mask:0x1
    v_mov_b32_dpp v29, v36 row_ror:8 row_mask:0xf bank_mask:0x4
    v_mov_b32_dpp v30, v36 row_ror:12 row_mask:0xf bank_mask:0x1
    v_mov_b32_dpp v31, v36 row_ror:4 row_mask:0xf bank_mask:0x4
    v_mov_b32_dpp v28, v37 row_ror:4 row_mask:0xf bank_mask:0x2
    v_mov_b32_dpp v29, v37 row_ror:12 row_mask:0xf bank_mask:0x8
    v_mov_b32_dpp v30, v37 quad_perm:[0,1,2,3] row_mask:0xf bank_mask:0x2
    v_mov_b32_dpp v31, v37 row_ror:8 row_mask:0xf bank_mask:0x8
    s_cmp_gt_u32 s76, 17
    s_cbranch_scc1 L_bo_175
    s_waitcnt vmcnt(4)
L_bo_175:
    s_waitcnt vmcnt(5)
    buffer_load_dwordx4 v[68:71], v2, s[12:15], s57 offen nt
    s_add_u32 s57, s57, 4096
    v_mfma_f32_16x16x16_bf16 v[56:59], v[28:29], v[236:237], v[56:59]
    v_mfma_f32_16x16x16_bf16 v[60:63], v[28:29], v[238:239], v[60:63]
    s_cmp_gt_u32 s76, 18
    s_cbranch_scc1 L_bo_177
    s_waitcnt vmcnt(4)
L_bo_177:
    s_waitcnt vmcnt(5)
    buffer_load_dwordx4 v[72:75], v2, s[12:15], s57 offen nt
    s_add_u32 s57, s57, 4096
    v_mfma_f32_16x16x16_bf16 v[56:59], v[30:31], v[240:241], v[56:59]
    v_mfma_f32_16x16x16_bf16 v[60:63], v[30:31], v[242:243], v[60:63]
    v_mov_b32_dpp v32, v36 row_ror:8 row_mask:0xf bank_mask:0x1
    v_mov_b32_dpp v33, v36 quad_perm:[0,1,2,3] row_mask:0xf bank_mask:0x4
    v_mov_b32_dpp v34, v36 row_ror:4 row_mask:0xf bank_mask:0x1
    v_mov_b32_dpp v35, v36 row_ror:12 row_mask:0xf bank_mask:0x4
    v_mov_b32_dpp v32, v37 row_ror:12 row_mask:0xf bank_mask:0x2
    v_mov_b32_dpp v33, v37 row_ror:4 row_mask:0xf bank_mask:0x8
    v_mov_b32_dpp v34, v37 row_ror:8 row_mask:0xf bank_mask:0x2
    v_mov_b32_dpp v35, v37 quad_perm:[0,1,2,3] row_mask:0xf bank_mask:0x8
    s_cmp_gt_u32 s76, 19
    s_cbranch_scc1 L_bo_179
    s_waitcnt vmcnt(4)
L_bo_179:
    s_waitcnt vmcnt(5)
    buffer_load_dwordx4 v[76:79], v2, s[12:15], s57 offen nt
    s_add_u32 s57, s57, 4096
    v_mfma_f32_16x16x16_bf16 v[56:59], v[32:33], v[244:245], v[56:59]
    v_mfma_f32_16x16x16_bf16 v[60:63], v[32:33], v[246:247], v[60:63]
    s_cmp_gt_u32 s76, 20
    s_cbranch_scc1 L_bo_181
    s_waitcnt vmcnt(4)
L_bo_181:
    s_waitcnt vmcnt(5)
    buffer_load_dwordx4 v[80:83], v2, s[12:15], s57 offen nt
    s_add_u32 s57, s57, 4096
    s_mov_b64 exec, 1
    ds_add_u32 v25, v26 offset:16
    s_mov_b64 exec, -1
    v_mfma_f32_16x16x16_bf16 v[56:59], v[34:35], v[248:249], v[56:59]
    v_mfma_f32_16x16x16_bf16 v[60:63], v[34:35], v[250:251], v[60:63]
    v_mul_f32 v49, v16, v48
    v_cvt_pk_bf16_f32 v36, v49, 0
    v_cvt_pk_bf16_f32 v37, 0, v49
    s_nop 0
    v_mov_b32_dpp v28, v36 quad_perm:[0,1,2,3] row_mask:0xf bank_mask:0x1
    v_mov_b32_dpp v29, v36 row_ror:8 row_mask:0xf bank_mask:0x4
    v_mov_b32_dpp v30, v36 row_ror:12 row_mask:0xf bank_mask:0x1
    v_mov_b32_dpp v31, v36 row_ror:4 row_mask:0xf bank_mask:0x4
    v_mov_b32_dpp v28, v37 row_ror:4 row_mask:0xf bank_mask:0x2
    v_mov_b32_dpp v29, v37 row_ror:12 row_mask:0xf bank_mask:0x8
    v_mov_b32_dpp v30, v37 quad_perm:[0,1,2,3] row_mask:0xf bank_mask:0x2
    v_mov_b32_dpp v31, v37 row_ror:8 row_mask:0xf bank_mask:0x8
    s_cmp_gt_u32 s76, 21
    s_cbranch_scc1 L_bo_183
    s_waitcnt vmcnt(4)
L_bo_183:
    s_waitcnt vmcnt(5)
    buffer_load_dwordx4 v[84:87], v2, s[12:15], s57 offen nt
    s_add_u32 s57, s57, 4096
    v_mfma_f32_16x16x16_bf16 v[56:59], v[28:29], v[252:253], v[56:59]
    v_mfma_f32_16x16x16_bf16 v[60:63], v[28:29], v[254:255], v[60:63]
    s_cmp_gt_u32 s76, 22
    s_cbranch_scc1 L_bo_185
    s_waitcnt vmcnt(4)
L_bo_185:
    s_waitcnt vmcnt(5)
    buffer_load_dwordx4 v[88:91], v2, s[12:15], s57 offen nt
    s_add_u32 s57, s57, 4096
    v_mfma_f32_16x16x16_bf16 v[56:59], v[30:31], v[64:65], v[56:59]
    v_mfma_f32_16x16x16_bf16 v[60:63], v[30:31], v[66:67], v[60:63]
    v_mov_b32_dpp v32, v36 row_ror:8 row_mask:0xf bank_mask:0x1
    v_mov_b32_dpp v33, v36 quad_perm:[0,1,2,3] row_mask:0xf bank_mask:0x4
    v_mov_b32_dpp v34, v36 row_ror:4 row_mask:0xf bank_mask:0x1
    v_mov_b32_dpp v35, v36 row_ror:12 row_mask:0xf bank_mask:0x4
    v_mov_b32_dpp v32, v37 row_ror:12 row_mask:0xf bank_mask:0x2
    v_mov_b32_dpp v33, v37 row_ror:4 row_mask:0xf bank_mask:0x8
    v_mov_b32_dpp v34, v37 row_ror:8 row_mask:0xf bank_mask:0x2
    v_mov_b32_dpp v35, v37 quad_perm:[0,1,2,3] row_mask:0xf bank_mask:0x8
    s_cmp_gt_u32 s76, 23
    s_cbranch_scc1 L_bo_187
    s_waitcnt vmcnt(4)
L_bo_187:
    s_waitcnt vmcnt(5)
    buffer_load_dwordx4 v[92:95], v2, s[12:15], s57 offen nt
    s_add_u32 s57, s57, 4096
    v_mfma_f32_16x16x16_bf16 v[56:59], v[32:33], v[68:69], v[56:59]
    v_mfma_f32_16x16x16_bf16 v[60:63], v[32:33], v[70:71], v[60:63]
    s_cmp_gt_u32 s76, 24
    s_cbranch_scc1 L_bo_189
    s_waitcnt vmcnt(4)
L_bo_189:
    s_waitcnt vmcnt(5)
    buffer_load_dwordx4 v[96:99], v2, s[12:15], s57 offen nt
    s_add_u32 s57, s57, 4096
    v_mfma_f32_16x16x16_bf16 v[56:59], v[34:35], v[72:73], v[56:59]
    v_mfma_f32_16x16x16_bf16 v[60:63], v[34:35], v[74:75], v[60:63]
    v_mul_f32 v49, v17, v48
    v_cvt_pk_bf16_f32 v36, v49, 0
    v_cvt_pk_bf16_f32 v37, 0, v49
    s_nop 0
    v_mov_b32_dpp v28, v36 quad_perm:[0,1,2,3] row_mask:0xf bank_mask:0x1
    v_mov_b32_dpp v29, v36 row_ror:8 row_mask:0xf bank_mask:0x4
    v_mov_b32_dpp v30, v36 row_ror:12 row_mask:0xf bank_mask:0x1
    v_mov_b32_dpp v31, v36 row_ror:4 row_mask:0xf bank_mask:0x4
    v_mov_b32_dpp v28, v37 row_ror:4 row_mask:0xf bank_mask:0x2
    v_mov_b32_dpp v29, v37 row_ror:12 row_mask:0xf bank_mask:0x8
    v_mov_b32_dpp v30, v37 quad_perm:[0,1,2,3] row_mask:0xf bank_mask:0x2
    v_mov_b32_dpp v31, v37 row_ror:8 row_mask:0xf bank_mask:0x8
    s_cmp_gt_u32 s76, 25
    s_cbranch_scc1 L_bo_191
    s_waitcnt vmcnt(4)
L_bo_191:
    s_waitcnt vmcnt(5)
    buffer_load_dwordx4 v[100:103], v2, s[12:15], s57 offen nt
    s_add_u32 s57, s57, 4096
    v_mfma_f32_16x16x16_bf16 v[56:59], v[28:29], v[76:77], v[56:59]
    v_mfma_f32_16x16x16_bf16 v[60:63], v[28:29], v[78:79], v[60:63]
    s_cmp_gt_u32 s76, 26
    s_cbranch_scc1 L_bo_193
    s_waitcnt vmcnt(4)
L_bo_193:
    s_waitcnt vmcnt(5)
    buffer_load_dwordx4 v[104:107], v2, s[12:15], s57 offen nt
    s_add_u32 s57, s57, 4096
    v_mfma_f32_16x16x16_bf16 v[56:59], v[30:31], v[80:81], v[56:59]
    v_mfma_f32_16x16x16_bf16 v[60:63], v[30:31], v[82:83], v[60:63]
    v_mov_b32_dpp v32, v36 row_ror:8 row_mask:0xf bank_mask:0x1
    v_mov_b32_dpp v33, v36 quad_perm:[0,1,2,3] row_mask:0xf bank_mask:0x4
    v_mov_b32_dpp v34, v36 row_ror:4 row_mask:0xf bank_mask:0x1
    v_mov_b32_dpp v35, v36 row_ror:12 row_mask:0xf bank_mask:0x4
    v_mov_b32_dpp v32, v37 row_ror:12 row_mask:0xf bank_mask:0x2
    v_mov_b32_dpp v33, v37 row_ror:4 row_mask:0xf bank_mask:0x8
    v_mov_b32_dpp v34, v37 row_ror:8 row_mask:0xf bank_mask:0x2
    v_mov_b32_dpp v35, v37 quad_perm:[0,1,2,3] row_mask:0xf bank_mask:0x8
    s_cmp_gt_u32 s76, 27
    s_cbranch_scc1 L_bo_195
    s_waitcnt vmcnt(4)
L_bo_195:
    s_waitcnt vmcnt(5)
    buffer_load_dwordx4 v[108:111], v2, s[12:15], s57 offen nt
    s_add_u32 s57, s57, 4096
    v_mfma_f32_16x16x16_bf16 v[56:59], v[32:33], v[84:85], v[56:59]
    v_mfma_f32_16x16x16_bf16 v[60:63], v[32:33], v[86:87], v[60:63]
    s_cmp_gt_u32 s76, 28
    s_cbranch_scc1 L_bo_197
    s_waitcnt vmcnt(4)
L_bo_197:
    s_waitcnt vmcnt(5)
    buffer_load_dwordx4 v[112:115], v2, s[12:15], s57 offen nt
    s_add_u32 s57, s57, 4096
    v_mfma_f32_16x16x16_bf16 v[56:59], v[34:35], v[88:89], v[56:59]
    v_mfma_f32_16x16x16_bf16 v[60:63], v[34:35], v[90:91], v[60:63]
    v_mul_f32 v49, v18, v48
    v_cvt_pk_bf16_f32 v36, v49, 0
    v_cvt_pk_bf16_f32 v37, 0, v49
    s_nop 0
    v_mov_b32_dpp v28, v36 quad_perm:[0,1,2,3] row_mask:0xf bank_mask:0x1
    v_mov_b32_dpp v29, v36 row_ror:8 row_mask:0xf bank_mask:0x4
    v_mov_b32_dpp v30, v36 row_ror:12 row_mask:0xf bank_mask:0x1
    v_mov_b32_dpp v31, v36 row_ror:4 row_mask:0xf bank_mask:0x4
    v_mov_b32_dpp v28, v37 row_ror:4 row_mask:0xf bank_mask:0x2
    v_mov_b32_dpp v29, v37 row_ror:12 row_mask:0xf bank_mask:0x8
    v_mov_b32_dpp v30, v37 quad_perm:[0,1,2,3] row_mask:0xf bank_mask:0x2
    v_mov_b32_dpp v31, v37 row_ror:8 row_mask:0xf bank_mask:0x8
    s_cmp_gt_u32 s76, 29
    s_cbranch_scc1 L_bo_199
    s_waitcnt vmcnt(4)
L_bo_199:
    s_waitcnt vmcnt(5)
    buffer_load_dwordx4 v[116:119], v2, s[12:15], s57 offen nt
    s_add_u32 s57, s57, 4096
    v_mfma_f32_16x16x16_bf16 v[56:59], v[28:29], v[92:93], v[56:59]
    v_mfma_f32_16x16x16_bf16 v[60:63], v[28:29], v[94:95], v[60:63]
    s_cmp_gt_u32 s76, 30
    s_cbranch_scc1 L_bo_201
    s_waitcnt vmcnt(4)
L_bo_201:
    s_waitcnt vmcnt(5)
    buffer_load_dwordx4 v[120:123], v2, s[12:15], s57 offen nt
    s_add_u32 s57, s57, 4096
    v_mfma_f32_16x16x16_bf16 v[56:59], v[30:31], v[96:97], v[56:59]
    v_mfma_f32_16x16x16_bf16 v[60:63], v[30:31], v[98:99], v[60:63]
    v_mov_b32_dpp v32, v36 row_ror:8 row_mask:0xf bank_mask:0x1
    v_mov_b32_dpp v33, v36 quad_perm:[0,1,2,3] row_mask:0xf bank_mask:0x4
    v_mov_b32_dpp v34, v36 row_ror:4 row_mask:0xf bank_mask:0x1
    v_mov_b32_dpp v35, v36 row_ror:12 row_mask:0xf bank_mask:0x4
    v_mov_b32_dpp v32, v37 row_ror:12 row_mask:0xf bank_mask:0x2
    v_mov_b32_dpp v33, v37 row_ror:4 row_mask:0xf bank_mask:0x8
    v_mov_b32_dpp v34, v37 row_ror:8 row_mask:0xf bank_mask:0x2
    v_mov_b32_dpp v35, v37 quad_perm:[0,1,2,3] row_mask:0xf bank_mask:0x8
    s_cmp_gt_u32 s76, 31
    s_cbranch_scc1 L_bo_203
    s_waitcnt vmcnt(4)
L_bo_203:
    s_waitcnt vmcnt(5)
    buffer_load_dwordx4 v[124:127], v2, s[12:15], s57 offen nt
    s_add_u32 s57, s57, 4096
    v_mfma_f32_16x16x16_bf16 v[56:59], v[32:33], v[100:101], v[56:59]
    v_mfma_f32_16x16x16_bf16 v[60:63], v[32:33], v[102:103], v[60:63]
    s_waitcnt vmcnt(4)
    buffer_load_dwordx4 v[128:131], v2, s[12:15], s57 offen nt
    s_add_u32 s57, s57, 4096
    v_mfma_f32_16x16x16_bf16 v[56:59], v[34:35], v[104:105], v[56:59]
    v_mfma_f32_16x16x16_bf16 v[60:63], v[34:35], v[106:107], v[60:63]
    v_mul_f32 v49, v19, v48
    v_cvt_pk_bf16_f32 v36, v49, 0
    v_cvt_pk_bf16_f32 v37, 0, v49
    s_nop 0
    v_mov_b32_dpp v28, v36 quad_perm:[0,1,2,3] row_mask:0xf bank_mask:0x1
    v_mov_b32_dpp v29, v36 row_ror:8 row_mask:0xf bank_mask:0x4
    v_mov_b32_dpp v30, v36 row_ror:12 row_mask:0xf bank_mask:0x1
    v_mov_b32_dpp v31, v36 row_ror:4 row_mask:0xf bank_mask:0x4
    v_mov_b32_dpp v28, v37 row_ror:4 row_mask:0xf bank_mask:0x2
    v_mov_b32_dpp v29, v37 row_ror:12 row_mask:0xf bank_mask:0x8
    v_mov_b32_dpp v30, v37 quad_perm:[0,1,2,3] row_mask:0xf bank_mask:0x2
    v_mov_b32_dpp v31, v37 row_ror:8 row_mask:0xf bank_mask:0x8
    v_mfma_f32_16x16x16_bf16 v[56:59], v[28:29], v[108:109], v[56:59]
    v_mfma_f32_16x16x16_bf16 v[60:63], v[28:29], v[110:111], v[60:63]
    s_waitcnt vmcnt(4)
    buffer_load_dwordx4 v[132:135], v2, s[12:15], s57 offen nt
    s_add_u32 s57, s57, 4096
    v_mfma_f32_16x16x16_bf16 v[56:59], v[30:31], v[112:113], v[56:59]
    v_mfma_f32_16x16x16_bf16 v[60:63], v[30:31], v[114:115], v[60:63]
    v_mov_b32_dpp v32, v36 row_ror:8 row_mask:0xf bank_mask:0x1
    v_mov_b32_dpp v33, v36 quad_perm:[0,1,2,3] row_mask:0xf bank_mask:0x4
    v_mov_b32_dpp v34, v36 row_ror:4 row_mask:0xf bank_mask:0x1
    v_mov_b32_dpp v35, v36 row_ror:12 row_mask:0xf bank_mask:0x4
    v_mov_b32_dpp v32, v37 row_ror:12 row_mask:0xf bank_mask:0x2
    v_mov_b32_dpp v33, v37 row_ror:4 row_mask:0xf bank_mask:0x8
    v_mov_b32_dpp v34, v37 row_ror:8 row_mask:0xf bank_mask:0x2
    v_mov_b32_dpp v35, v37 quad_perm:[0,1,2,3] row_mask:0xf bank_mask:0x8
    buffer_load_dwordx4 v[136:139], v2, s[12:15], s57 offen nt
    s_add_u32 s57, s57, 4096
    buffer_load_dwordx4 v[140:143], v2, s[12:15], s57 offen nt
    s_add_u32 s57, s57, 4096
    buffer_load_dwordx4 v[144:147], v2, s[12:15], s57 offen nt
    s_add_u32 s57, s57, 4096
    buffer_load_dwordx4 v[148:151], v2, s[12:15], s57 offen nt
    s_add_u32 s57, s57, 4096
    buffer_load_dwordx4 v[152:155], v2, s[12:15], s57 offen nt
    s_add_u32 s57, s57, 4096
    buffer_load_dwordx4 v[156:159], v2, s[12:15], s57 offen nt
    s_add_u32 s57, s57, 4096
    buffer_load_dwordx4 v[160:163], v2, s[12:15], s57 offen nt
    s_add_u32 s57, s57, 4096
    s_waitcnt vmcnt(11)
    buffer_load_dwordx4 v[164:167], v2, s[12:15], s57 offen nt
    s_add_u32 s57, s57, 4096
    v_mfma_f32_16x16x16_bf16 v[56:59], v[32:33], v[116:117], v[56:59]
    v_mfma_f32_16x16x16_bf16 v[60:63], v[32:33], v[118:119], v[60:63]
    s_waitcnt vmcnt(11)
    buffer_load_dwordx4 v[168:171], v2, s[12:15], s57 offen nt
    s_add_u32 s57, s57, 4096
    v_mfma_f32_16x16x16_bf16 v[56:59], v[34:35], v[120:121], v[56:59]
    v_mfma_f32_16x16x16_bf16 v[60:63], v[34:35], v[122:123], v[60:63]
    v_mul_f32 v49, v20, v48
    v_cvt_pk_bf16_f32 v36, v49, 0
    v_cvt_pk_bf16_f32 v37, 0, v49
    s_nop 0
    v_mov_b32_dpp v28, v36 quad_perm:[0,1,2,3] row_mask:0xf bank_mask:0x1
    v_mov_b32_dpp v29, v36 row_ror:8 row_mask:0xf bank_mask:0x4
    v_mov_b32_dpp v30, v36 row_ror:12 row_mask:0xf bank_mask:0x1
    v_mov_b32_dpp v31, v36 row_ror:4 row_mask:0xf bank_mask:0x4
    v_mov_b32_dpp v28, v37 row_ror:4 row_mask:0xf bank_mask:0x2
    v_mov_b32_dpp v29, v37 row_ror:12 row_mask:0xf bank_mask:0x8
    v_mov_b32_dpp v30, v37 quad_perm:[0,1,2,3] row_mask:0xf bank_mask:0x2
    v_mov_b32_dpp v31, v37 row_ror:8 row_mask:0xf bank_mask:0x8
    s_waitcnt vmcnt(11)
    buffer_load_dwordx4 v[172:175], v2, s[12:15], s57 offen nt
    s_add_u32 s57, s57, 4096
    v_mfma_f32_16x16x16_bf16 v[56:59], v[28:29], v[124:125], v[56:59]
    v_mfma_f32_16x16x16_bf16 v[60:63], v[28:29], v[126:127], v[60:63]
    s_waitcnt vmcnt(11)
    buffer_load_dwordx4 v[176:179], v2, s[12:15], s57 offen nt
    s_add_u32 s57, s57, 4096
    v_mfma_f32_16x16x16_bf16 v[56:59], v[30:31], v[128:129], v[56:59]
    v_mfma_f32_16x16x16_bf16 v[60:63], v[30:31], v[130:131], v[60:63]
    v_mov_b32_dpp v32, v36 row_ror:8 row_mask:0xf bank_mask:0x1
    v_mov_b32_dpp v33, v36 quad_perm:[0,1,2,3] row_mask:0xf bank_mask:0x4
    v_mov_b32_dpp v34, v36 row_ror:4 row_mask:0xf bank_mask:0x1
    v_mov_b32_dpp v35, v36 row_ror:12 row_mask:0xf bank_mask:0x4
    v_mov_b32_dpp v32, v37 row_ror:12 row_mask:0xf bank_mask:0x2
    v_mov_b32_dpp v33, v37 row_ror:4 row_mask:0xf bank_mask:0x8
    v_mov_b32_dpp v34, v37 row_ror:8 row_mask:0xf bank_mask:0x2
    v_mov_b32_dpp v35, v37 quad_perm:[0,1,2,3] row_mask:0xf bank_mask:0x8
    s_waitcnt vmcnt(11)
    buffer_load_dwordx4 v[180:183], v2, s[12:15], s57 offen nt
    s_mov_b64 exec, 1
    ds_add_u32 v25, v26 offset:20
    s_mov_b64 exec, -1
    v_mfma_f32_16x16x16_bf16 v[56:59], v[32:33], v[132:133], v[56:59]
    v_mfma_f32_16x16x16_bf16 v[60:63], v[32:33], v[134:135], v[60:63]
    s_waitcnt vmcnt(11)
    v_mfma_f32_16x16x16_bf16 v[56:59], v[34:35], v[136:137], v[56:59]
    v_mfma_f32_16x16x16_bf16 v[60:63], v[34:35], v[138:139], v[60:63]
    v_mul_f32 v49, v21, v48
    v_cvt_pk_bf16_f32 v36, v49, 0
    v_cvt_pk_bf16_f32 v37, 0, v49
    s_nop 0
    v_mov_b32_dpp v28, v36 quad_perm:[0,1,2,3] row_mask:0xf bank_mask:0x1
    v_mov_b32_dpp v29, v36 row_ror:8 row_mask:0xf bank_mask:0x4
    v_mov_b32_dpp v30, v36 row_ror:12 row_mask:0xf bank_mask:0x1
    v_mov_b32_dpp v31, v36 row_ror:4 row_mask:0xf bank_mask:0x4
    v_mov_b32_dpp v28, v37 row_ror:4 row_mask:0xf bank_mask:0x2
    v_mov_b32_dpp v29, v37 row_ror:12 row_mask:0xf bank_mask:0x8
    v_mov_b32_dpp v30, v37 quad_perm:[0,1,2,3] row_mask:0xf bank_mask:0x2
    v_mov_b32_dpp v31, v37 row_ror:8 row_mask:0xf bank_mask:0x8
    s_waitcnt vmcnt(10)
    v_mfma_f32_16x16x16_bf16 v[56:59], v[28:29], v[140:141], v[56:59]
    v_mfma_f32_16x16x16_bf16 v[60:63], v[28:29], v[142:143], v[60:63]
    s_waitcnt vmcnt(9)
    v_mfma_f32_16x16x16_bf16 v[56:59], v[30:31], v[144:145], v[56:59]
    v_mfma_f32_16x16x16_bf16 v[60:63], v[30:31], v[146:147], v[60:63]
    v_mov_b32_dpp v32, v36 row_ror:8 row_mask:0xf bank_mask:0x1
    v_mov_b32_dpp v33, v36 quad_perm:[0,1,2,3] row_mask:0xf bank_mask:0x4
    v_mov_b32_dpp v34, v36 row_ror:4 row_mask:0xf bank_mask:0x1
    v_mov_b32_dpp v35, v36 row_ror:12 row_mask:0xf bank_mask:0x4
    v_mov_b32_dpp v32, v37 row_ror:12 row_mask:0xf bank_mask:0x2
    v_mov_b32_dpp v33, v37 row_ror:4 row_mask:0xf bank_mask:0x8
    v_mov_b32_dpp v34, v37 row_ror:8 row_mask:0xf bank_mask:0x2
    v_mov_b32_dpp v35, v37 quad_perm:[0,1,2,3] row_mask:0xf bank_mask:0x8
    s_waitcnt vmcnt(8)
    v_mfma_f32_16x16x16_bf16 v[56:59], v[32:33], v[148:149], v[56:59]
    v_mfma_f32_16x16x16_bf16 v[60:63], v[32:33], v[150:151], v[60:63]
    s_waitcnt vmcnt(7)
    v_mfma_f32_16x16x16_bf16 v[56:59], v[34:35], v[152:153], v[56:59]
    v_mfma_f32_16x16x16_bf16 v[60:63], v[34:35], v[154:155], v[60:63]
    v_mul_f32 v49, v22, v48
    v_cvt_pk_bf16_f32 v36, v49, 0
    v_cvt_pk_bf16_f32 v37, 0, v49
    s_nop 0
    v_mov_b32_dpp v28, v36 quad_perm:[0,1,2,3] row_mask:0xf bank_mask:0x1
    v_mov_b32_dpp v29, v36 row_ror:8 row_mask:0xf bank_mask:0x4
    v_mov_b32_dpp v30, v36 row_ror:12 row_mask:0xf bank_mask:0x1
    v_mov_b32_dpp v31, v36 row_ror:4 row_mask:0xf bank_mask:0x4
    v_mov_b32_dpp v28, v37 row_ror:4 row_mask:0xf bank_mask:0x2
    v_mov_b32_dpp v29, v37 row_ror:12 row_mask:0xf bank_mask:0x8
    v_mov_b32_dpp v30, v37 quad_perm:[0,1,2,3] row_mask:0xf bank_mask:0x2
    v_mov_b32_dpp v31, v37 row_ror:8 row_mask:0xf bank_mask:0x8
    s_waitcnt vmcnt(6)
    v_mfma_f32_16x16x16_bf16 v[56:59], v[28:29], v[156:157], v[56:59]
    v_mfma_f32_16x16x16_bf16 v[60:63], v[28:29], v[158:159], v[60:63]
    s_waitcnt vmcnt(5)
    v_mfma_f32_16x16x16_bf16 v[56:59], v[30:31], v[160:161], v[56:59]
    v_mfma_f32_16x16x16_bf16 v[60:63], v[30:31], v[162:163], v[60:63]
    v_mov_b32_dpp v32, v36 row_ror:8 row_mask:0xf bank_mask:0x1
    v_mov_b32_dpp v33, v36 quad_perm:[0,1,2,3] row_mask:0xf bank_mask:0x4
    v_mov_b32_dpp v34, v36 row_ror:4 row_mask:0xf bank_mask:0x1
    v_mov_b32_dpp v35, v36 row_ror:12 row_mask:0xf bank_mask:0x4
    v_mov_b32_dpp v32, v37 row_ror:12 row_mask:0xf bank_mask:0x2
    v_mov_b32_dpp v33, v37 row_ror:4 row_mask:0xf bank_mask:0x8
    v_mov_b32_dpp v34, v37 row_ror:8 row_mask:0xf bank_mask:0x2
    v_mov_b32_dpp v35, v37 quad_perm:[0,1,2,3] row_mask:0xf bank_mask:0x8
    s_waitcnt vmcnt(4)
    v_mfma_f32_16x16x16_bf16 v[56:59], v[32:33], v[164:165], v[56:59]
    v_mfma_f32_16x16x16_bf16 v[60:63], v[32:33], v[166:167], v[60:63]
    s_waitcnt vmcnt(3)
    v_mfma_f32_16x16x16_bf16 v[56:59], v[34:35], v[168:169], v[56:59]
    v_mfma_f32_16x16x16_bf16 v[60:63], v[34:35], v[170:171], v[60:63]
    v_mul_f32 v49, v23, v48
    v_cvt_pk_bf16_f32 v36, v49, 0
    v_cvt_pk_bf16_f32 v37, 0, v49
    s_nop 0
    v_mov_b32_dpp v28, v36 quad_perm:[0,1,2,3] row_mask:0xf bank_mask:0x1
    v_mov_b32_dpp v29, v36 row_ror:8 row_mask:0xf bank_mask:0x4
    v_mov_b32_dpp v30, v36 row_ror:12 row_mask:0xf bank_mask:0x1
    v_mov_b32_dpp v31, v36 row_ror:4 row_mask:0xf bank_mask:0x4
    v_mov_b32_dpp v28, v37 row_ror:4 row_mask:0xf bank_mask:0x2
    v_mov_b32_dpp v29, v37 row_ror:12 row_mask:0xf bank_mask:0x8
    v_mov_b32_dpp v30, v37 quad_perm:[0,1,2,3] row_mask:0xf bank_mask:0x2
    v_mov_b32_dpp v31, v37 row_ror:8 row_mask:0xf bank_mask:0x8
    s_waitcnt vmcnt(2)
    v_mfma_f32_16x16x16_bf16 v[56:59], v[28:29], v[172:173], v[56:59]
    v_mfma_f32_16x16x16_bf16 v[60:63], v[28:29], v[174:175], v[60:63]
    s_waitcnt vmcnt(1)
    v_mfma_f32_16x16x16_bf16 v[56:59], v[30:31], v[176:177], v[56:59]
    v_mfma_f32_16x16x16_bf16 v[60:63], v[30:31], v[178:179], v[60:63]
    v_mov_b32_dpp v32, v36 row_ror:8 row_mask:0xf bank_mask:0x1
    v_mov_b32_dpp v33, v36 quad_perm:[0,1,2,3] row_mask:0xf bank_mask:0x4
    s_nop 0
    v_mov_b32_dpp v32, v37 row_ror:12 row_mask:0xf bank_mask:0x2
    v_mov_b32_dpp v33, v37 row_ror:4 row_mask:0xf bank_mask:0x8
    s_waitcnt vmcnt(0)
    s_nop 0
    v_mfma_f32_16x16x16_bf16 v[56:59], v[32:33], v[180:181], v[56:59]
    v_mfma_f32_16x16x16_bf16 v[60:63], v[32:33], v[182:183], v[60:63]
    s_cmp_ge_u32 s3, 2
    s_nop 5
    ds_write_b128 v3, v[56:59]
    ds_write_b128 v3, v[60:63] offset:1024
    s_mov_b64 exec, 1
    ds_add_u32 v25, v26 offset:28
    s_mov_b64 exec, -1
L_stail:
    s_cbranch_scc1 L_noop
    s_mov_b32 s7, 0
L_fl_205:
    ds_read_b32 v27, v25 offset:28
    ds_read_b128 v[8:11], v51 offset:0
    ds_read_b128 v[12:15], v51 offset:2048
    ds_read_b128 v[16:19], v51 offset:4096
    ds_read_b128 v[20:23], v51 offset:6144
    s_add_u32 s7, s7, 1
    s_cmp_gt_u32 s7, 33554432
    s_cbranch_scc1 L_flok_206
    s_waitcnt lgkmcnt(4)
    v_cmp_le_u32 vcc, 4, v27
    s_cbranch_vccnz L_flok_206
    s_waitcnt lgkmcnt(0)
    s_branch L_fl_205
L_flok_206:
    s_waitcnt lgkmcnt(2)
    v_pk_add_f32 v[8:9], v[8:9], v[12:13]
    v_pk_add_f32 v[10:11], v[10:11], v[14:15]
    s_waitcnt lgkmcnt(0)
    v_pk_add_f32 v[16:17], v[16:17], v[20:21]
    v_pk_add_f32 v[18:19], v[18:19], v[22:23]
    v_pk_add_f32 v[8:9], v[8:9], v[16:17]
    v_pk_add_f32 v[10:11], v[10:11], v[18:19]
    s_cmp_lg_u32 s63, 0
    s_cbranch_scc1 L_sa_207
    buffer_store_dwordx4 v[8:11], v2, s[16:19], s61 offen sc1
    s_branch L_sb_208
L_sa_207:
    buffer_store_dwordx4 v[8:11], v2, s[16:19], s61 offen
L_sb_208:
    s_mov_b64 exec, 1
    ds_add_u32 v25, v26 offset:32
    s_mov_b64 exec, -1
L_noop:
    s_cmp_ge_u32 s100, 56
    s_cbranch_scc1 L_sexit
    s_load_dwordx2 s[20:21], s[0:1], 0
    s_load_dwordx2 s[44:45], s[0:1], 72
    s_mov_b32 s22, 1024
    s_mov_b32 s23, 0x20000
    s_mov_b32 s46, 1024
    s_mov_b32 s47, 0x20000
    v_lshrrev_b32 v12, 4, v0
    v_and_b32 v5, 15, v0
    s_lshl_b32 s6, s3, 8
    v_lshlrev_b32 v6, 10, v12
    v_lshl_add_u32 v32, v5, 4, v6
    v_and_b32 v6, 1, v12
    v_lshlrev_b32 v6, 3, v6
    v_lshl_add_u32 v6, v5, 4, v6
    v_add_u32 v13, s6, v6
    v_add_u32 v33, 141312, v13
    s_add_u32 s64, s6, 65536
    s_add_u32 s65, s64, 4096
    s_add_u32 s66, s64, 8192
    s_add_u32 s67, s64, 12288
    s_add_u32 s68, s64, 16384
    s_add_u32 s69, s64, 20480
    s_add_u32 s70, s64, 24576
    s_add_u32 s71, s64, 28672
    v_and_b32 v6, 1, v5
    v_lshlrev_b32 v6, 4, v6
    v_mov_b32 v7, 0x3f80
    v_lshlrev_b32 v6, v6, v7
    v_lshrrev_b32 v7, 1, v5
    v_cmp_eq_u32 vcc, 0, v7
    s_nop 1
    v_cndmask_b32 v40, 0, v6, vcc
    v_cmp_eq_u32 vcc, 1, v7
    s_nop 1
    v_cndmask_b32 v41, 0, v6, vcc
    v_cmp_eq_u32 vcc, 2, v7
    s_nop 1
    v_cndmask_b32 v42, 0, v6, vcc
    v_cmp_eq_u32 vcc, 3, v7
    s_nop 1
    v_cndmask_b32 v43, 0, v6, vcc
    v_lshrrev_b32 v6, 3, v0
    v_lshlrev_b32 v6, 11, v6
    v_and_b32 v7, 7, v0
    v_lshl_add_u32 v34, v7, 4, v6
    s_mul_i32 s101, s4, 3
    s_add_u32 s101, s101, s5
    s_cmp_lt_u32 s5, 3
    s_cselect_b32 s101, s101, 63
    s_and_b32 s72, s101, 15
    s_lshl_b32 s6, s72, 6
    v_lshlrev_b32 v6, 3, v7
    v_lshl_add_u32 v6, v12, 1, v6
    v_add_u32 v35, s6, v6
    v_add_u32 v36, 141312, v35
    s_lshl_b32 s72, s72, 7
    s_add_u32 s72, s72, 131072
    s_waitcnt lgkmcnt(0)
    buffer_load_dwordx2 v[8:9], v13, s[20:23], 0 offen
    buffer_load_dword v10, v13, s[44:47], 0 offen
    s_mov_b32 s7, 0
L_fl_209:
    ds_read_b32 v4, v25 offset:40
    s_add_u32 s7, s7, 1
    s_cmp_gt_u32 s7, 33554432
    s_cbranch_scc1 L_flok_210
    s_waitcnt lgkmcnt(0)
    v_cmp_le_u32 vcc, 4, v4
    s_cbranch_vccnz L_flok_210
    s_sleep 1
    s_branch L_fl_209
L_flok_210:
    s_waitcnt lgkmcnt(0)
    buffer_load_dwordx4 v[64:67], v32, s[16:19], s64 offen sc1
    buffer_load_dwordx4 v[68:71], v32, s[16:19], s65 offen sc1
    buffer_load_dwordx4 v[72:75], v32, s[16:19], s66 offen sc1
    buffer_load_dwordx4 v[76:79], v32, s[16:19], s67 offen sc1
    buffer_load_dwordx4 v[80:83], v32, s[16:19], s68 offen sc1
    buffer_load_dwordx4 v[84:87], v32, s[16:19], s69 offen sc1
    buffer_load_dwordx4 v[88:91], v32, s[16:19], s70 offen sc1
    buffer_load_dwordx4 v[92:95], v32, s[16:19], s71 offen sc1
    s_waitcnt vmcnt(8)
    v_lshlrev_b32 v28, 16, v8
    v_and_b32 v29, s60, v8
    v_lshlrev_b32 v30, 16, v9
    v_and_b32 v31, s60, v9
    s_mov_b32 s7, 0
L_h2_211:
    s_waitcnt vmcnt(0)
    v_mfma_f32_16x16x32_bf16 v[8:11], v[40:43], v[64:67], 0
    v_mfma_f32_16x16x32_bf16 v[8:11], v[40:43], v[68:71], v[8:11]
    v_mfma_f32_16x16x32_bf16 v[8:11], v[40:43], v[72:75], v[8:11]
    v_mfma_f32_16x16x32_bf16 v[8:11], v[40:43], v[76:79], v[8:11]
    v_mfma_f32_16x16x32_bf16 v[8:11], v[40:43], v[80:83], v[8:11]
    v_mfma_f32_16x16x32_bf16 v[8:11], v[40:43], v[84:87], v[8:11]
    v_mfma_f32_16x16x32_bf16 v[8:11], v[40:43], v[88:91], v[8:11]
    v_mfma_f32_16x16x32_bf16 v[8:11], v[40:43], v[92:95], v[8:11]
    s_nop 7
    v_cmp_u_f32 vcc, v8, v9
    v_cmp_u_f32 s[78:79], v10, v11
    s_nop 0
    s_or_b64 vcc, vcc, s[78:79]
    s_cbranch_scc0 L_h2ok_212
    s_add_u32 s7, s7, 1
    s_cmp_gt_u32 s7, 100000
    s_cbranch_scc1 L_h2ok_212
    v_cmp_u_f32 vcc, v64, v65
    v_cmp_u_f32 s[78:79], v66, v67
    s_nop 0
    s_or_b64 exec, vcc, s[78:79]
    s_cbranch_execz L_rs_213
    buffer_load_dwordx4 v[64:67], v32, s[16:19], s64 offen sc1
L_rs_213:
    s_mov_b64 exec, -1
    v_cmp_u_f32 vcc, v68, v69
    v_cmp_u_f32 s[78:79], v70, v71
    s_nop 0
    s_or_b64 exec, vcc, s[78:79]
    s_cbranch_execz L_rs_214
    buffer_load_dwordx4 v[68:71], v32, s[16:19], s65 offen sc1
L_rs_214:
    s_mov_b64 exec, -1
    v_cmp_u_f32 vcc, v72, v73
    v_cmp_u_f32 s[78:79], v74, v75
    s_nop 0
    s_or_b64 exec, vcc, s[78:79]
    s_cbranch_execz L_rs_215
    buffer_load_dwordx4 v[72:75], v32, s[16:19], s66 offen sc1
L_rs_215:
    s_mov_b64 exec, -1
    v_cmp_u_f32 vcc, v76, v77
    v_cmp_u_f32 s[78:79], v78, v79
    s_nop 0
    s_or_b64 exec, vcc, s[78:79]
    s_cbranch_execz L_rs_216
    buffer_load_dwordx4 v[76:79], v32, s[16:19], s67 offen sc1
L_rs_216:
    s_mov_b64 exec, -1
    v_cmp_u_f32 vcc, v80, v81
    v_cmp_u_f32 s[78:79], v82, v83
    s_nop 0
    s_or_b64 exec, vcc, s[78:79]
    s_cbranch_execz L_rs_217
    buffer_load_dwordx4 v[80:83], v32, s[16:19], s68 offen sc1
L_rs_217:
    s_mov_b64 exec, -1
    v_cmp_u_f32 vcc, v84, v85
    v_cmp_u_f32 s[78:79], v86, v87
    s_nop 0
    s_or_b64 exec, vcc, s[78:79]
    s_cbranch_execz L_rs_218
    buffer_load_dwordx4 v[84:87], v32, s[16:19], s69 offen sc1
L_rs_218:
    s_mov_b64 exec, -1
    v_cmp_u_f32 vcc, v88, v89
    v_cmp_u_f32 s[78:79], v90, v91
    s_nop 0
    s_or_b64 exec, vcc, s[78:79]
    s_cbranch_execz L_rs_219
    buffer_load_dwordx4 v[88:91], v32, s[16:19], s70 offen sc1
L_rs_219:
    s_mov_b64 exec, -1
    v_cmp_u_f32 vcc, v92, v93
    v_cmp_u_f32 s[78:79], v94, v95
    s_nop 0
    s_or_b64 exec, vcc, s[78:79]
    s_cbranch_execz L_rs_220
    buffer_load_dwordx4 v[92:95], v32, s[16:19], s71 offen sc1
L_rs_220:
    s_mov_b64 exec, -1
    s_branch L_h2_211
L_h2ok_212:
    v_pk_add_f32 v[8:9], v[8:9], v[28:29]
    v_pk_add_f32 v[10:11], v[10:11], v[30:31]
    v_cvt_pk_bf16_f32 v4, v8, v9
    v_cvt_pk_bf16_f32 v5, v10, v11
    s_mov_b64 exec, 0xffffffff
    ds_write_b64 v33, v[4:5]
    s_mov_b64 exec, -1
    s_waitcnt lgkmcnt(0)
    s_barrier
    s_cmp_ge_u32 s101, 16
    s_cbranch_scc1 L_sexit
    s_cmp_lg_u32 s3, 2
    s_cbranch_scc1 L_sexit
    ds_read_u16 v12, v36
    s_add_u32 s65, s72, 16384
    s_add_u32 s66, s72, 32768
    s_add_u32 s67, s72, 49152
    s_add_u32 s68, s72, 65536
    s_add_u32 s69, s72, 81920
    s_add_u32 s70, s72, 98304
    s_mov_b32 s64, s72
    s_waitcnt lgkmcnt(0)
    v_lshlrev_b32 v12, 16, v12
    s_barrier
    s_sleep 18
    buffer_load_dwordx4 v[64:67], v34, s[16:19], s64 offen sc1
    buffer_load_dwordx4 v[68:71], v34, s[16:19], s65 offen sc1
    buffer_load_dwordx4 v[72:75], v34, s[16:19], s66 offen sc1
    buffer_load_dwordx4 v[76:79], v34, s[16:19], s67 offen sc1
    buffer_load_dwordx4 v[80:83], v34, s[16:19], s68 offen sc1
    buffer_load_dwordx4 v[84:87], v34, s[16:19], s69 offen sc1
    buffer_load_dwordx4 v[88:91], v34, s[16:19], s70 offen sc1
    s_mov_b32 s7, 0
L_h3_221:
    s_waitcnt vmcnt(0)
    v_pk_add_f32 v[4:5], v[64:65], v[68:69]
    v_pk_add_f32 v[6:7], v[66:67], v[70:71]
    v_pk_add_f32 v[8:9], v[72:73], v[76:77]
    v_pk_add_f32 v[10:11], v[74:75], v[78:79]
    v_pk_add_f32 v[16:17], v[80:81], v[84:85]
    v_pk_add_f32 v[18:19], v[82:83], v[86:87]
    v_pk_add_f32 v[4:5], v[4:5], v[88:89]
    v_pk_add_f32 v[6:7], v[6:7], v[90:91]
    v_pk_add_f32 v[8:9], v[8:9], v[16:17]
    v_pk_add_f32 v[10:11], v[10:11], v[18:19]
    v_pk_add_f32 v[4:5], v[4:5], v[8:9]
    v_pk_add_f32 v[6:7], v[6:7], v[10:11]
    v_cmp_u_f32 vcc, v4, v5
    v_cmp_u_f32 s[78:79], v6, v7
    s_nop 0
    s_or_b64 vcc, vcc, s[78:79]
    s_cbranch_scc0 L_h3ok_222
    s_add_u32 s7, s7, 1
    s_cmp_gt_u32 s7, 100000
    s_cbranch_scc1 L_h3ok_222
    v_cmp_u_f32 vcc, v64, v65
    v_cmp_u_f32 s[78:79], v66, v67
    s_nop 0
    s_or_b64 exec, vcc, s[78:79]
    s_cbranch_execz L_rs_223
    buffer_load_dwordx4 v[64:67], v34, s[16:19], s64 offen sc1
L_rs_223:
    s_mov_b64 exec, -1
    v_cmp_u_f32 vcc, v68, v69
    v_cmp_u_f32 s[78:79], v70, v71
    s_nop 0
    s_or_b64 exec, vcc, s[78:79]
    s_cbranch_execz L_rs_224
    buffer_load_dwordx4 v[68:71], v34, s[16:19], s65 offen sc1
L_rs_224:
    s_mov_b64 exec, -1
    v_cmp_u_f32 vcc, v72, v73
    v_cmp_u_f32 s[78:79], v74, v75
    s_nop 0
    s_or_b64 exec, vcc, s[78:79]
    s_cbranch_execz L_rs_225
    buffer_load_dwordx4 v[72:75], v34, s[16:19], s66 offen sc1
L_rs_225:
    s_mov_b64 exec, -1
    v_cmp_u_f32 vcc, v76, v77
    v_cmp_u_f32 s[78:79], v78, v79
    s_nop 0
    s_or_b64 exec, vcc, s[78:79]
    s_cbranch_execz L_rs_226
    buffer_load_dwordx4 v[76:79], v34, s[16:19], s67 offen sc1
L_rs_226:
    s_mov_b64 exec, -1
    v_cmp_u_f32 vcc, v80, v81
    v_cmp_u_f32 s[78:79], v82, v83
    s_nop 0
    s_or_b64 exec, vcc, s[78:79]
    s_cbranch_execz L_rs_227
    buffer_load_dwordx4 v[80:83], v34, s[16:19], s68 offen sc1
L_rs_227:
    s_mov_b64 exec, -1
    v_cmp_u_f32 vcc, v84, v85
    v_cmp_u_f32 s[78:79], v86, v87
    s_nop 0
    s_or_b64 exec, vcc, s[78:79]
    s_cbranch_execz L_rs_228
    buffer_load_dwordx4 v[84:87], v34, s[16:19], s69 offen sc1
L_rs_228:
    s_mov_b64 exec, -1
    v_cmp_u_f32 vcc, v88, v89
    v_cmp_u_f32 s[78:79], v90, v91
    s_nop 0
    s_or_b64 exec, vcc, s[78:79]
    s_cbranch_execz L_rs_229
    buffer_load_dwordx4 v[88:91], v34, s[16:19], s70 offen sc1
L_rs_229:
    s_mov_b64 exec, -1
    s_branch L_h3_221
L_h3ok_222:
    v_permlane32_swap_b32 v4, v6
    v_permlane32_swap_b32 v5, v7
    v_add_f32 v4, v4, v6
    v_add_f32 v5, v5, v7
    s_nop 1
    v_permlane16_swap_b32 v4, v5
    v_add_f32 v4, v4, v5
    s_nop 1
    v_add_f32_dpp v4, v4, v4 row_ror:8 row_mask:0xf bank_mask:0xf
    v_add_f32 v4, v12, v4
    v_cvt_pk_bf16_f32 v4, v4, v4
    s_mov_b32 exec_lo, 0x00ff00ff
    s_mov_b32 exec_hi, 0x00ff00ff
    buffer_store_short v4, v35, s[44:47], 0 offen
L_sexit:
    s_endpgm
L_helper:
    s_load_dwordx2 s[20:21], s[0:1], 0
    s_load_dwordx2 s[24:25], s[0:1], 24
    s_load_dwordx2 s[48:49], s[0:1], 80
    s_load_dwordx2 s[28:29], s[0:1], 32
    s_sub_u32 s3, s3, 4
    s_mov_b32 s22, 1024
    s_mov_b32 s23, 0x20000
    s_mov_b32 s26, 0x400000
    s_mov_b32 s27, 0x20000
    s_mov_b32 s50, 256
    s_mov_b32 s51, 0x20000
    s_mov_b32 s30, 0x400000
    s_mov_b32 s31, 0x20000
    v_lshlrev_b32 v2, 4, v0
    s_mov_b32 s59, 0x3fb8aa3b
    s_mov_b32 s60, 0xffff0000
    s_lshr_b32 s62, s5, 3
    s_and_b32 s63, s5, 7
    s_waitcnt lgkmcnt(0)
    s_load_dwordx2 s[32:33], s[0:1], 48
    s_load_dwordx2 s[36:37], s[0:1], 56
    s_load_dwordx2 s[40:41], s[0:1], 64
    s_mov_b32 s34, 0x1c0000
    s_mov_b32 s35, 0x20000
    s_mov_b32 s38, 0x1c0000
    s_mov_b32 s39, 0x20000
    s_mov_b32 s42, 0x1c0000
    s_mov_b32 s43, 0x20000
    s_lshl_b32 s6, s4, 5
    s_add_u32 s6, s6, s5
    s_lshl_b32 s64, s6, 5
    s_add_u32 s64, s64, 8192
    s_lshl_b32 s66, s6, 11
    s_add_u32 s66, s66, 262144
    s_lshl_b32 s7, s4, 2
    s_add_u32 s7, s7, s62
    s_lshl_b32 s7, s7, 11
    s_lshl_b32 s6, s63, 8
    s_add_u32 s58, s7, s6
    s_add_u32 s58, s58, 786432
    s_lshl_b32 s65, s4, 5
    s_sub_u32 s12, s5, 8
    s_lshl_b32 s13, s4, 4
    s_add_u32 s13, s13, s12
    s_lshl_b32 s13, s13, 8
    s_add_u32 s13, s13, 65536
    s_getreg_b32 s6, hwreg(HW_REG_XCC_ID, 0, 4)
    s_mul_i32 s7, s6, s6
    s_lshl_b32 s7, s7, 18
    s_lshl_b32 s6, s6, 8
    s_or_b32 s6, s6, s7
    s_or_b32 s14, s6, 1
    v_mov_b32 v245, 144000
    s_cmp_lg_u32 s3, 0
    s_cbranch_scc1 L_h123
    buffer_load_dwordx4 v[4:7], v2, s[20:23], 0 offen
    v_lshrrev_b32 v3, 3, v0
    v_lshlrev_b32 v3, 13, v3
    v_and_b32 v1, 7, v0
    v_lshl_add_u32 v3, v1, 4, v3
    s_lshl_b32 s6, s62, 20
    s_lshl_b32 s7, s4, 10
    s_add_u32 s6, s6, s7
    s_lshl_b32 s7, s63, 7
    s_add_u32 s6, s6, s7
    s_mov_b32 m0, 0
    s_nop 0
    buffer_load_dwordx4 v3, s[24:27], s6 offen nt lds
    s_add_u32 s6, s6, 0x10000
    s_mov_b32 m0, 1024
    s_nop 0
    buffer_load_dwordx4 v3, s[24:27], s6 offen nt lds
    s_add_u32 s6, s6, 0x10000
    s_mov_b32 m0, 2048
    s_nop 0
    buffer_load_dwordx4 v3, s[24:27], s6 offen nt lds
    s_add_u32 s6, s6, 0x10000
    s_mov_b32 m0, 3072
    s_nop 0
    buffer_load_dwordx4 v3, s[24:27], s6 offen nt lds
    s_add_u32 s6, s6, 0x10000
    s_barrier
    s_mov_b32 m0, 4096
    s_nop 0
    buffer_load_dwordx4 v3, s[24:27], s6 offen nt lds
    s_add_u32 s6, s6, 0x10000
    s_mov_b32 m0, 5120
    s_nop 0
    buffer_load_dwordx4 v3, s[24:27], s6 offen nt lds
    s_add_u32 s6, s6, 0x10000
    s_mov_b32 m0, 6144
    s_nop 0
    buffer_load_dwordx4 v3, s[24:27], s6 offen nt lds
    s_add_u32 s6, s6, 0x10000
    s_mov_b32 m0, 7168
    s_nop 0
    buffer_load_dwordx4 v3, s[24:27], s6 offen nt lds
    s_add_u32 s6, s6, 0x10000
    s_mov_b32 m0, 8192
    s_nop 0
    buffer_load_dwordx4 v3, s[24:27], s6 offen nt lds
    s_add_u32 s6, s6, 0x10000
    s_mov_b32 m0, 9216
    s_nop 0
    buffer_load_dwordx4 v3, s[24:27], s6 offen nt lds
    s_add_u32 s6, s6, 0x10000
    s_mov_b32 m0, 10240
    s_nop 0
    buffer_load_dwordx4 v3, s[24:27], s6 offen nt lds
    s_add_u32 s6, s6, 0x10000
    s_mov_b32 m0, 11264
    s_nop 0
    buffer_load_dwordx4 v3, s[24:27], s6 offen nt lds
    s_add_u32 s6, s6, 0x10000
    s_mov_b32 m0, 12288
    s_nop 0
    buffer_load_dwordx4 v3, s[24:27], s6 offen nt lds
    s_add_u32 s6, s6, 0x10000
    s_mov_b32 m0, 13312
    s_nop 0
    buffer_load_dwordx4 v3, s[24:27], s6 offen nt lds
    s_add_u32 s6, s6, 0x10000
    s_mov_b32 m0, 14336
    s_nop 0
    buffer_load_dwordx4 v3, s[24:27], s6 offen nt lds
    s_add_u32 s6, s6, 0x10000
    s_mov_b32 m0, 15360
    s_nop 0
    buffer_load_dwordx4 v3, s[24:27], s6 offen nt lds
    s_waitcnt vmcnt(16)
    v_lshlrev_b32 v12, 16, v4
    v_and_b32 v13, s60, v4
    v_lshlrev_b32 v14, 16, v5
    v_and_b32 v15, s60, v5
    v_lshlrev_b32 v16, 16, v6
    v_and_b32 v17, s60, v6
    v_lshlrev_b32 v18, 16, v7
    v_and_b32 v19, s60, v7
    v_add_f32 v20, v12, v13
    v_add_f32 v21, v14, v15
    v_add_f32 v22, v16, v17
    v_add_f32 v23, v18, v19
    v_add_f32 v20, v20, v21
    v_add_f32 v22, v22, v23
    v_add_f32 v20, v20, v22
    s_nop 1
    v_add_f32_dpp v20, v20, v20 row_ror:8 row_mask:0xf bank_mask:0xf
    s_nop 1
    v_add_f32_dpp v20, v20, v20 row_ror:4 row_mask:0xf bank_mask:0xf
    s_nop 1
    v_add_f32_dpp v20, v20, v20 row_ror:2 row_mask:0xf bank_mask:0xf
    s_nop 1
    v_add_f32_dpp v20, v20, v20 row_ror:1 row_mask:0xf bank_mask:0xf
    v_mov_b32 v21, v20
    s_nop 1
    v_permlane16_swap_b32 v20, v21
    v_add_f32 v20, v20, v21
    v_mov_b32 v21, v20
    s_nop 1
    v_permlane32_swap_b32 v20, v21
    v_add_f32 v20, v20, v21
    v_mul_f32 v20, 0x3b000000, v20
    v_sub_f32 v24, v12, v20
    v_sub_f32 v25, v13, v20
    v_sub_f32 v26, v14, v20
    v_sub_f32 v27, v15, v20
    v_sub_f32 v28, v16, v20
    v_sub_f32 v29, v17, v20
    v_sub_f32 v30, v18, v20
    v_sub_f32 v31, v19, v20
    v_mul_f32 v22, v24, v24
    v_fmac_f32 v22, v25, v25
    v_fmac_f32 v22, v26, v26
    v_fmac_f32 v22, v27, v27
    v_fmac_f32 v22, v28, v28
    v_fmac_f32 v22, v29, v29
    v_fmac_f32 v22, v30, v30
    v_fmac_f32 v22, v31, v31
    s_nop 1
    v_add_f32_dpp v22, v22, v22 row_ror:8 row_mask:0xf bank_mask:0xf
    s_nop 1
    v_add_f32_dpp v22, v22, v22 row_ror:4 row_mask:0xf bank_mask:0xf
    s_nop 1
    v_add_f32_dpp v22, v22, v22 row_ror:2 row_mask:0xf bank_mask:0xf
    s_nop 1
    v_add_f32_dpp v22, v22, v22 row_ror:1 row_mask:0xf bank_mask:0xf
    v_mov_b32 v21, v22
    s_nop 1
    v_permlane16_swap_b32 v22, v21
    v_add_f32 v22, v22, v21
    v_mov_b32 v21, v22
    s_nop 1
    v_permlane32_swap_b32 v22, v21
    v_add_f32 v22, v22, v21
    v_mul_f32 v22, 0x3b000000, v22
    v_cvt_pk_bf16_f32 v21, v20, v22
    v_lshlrev_b32 v20, 16, v21
    v_and_b32 v22, s60, v21
    v_add_f32 v22, 0x3727c5ac, v22
    v_cvt_pk_bf16_f32 v21, v22, v22
    v_and_b32 v22, s60, v21
    v_sqrt_f32 v22, v22
    s_nop 0
    v_cvt_pk_bf16_f32 v21, v22, v22
    v_and_b32 v22, s60, v21
    v_rcp_f32 v22, v22
    v_sub_f32 v12, v12, v20
    v_sub_f32 v13, v13, v20
    v_cvt_pk_bf16_f32 v21, v12, v13
    v_lshlrev_b32 v12, 16, v21
    v_and_b32 v13, s60, v21
    v_mul_f32 v12, v12, v22
    v_mul_f32 v13, v13, v22
    v_cvt_pk_bf16_f32 v4, v12, v13
    v_sub_f32 v14, v14, v20
    v_sub_f32 v15, v15, v20
    v_cvt_pk_bf16_f32 v21, v14, v15
    v_lshlrev_b32 v14, 16, v21
    v_and_b32 v15, s60, v21
    v_mul_f32 v14, v14, v22
    v_mul_f32 v15, v15, v22
    v_cvt_pk_bf16_f32 v5, v14, v15
    v_sub_f32 v16, v16, v20
    v_sub_f32 v17, v17, v20
    v_cvt_pk_bf16_f32 v21, v16, v17
    v_lshlrev_b32 v16, 16, v21
    v_and_b32 v17, s60, v21
    v_mul_f32 v16, v16, v22
    v_mul_f32 v17, v17, v22
    v_cvt_pk_bf16_f32 v6, v16, v17
    v_sub_f32 v18, v18, v20
    v_sub_f32 v19, v19, v20
    v_cvt_pk_bf16_f32 v21, v18, v19
    v_lshlrev_b32 v18, 16, v21
    v_and_b32 v19, s60, v21
    v_mul_f32 v18, v18, v22
    v_mul_f32 v19, v19, v22
    v_cvt_pk_bf16_f32 v7, v18, v19
    v_add_u32 v1, 139264, v2
    ds_write_b128 v1, v[4:7]
    v_lshrrev_b32 v12, 4, v0
    v_bfe_u32 v13, v0, 2, 2
    v_and_b32 v14, 3, v0
    v_lshl_add_u32 v15, v12, 3, v13
    v_lshlrev_b32 v15, 7, v15
    v_lshl_add_u32 v15, v14, 3, v15
    s_lshl_b32 s6, s62, 8
    s_add_u32 s6, s6, 139264
    v_lshlrev_b32 v17, 4, v12
    v_add_u32 v16, s6, v17
    s_waitcnt lgkmcnt(0)
    ds_read_b128 v[128:131], v16 offset:0
    ds_read_b128 v[132:135], v16 offset:64
    ds_read_b128 v[136:139], v16 offset:128
    ds_read_b128 v[140:143], v16 offset:192
    v_mov_b32 v1, 0
    s_waitcnt vmcnt(0)
    ds_read_b64_tr_b16 v[64:65], v15 offset:0
    ds_read_b64_tr_b16 v[66:67], v15 offset:512
    ds_read_b64_tr_b16 v[68:69], v15 offset:32
    ds_read_b64_tr_b16 v[70:71], v15 offset:544
    ds_read_b64_tr_b16 v[72:73], v15 offset:64
    ds_read_b64_tr_b16 v[74:75], v15 offset:576
    ds_read_b64_tr_b16 v[76:77], v15 offset:96
    ds_read_b64_tr_b16 v[78:79], v15 offset:608
    s_waitcnt lgkmcnt(0)
    v_mfma_f32_16x16x32_bf16 v[32:35], v[64:67], v[128:131], 0
    v_mfma_f32_16x16x32_bf16 v[36:39], v[68:71], v[128:131], 0
    v_mfma_f32_16x16x32_bf16 v[40:43], v[72:75], v[128:131], 0
    v_mfma_f32_16x16x32_bf16 v[44:47], v[76:79], v[128:131], 0
    ds_read_b64_tr_b16 v[80:81], v15 offset:4096
    ds_read_b64_tr_b16 v[82:83], v15 offset:4608
    ds_read_b64_tr_b16 v[84:85], v15 offset:4128
    ds_read_b64_tr_b16 v[86:87], v15 offset:4640
    ds_read_b64_tr_b16 v[88:89], v15 offset:4160
    ds_read_b64_tr_b16 v[90:91], v15 offset:4672
    ds_read_b64_tr_b16 v[92:93], v15 offset:4192
    ds_read_b64_tr_b16 v[94:95], v15 offset:4704
    s_waitcnt lgkmcnt(0)
    v_mfma_f32_16x16x32_bf16 v[32:35], v[80:83], v[132:135], v[32:35]
    v_mfma_f32_16x16x32_bf16 v[36:39], v[84:87], v[132:135], v[36:39]
    v_mfma_f32_16x16x32_bf16 v[40:43], v[88:91], v[132:135], v[40:43]
    v_mfma_f32_16x16x32_bf16 v[44:47], v[92:95], v[132:135], v[44:47]
    ds_read_b64_tr_b16 v[96:97], v15 offset:8192
    ds_read_b64_tr_b16 v[98:99], v15 offset:8704
    ds_read_b64_tr_b16 v[100:101], v15 offset:8224
    ds_read_b64_tr_b16 v[102:103], v15 offset:8736
    ds_read_b64_tr_b16 v[104:105], v15 offset:8256
    ds_read_b64_tr_b16 v[106:107], v15 offset:8768
    ds_read_b64_tr_b16 v[108:109], v15 offset:8288
    ds_read_b64_tr_b16 v[110:111], v15 offset:8800
    s_waitcnt lgkmcnt(0)
    v_mfma_f32_16x16x32_bf16 v[32:35], v[96:99], v[136:139], v[32:35]
    v_mfma_f32_16x16x32_bf16 v[36:39], v[100:103], v[136:139], v[36:39]
    v_mfma_f32_16x16x32_bf16 v[40:43], v[104:107], v[136:139], v[40:43]
    v_mfma_f32_16x16x32_bf16 v[44:47], v[108:111], v[136:139], v[44:47]
    ds_read_b64_tr_b16 v[112:113], v15 offset:12288
    ds_read_b64_tr_b16 v[114:115], v15 offset:12800
    ds_read_b64_tr_b16 v[116:117], v15 offset:12320
    ds_read_b64_tr_b16 v[118:119], v15 offset:12832
    ds_read_b64_tr_b16 v[120:121], v15 offset:12352
    ds_read_b64_tr_b16 v[122:123], v15 offset:12864
    ds_read_b64_tr_b16 v[124:125], v15 offset:12384
    ds_read_b64_tr_b16 v[126:127], v15 offset:12896
    s_waitcnt lgkmcnt(0)
    v_mfma_f32_16x16x32_bf16 v[32:35], v[112:115], v[140:143], v[32:35]
    v_mfma_f32_16x16x32_bf16 v[36:39], v[116:119], v[140:143], v[36:39]
    v_mfma_f32_16x16x32_bf16 v[40:43], v[120:123], v[140:143], v[40:43]
    v_mfma_f32_16x16x32_bf16 v[44:47], v[124:127], v[140:143], v[44:47]
    s_mov_b32 s7, 0
L_fl_230:
    ds_read_b32 v4, v245 offset:12
    s_add_u32 s7, s7, 1
    s_cmp_gt_u32 s7, 33554432
    s_cbranch_scc1 L_flok_231
    s_waitcnt lgkmcnt(0)
    v_cmp_le_u32 vcc, 1, v4
    s_cbranch_vccnz L_flok_231
    s_sleep 2
    s_branch L_fl_230
L_flok_231:
    s_waitcnt lgkmcnt(0)
    s_mov_b32 s7, 0
L_cpoll_232:
    buffer_load_dword v4, v1, s[48:51], s65 offen sc1
    s_add_u32 s7, s7, 1
    s_cmp_gt_u32 s7, 100000
    s_cbranch_scc1 L_cok_233
    s_waitcnt vmcnt(0)
    v_and_b32 v5, 0xff, v4
    v_cmp_gt_u32 vcc, 32, v5
    s_cbranch_vccz L_cok_233
    s_sleep 8
    s_branch L_cpoll_232
L_cok_233:
    s_waitcnt vmcnt(0)
    v_readfirstlane_b32 s6, v4
    s_lshl_b32 s7, s14, 5
    s_cmp_eq_u32 s6, s7
    s_cselect_b32 s15, 1, 0
    v_mov_b32 v5, s15
    ds_write_b32 v245, v5 offset:24
    s_mov_b32 exec_lo, 0x00010001
    s_mov_b32 exec_hi, 0x00010001
    s_cmp_lg_u32 s15, 0
    s_cbranch_scc1 L_sa_234
    buffer_store_dwordx4 v[32:35], v17, s[16:19], s58 offen offset:0 sc1
    buffer_store_dwordx4 v[36:39], v17, s[16:19], s58 offen offset:64 sc1
    buffer_store_dwordx4 v[40:43], v17, s[16:19], s58 offen offset:128 sc1
    buffer_store_dwordx4 v[44:47], v17, s[16:19], s58 offen offset:192 sc1
    s_branch L_sb_235
L_sa_234:
    buffer_store_dwordx4 v[32:35], v17, s[16:19], s58 offen offset:0
    buffer_store_dwordx4 v[36:39], v17, s[16:19], s58 offen offset:64
    buffer_store_dwordx4 v[40:43], v17, s[16:19], s58 offen offset:128
    buffer_store_dwordx4 v[44:47], v17, s[16:19], s58 offen offset:192
L_sb_235:
    s_mov_b64 exec, -1
    s_sleep 16
    s_lshl_b32 s6, s4, 13
    s_add_u32 s6, s6, 786432
    s_add_u32 s66, s6, 4096
    s_mov_b32 s7, 0
L_qpoll_236:
    buffer_load_dwordx4 v[64:67], v2, s[16:19], s6 offen offset:0 sc1
    buffer_load_dwordx4 v[68:71], v2, s[16:19], s6 offen offset:1024 sc1
    buffer_load_dwordx4 v[72:75], v2, s[16:19], s6 offen offset:2048 sc1
    buffer_load_dwordx4 v[76:79], v2, s[16:19], s6 offen offset:3072 sc1
    buffer_load_dwordx4 v[80:83], v2, s[16:19], s66 offen offset:0 sc1
    buffer_load_dwordx4 v[84:87], v2, s[16:19], s66 offen offset:1024 sc1
    buffer_load_dwordx4 v[88:91], v2, s[16:19], s66 offen offset:2048 sc1
    buffer_load_dwordx4 v[92:95], v2, s[16:19], s66 offen offset:3072 sc1
    s_add_u32 s7, s7, 1
    s_cmp_gt_u32 s7, 100000
    s_cbranch_scc1 L_qok_237
    s_waitcnt vmcnt(0)
    v_pk_add_f32 v[64:65], v[64:65], v[72:73]
    v_pk_add_f32 v[80:81], v[80:81], v[88:89]
    v_pk_add_f32 v[66:67], v[66:67], v[74:75]
    v_pk_add_f32 v[82:83], v[82:83], v[90:91]
    v_pk_add_f32 v[68:69], v[68:69], v[76:77]
    v_pk_add_f32 v[84:85], v[84:85], v[92:93]
    v_pk_add_f32 v[70:71], v[70:71], v[78:79]
    v_pk_add_f32 v[86:87], v[86:87], v[94:95]
    v_pk_add_f32 v[64:65], v[64:65], v[80:81]
    v_pk_add_f32 v[66:67], v[66:67], v[82:83]
    v_pk_add_f32 v[68:69], v[68:69], v[84:85]
    v_pk_add_f32 v[70:71], v[70:71], v[86:87]
    v_cmp_u_f32 vcc, v64, v65
    v_cmp_u_f32 s[68:69], v66, v67
    v_cmp_u_f32 s[70:71], v68, v69
    v_cmp_u_f32 s[72:73], v70, v71
    s_or_b64 vcc, vcc, s[68:69]
    s_or_b64 s[70:71], s[70:71], s[72:73]
    s_or_b64 vcc, vcc, s[70:71]
    s_cbranch_scc0 L_qok_237
    s_sleep 8
    s_branch L_qpoll_236
L_qok_237:
    s_waitcnt vmcnt(0)
    v_cvt_pk_bf16_f32 v4, v64, v65
    v_cvt_pk_bf16_f32 v5, v66, v67
    v_cvt_pk_bf16_f32 v6, v68, v69
    v_cvt_pk_bf16_f32 v7, v70, v71
    v_lshlrev_b32 v1, 3, v0
    v_add_u32 v1, 140288, v1
    v_mov_b32 v8, 1
    ds_write_b64 v1, v[4:5]
    ds_write_b64 v1, v[6:7] offset:512
    s_mov_b64 exec, 1
    ds_add_u32 v245, v8 offset:0
    s_mov_b64 exec, -1
    v_and_b32 v1, 3, v0
    v_lshlrev_b32 v5, 4, v1
    v_add_u32 v5, 143872, v5
    v_lshlrev_b32 v1, 3, v1
    s_mov_b32 s7, 0
L_fl_238:
    ds_read_b32 v4, v245 offset:4
    s_add_u32 s7, s7, 1
    s_cmp_gt_u32 s7, 33554432
    s_cbranch_scc1 L_flok_239
    s_waitcnt lgkmcnt(0)
    v_cmp_le_u32 vcc, 4, v4
    s_cbranch_vccnz L_flok_239
    s_sleep 4
    s_branch L_fl_238
L_flok_239:
    s_waitcnt lgkmcnt(0)
    ds_read_b128 v[8:11], v5
    ds_read_b128 v[12:15], v5 offset:64
    s_waitcnt lgkmcnt(0)
    v_max3_f32 v16, v8, v9, v10
    v_max_f32 v16, v16, v11
    v_sub_f32 v8, v8, v16
    v_sub_f32 v9, v9, v16
    v_sub_f32 v10, v10, v16
    v_sub_f32 v11, v11, v16
    v_mul_f32 v8, s59, v8
    v_mul_f32 v9, s59, v9
    v_mul_f32 v10, s59, v10
    v_mul_f32 v11, s59, v11
    v_exp_f32 v8, v8
    v_exp_f32 v9, v9
    v_exp_f32 v10, v10
    v_exp_f32 v11, v11
    v_mul_f32 v17, v8, v12
    v_fmac_f32 v17, v9, v13
    v_fmac_f32 v17, v10, v14
    v_fmac_f32 v17, v11, v15
    s_mov_b64 exec, 15
    s_cmp_lg_u32 s15, 0
    s_cbranch_scc1 L_sa_240
    buffer_store_dwordx2 v[16:17], v1, s[16:19], s64 offen sc1
    s_branch L_sb_241
L_sa_240:
    buffer_store_dwordx2 v[16:17], v1, s[16:19], s64 offen
L_sb_241:
    s_mov_b64 exec, -1
    s_cmp_eq_u32 s15, 0
    s_cbranch_scc1 L_rk_242
    s_lshl_b32 s6, s4, 10
    s_add_u32 s6, s6, 8192
    buffer_load_dword v4, v2, s[16:19], s6 offen sc1
    s_waitcnt vmcnt(0)
    v_cmp_o_f32 vcc, v4, v4
    s_nop 0
    s_bcnt1_i32_b64 s6, vcc
    s_min_u32 s6, s6, 63
    s_and_b32 s6, s6, 60
    s_mov_b32 s70, 0x11223
    s_mov_b32 s71, 0x86432100
    s_lshr_b64 s[70:71], s[70:71], s6
    s_and_b32 s70, s70, 15
    s_lshl_b32 s70, s70, 2
    s_lshl_b32 s71, s70, 8
    s_cmp_lt_u32 s6, 32
    s_cselect_b32 s6, s71, s70
    v_mov_b32 v4, s6
    ds_write_b32 v245, v4 offset:52
L_rk_242:
    s_mov_b32 s7, 0
L_fl_243:
    ds_read_b32 v4, v245 offset:16
    s_add_u32 s7, s7, 1
    s_cmp_gt_u32 s7, 33554432
    s_cbranch_scc1 L_flok_244
    s_waitcnt lgkmcnt(0)
    v_cmp_le_u32 vcc, 1, v4
    s_cbranch_vccnz L_flok_244
    s_sleep 4
    s_branch L_fl_243
L_flok_244:
    s_waitcnt lgkmcnt(0)
    v_and_b32 v1, 7, v0
    v_lshlrev_b32 v1, 5, v1
    s_mov_b32 s7, 0
L_cpoll_245:
    buffer_load_dword v4, v1, s[48:51], 0 offen sc1
    s_add_u32 s7, s7, 1
    s_cmp_gt_u32 s7, 100000
    s_cbranch_scc1 L_cok_246
    s_waitcnt vmcnt(0)
    v_and_b32 v5, 0xff, v4
    v_cmp_gt_u32 vcc, 32, v5
    s_cbranch_vccz L_cok_246
    s_sleep 8
    s_branch L_cpoll_245
L_cok_246:
    s_waitcnt vmcnt(0)
    v_mov_b32 v6, 1
    s_cmp_ge_u32 s12, 16
    s_cbranch_scc1 L_now_247
    s_lshl_b32 s6, s4, 10
    s_add_u32 s6, s6, 8192
    s_mov_b32 s7, 0
L_spoll_248:
    buffer_load_dwordx4 v[8:11], v2, s[16:19], s6 offen sc1
    s_add_u32 s7, s7, 1
    s_cmp_gt_u32 s7, 100000
    s_cbranch_scc1 L_sok_249
    s_waitcnt vmcnt(0)
    v_cmp_u_f32 vcc, v8, v9
    v_cmp_u_f32 s[78:79], v10, v11
    s_nop 0
    s_or_b64 vcc, vcc, s[78:79]
    s_cbranch_scc0 L_sok_249
    s_sleep 8
    s_branch L_spoll_248
L_sok_249:
    s_waitcnt vmcnt(0)
    v_mov_b32 v4, v8
    v_mov_b32 v5, v10
    s_nop 0
    v_max_f32_dpp v4, v4, v4 quad_perm:[2,3,0,1] row_mask:0xf bank_mask:0xf
    v_max_f32_dpp v5, v5, v5 quad_perm:[2,3,0,1] row_mask:0xf bank_mask:0xf
    s_nop 0
    v_max_f32_dpp v4, v4, v4 row_ror:4 row_mask:0xf bank_mask:0xf
    v_max_f32_dpp v5, v5, v5 row_ror:4 row_mask:0xf bank_mask:0xf
    s_nop 0
    v_max_f32_dpp v4, v4, v4 row_ror:8 row_mask:0xf bank_mask:0xf
    v_max_f32_dpp v5, v5, v5 row_ror:8 row_mask:0xf bank_mask:0xf
    v_mov_b32 v12, v4
    v_mov_b32 v13, v5
    s_nop 0
    v_permlane16_swap_b32 v4, v12
    v_permlane16_swap_b32 v5, v13
    v_max_f32 v4, v4, v12
    v_max_f32 v5, v5, v13
    v_mov_b32 v12, v4
    v_mov_b32 v13, v5
    s_nop 0
    v_permlane32_swap_b32 v4, v12
    v_permlane32_swap_b32 v5, v13
    v_max_f32 v4, v4, v12
    v_max_f32 v5, v5, v13
    v_sub_f32 v8, v8, v4
    v_sub_f32 v10, v10, v5
    v_mul_f32 v8, s59, v8
    v_mul_f32 v10, s59, v10
    v_exp_f32 v8, v8
    v_exp_f32 v10, v10
    v_mul_f32 v9, v8, v9
    v_mul_f32 v11, v10, v11
    s_nop 0
    v_add_f32_dpp v9, v9, v9 quad_perm:[2,3,0,1] row_mask:0xf bank_mask:0xf
    v_add_f32_dpp v11, v11, v11 quad_perm:[2,3,0,1] row_mask:0xf bank_mask:0xf
    s_nop 0
    v_add_f32_dpp v9, v9, v9 row_ror:4 row_mask:0xf bank_mask:0xf
    v_add_f32_dpp v11, v11, v11 row_ror:4 row_mask:0xf bank_mask:0xf
    s_nop 0
    v_add_f32_dpp v9, v9, v9 row_ror:8 row_mask:0xf bank_mask:0xf
    v_add_f32_dpp v11, v11, v11 row_ror:8 row_mask:0xf bank_mask:0xf
    v_mov_b32 v12, v9
    v_mov_b32 v13, v11
    s_nop 0
    v_permlane16_swap_b32 v9, v12
    v_permlane16_swap_b32 v11, v13
    v_add_f32 v9, v9, v12
    v_add_f32 v11, v11, v13
    v_mov_b32 v12, v9
    v_mov_b32 v13, v11
    s_nop 0
    v_permlane32_swap_b32 v9, v12
    v_permlane32_swap_b32 v11, v13
    v_add_f32 v9, v9, v12
    v_add_f32 v11, v11, v13
    v_rcp_f32 v9, v9
    v_rcp_f32 v11, v11
    v_lshlrev_b32 v5, 3, v0
    v_add_u32 v5, 144064, v5
    v_mul_f32 v8, v8, v9
    v_mul_f32 v9, v10, v11
    ds_write_b64 v5, v[8:9]
L_now_247:
    s_mov_b64 exec, 1
    ds_add_u32 v245, v6 offset:8
    s_mov_b64 exec, -1
    s_branch L_hjoin
L_h123:
    v_mov_b32 v4, 0
    v_mov_b32 v5, 0
    v_mov_b32 v6, 0
    v_mov_b32 v7, 0
    s_cmp_eq_u32 s3, 2
    s_cbranch_scc1 L_h2_250
    s_cmp_eq_u32 s3, 3
    s_cbranch_scc1 L_h3_251
    v_mov_b32 v8, -1
    v_mov_b32 v9, -1
    v_mov_b32 v10, -1
    v_mov_b32 v11, -1
    buffer_store_dwordx4 v[8:11], v2, s[16:19], s66 offen sc1
    buffer_store_dwordx4 v[8:11], v2, s[16:19], s66 offen offset:1024 sc1
    s_mov_b64 exec, 3
    buffer_store_dwordx4 v[8:11], v2, s[16:19], s64 offen sc1
    s_mov_b64 exec, 0xffff
    buffer_store_dwordx4 v[8:11], v2, s[16:19], s58 offen sc1
    s_cmp_lt_u32 s5, 8
    s_cbranch_scc1 L_cz_253
    s_cmp_ge_u32 s5, 24
    s_cbranch_scc1 L_cd_254
    buffer_store_dwordx4 v[8:11], v2, s[16:19], s13 offen sc1
    s_branch L_cd_254
L_cz_253:
    s_cmp_ge_u32 s100, 56
    s_cbranch_scc1 L_cd_254
    s_mov_b64 exec, -1
    s_lshl_b32 s7, s100, 11
    s_add_u32 s7, s7, 131072
    buffer_store_dwordx4 v[8:11], v2, s[16:19], s7 offen sc1
    buffer_store_dwordx4 v[8:11], v2, s[16:19], s7 offen offset:1024 sc1
L_cd_254:
    s_mov_b64 exec, -1
    v_mov_b32 v6, s14
    s_barrier
    s_waitcnt vmcnt(0)
    s_mov_b64 exec, 1
    buffer_atomic_add v6, v4, s[48:51], s65 offen sc1
    s_mov_b64 exec, -1
    s_branch L_hd_252
L_h2_250:
    ds_write_b128 v245, v[4:7] offset:0
    ds_write_b128 v245, v[4:7] offset:16
    ds_write_b128 v245, v[4:7] offset:32
    ds_write_b128 v245, v[4:7] offset:48
    s_waitcnt lgkmcnt(0)
    s_barrier
    s_getpc_b64 s[6:7]
L_pc_anchor:
    s_sub_u32 s6, s6, L_pc_anchor-sequential_preLN__gqa_block_cached__glu_gated_glu__decode_kernel
    s_subb_u32 s7, s7, 0
    s_lshl_b32 s68, s5, 11
    v_lshl_add_u32 v1, v0, 7, s68
    v_min_u32 v4, L_code_end-sequential_preLN__gqa_block_cached__glu_gated_glu__decode_kernel-4, v1
    s_mov_b64 exec, 0xffff
    global_load_dword v8, v4, s[6:7]
    s_mov_b64 exec, -1
    s_branch L_hd_252
L_h3_251:
    v_add_u32 v1, 142336, v2
    ds_write_b128 v1, v[4:7]
    ds_write_b128 v1, v[4:7] offset:512
    v_mov_b32 v8, 0x3f803f80
    v_mov_b32 v9, v8
    v_mov_b32 v10, v8
    v_mov_b32 v11, v8
    v_add_u32 v1, 146624, v2
    ds_write_b128 v1, v[8:11]
    s_barrier
    s_mov_b32 s7, 0
L_fl_255:
    ds_read_b32 v12, v245 offset:12
    s_add_u32 s7, s7, 1
    s_cmp_gt_u32 s7, 33554432
    s_cbranch_scc1 L_flok_256
    s_waitcnt lgkmcnt(0)
    v_cmp_le_u32 vcc, 1, v12
    s_cbranch_vccnz L_flok_256
    s_sleep 8
    s_branch L_fl_255
L_flok_256:
    s_waitcnt lgkmcnt(0)
    s_lshl_b32 s6, s4, 19
    s_mov_b64 exec, 1
    buffer_load_dword v8, v4, s[28:31], s6 offen nt
    buffer_load_dword v9, v4, s[32:35], 0 offen nt
    buffer_load_dword v10, v4, s[36:39], 0 offen nt
    buffer_load_dword v11, v4, s[40:43], 0 offen nt
    s_mov_b64 exec, -1
L_hd_252:
    s_waitcnt vmcnt(0) lgkmcnt(0)
L_hjoin:
    s_mov_b32 s7, 0
L_fl_257:
    ds_read_b32 v4, v245 offset:8
    s_add_u32 s7, s7, 1
    s_cmp_gt_u32 s7, 33554432
    s_cbranch_scc1 L_flok_258
    s_waitcnt lgkmcnt(0)
    v_cmp_le_u32 vcc, 1, v4
    s_cbranch_vccnz L_flok_258
    s_sleep 4
    s_branch L_fl_257
L_flok_258:
    s_waitcnt lgkmcnt(0)
    v_lshrrev_b32 v12, 4, v0
    v_bfe_u32 v13, v0, 2, 2
    v_and_b32 v14, 3, v0
    v_lshl_add_u32 v15, v12, 3, v13
    v_mov_b32 v240, 1
    s_cmp_lt_u32 s5, 8
    s_cbranch_scc1 L_gpath
    s_cmp_ge_u32 s5, 24
    s_cbranch_scc1 L_ppath
    v_lshrrev_b32 v4, 3, v0
    v_lshlrev_b32 v6, 11, v4
    v_and_b32 v5, 7, v0
    v_lshl_add_u32 v84, v5, 4, v6
    v_lshlrev_b32 v6, 4, v4
    v_add_u32 v6, 144064, v6
    ds_read_b128 v[64:67], v6 offset:0
    ds_read_b128 v[68:71], v6 offset:128
    ds_read_b128 v[72:75], v6 offset:256
    ds_read_b128 v[76:79], v6 offset:384
    s_and_b32 s8, s12, 12
    s_add_u32 s8, s8, s3
    s_and_b32 s9, s12, 3
    s_lshl_b32 s6, s4, 16
    s_add_u32 s6, s6, 262144
    s_lshl_b32 s64, s8, 7
    s_add_u32 s64, s64, s6
    s_add_u32 s65, s64, 16384
    s_add_u32 s66, s64, 32768
    s_add_u32 s67, s64, 49152
    s_lshl_b32 s72, s4, 19
    s_lshl_b32 s6, s9, 8
    s_add_u32 s72, s72, s6
    s_and_b32 s6, s8, 1
    s_lshl_b32 s6, s6, 16
    s_add_u32 s72, s72, s6
    s_lshr_b32 s6, s8, 2
    s_lshl_b32 s6, s6, 11
    s_add_u32 s72, s72, s6
    s_bfe_u32 s6, s8, 0x10001
    s_lshl_b32 s6, s6, 10
    s_add_u32 s72, s72, s6
    v_and_b32 v5, 15, v0
    v_lshlrev_b32 v6, 4, v5
    v_lshlrev_b32 v7, 5, v12
    v_xor_b32 v6, v6, v7
    v_lshl_add_u32 v89, v12, 13, v6
    v_xor_b32 v90, 0x80, v89
    s_lshl_b32 s74, s3, 13
    v_and_b32 v6, 1, v12
    v_lshl_add_u32 v6, v6, 2, v13
    v_lshlrev_b32 v6, 5, v6
    v_lshl_add_u32 v6, v15, 8, v6
    v_lshl_add_u32 v6, v14, 3, v6
    v_add_u32 v128, s74, v6
    v_xor_b32 v129, 32, v128
    v_xor_b32 v130, 64, v128
    v_xor_b32 v131, 96, v128
    v_xor_b32 v132, 128, v128
    v_xor_b32 v133, 160, v128
    v_xor_b32 v134, 192, v128
    v_xor_b32 v135, 224, v128
    s_lshl_b32 s6, s3, 9
    s_add_u32 s6, s6, 144576
    v_lshlrev_b32 v4, 4, v12
    v_add_u32 v85, s6, v4
    v_add_u32 v86, 144576, v2
    v_lshlrev_b32 v87, 3, v0
    v_and_b32 v4, 1, v0
    v_lshl_add_u32 v85, v4, 6, v85
    s_mov_b32 s22, 0xaaaaaaaa
    s_mov_b32 s23, 0xaaaaaaaa
    v_lshlrev_b32 v88, 7, v0
    s_lshl_b32 s20, s4, 18
    s_lshl_b32 s6, s12, 14
    s_add_u32 s20, s20, s6
    s_lshl_b32 s6, s3, 12
    s_add_u32 s20, s20, s6
    s_mov_b32 s7, 0
L_fl_259:
    ds_read_b32 v4, v245 offset:20
    s_add_u32 s7, s7, 1
    s_cmp_gt_u32 s7, 33554432
    s_cbranch_scc1 L_flok_260
    s_waitcnt lgkmcnt(0)
    v_cmp_le_u32 vcc, 4, v4
    s_cbranch_vccnz L_flok_260
    s_sleep 1
    s_branch L_fl_259
L_flok_260:
    s_waitcnt lgkmcnt(0)
    s_add_u32 m0, s74, 0
    s_add_u32 s6, s72, 0
    buffer_load_dwordx4 v89, s[28:31], s6 offen nt lds
    s_add_u32 m0, s74, 1024
    s_add_u32 s6, s72, 32768
    buffer_load_dwordx4 v89, s[28:31], s6 offen nt lds
    s_add_u32 m0, s74, 2048
    s_add_u32 s6, s72, 131072
    buffer_load_dwordx4 v90, s[28:31], s6 offen nt lds
    s_add_u32 m0, s74, 3072
    s_add_u32 s6, s72, 163840
    buffer_load_dwordx4 v90, s[28:31], s6 offen nt lds
    s_add_u32 m0, s74, 4096
    s_add_u32 s6, s72, 262144
    buffer_load_dwordx4 v89, s[28:31], s6 offen nt lds
    s_add_u32 m0, s74, 5120
    s_add_u32 s6, s72, 294912
    buffer_load_dwordx4 v89, s[28:31], s6 offen nt lds
    s_add_u32 m0, s74, 6144
    s_add_u32 s6, s72, 393216
    buffer_load_dwordx4 v90, s[28:31], s6 offen nt lds
    s_add_u32 m0, s74, 7168
    s_add_u32 s6, s72, 425984
    buffer_load_dwordx4 v90, s[28:31], s6 offen nt lds
    s_mov_b32 s7, 0
L_fl_261:
    ds_read_b32 v4, v245 offset:28
    s_add_u32 s7, s7, 1
    s_cmp_gt_u32 s7, 33554432
    s_cbranch_scc1 L_flok_262
    s_waitcnt lgkmcnt(0)
    v_cmp_le_u32 vcc, 4, v4
    s_cbranch_vccnz L_flok_262
    s_sleep 1
    s_branch L_fl_261
L_flok_262:
    s_waitcnt lgkmcnt(0)
    s_sleep 3
    buffer_load_dwordx4 v[48:51], v84, s[16:19], s64 offen sc1
    buffer_load_dwordx4 v[52:55], v84, s[16:19], s65 offen sc1
    buffer_load_dwordx4 v[56:59], v84, s[16:19], s66 offen sc1
    buffer_load_dwordx4 v[60:63], v84, s[16:19], s67 offen sc1
    s_waitcnt vmcnt(4)
    ds_read_b64_tr_b16 v[16:17], v128 offset:0
    ds_read_b64_tr_b16 v[18:19], v128 offset:1024
    ds_read_b64_tr_b16 v[20:21], v129 offset:0
    ds_read_b64_tr_b16 v[22:23], v129 offset:1024
    ds_read_b64_tr_b16 v[24:25], v130 offset:0
    ds_read_b64_tr_b16 v[26:27], v130 offset:1024
    ds_read_b64_tr_b16 v[28:29], v131 offset:0
    ds_read_b64_tr_b16 v[30:31], v131 offset:1024
    ds_read_b64_tr_b16 v[32:33], v132 offset:0
    ds_read_b64_tr_b16 v[34:35], v132 offset:1024
    s_waitcnt lgkmcnt(8)
    ds_read_b64_tr_b16 v[36:37], v133 offset:0
    ds_read_b64_tr_b16 v[38:39], v133 offset:1024
    ds_read_b64_tr_b16 v[40:41], v134 offset:0
    ds_read_b64_tr_b16 v[42:43], v134 offset:1024
    s_waitcnt lgkmcnt(8)
    ds_read_b64_tr_b16 v[44:45], v135 offset:0
    ds_read_b64_tr_b16 v[46:47], v135 offset:1024
    s_mov_b32 s7, 0
L_h1_263:
    s_waitcnt vmcnt(0)
    v_pk_mul_f32 v[80:81], v[48:49], v[64:65]
    v_pk_mul_f32 v[82:83], v[50:51], v[66:67]
    v_pk_fma_f32 v[80:81], v[52:53], v[68:69], v[80:81]
    v_pk_fma_f32 v[82:83], v[54:55], v[70:71], v[82:83]
    v_pk_fma_f32 v[80:81], v[56:57], v[72:73], v[80:81]
    v_pk_fma_f32 v[82:83], v[58:59], v[74:75], v[82:83]
    v_pk_fma_f32 v[80:81], v[60:61], v[76:77], v[80:81]
    v_pk_fma_f32 v[82:83], v[62:63], v[78:79], v[82:83]
    v_cmp_u_f32 vcc, v80, v81
    v_cmp_u_f32 s[78:79], v82, v83
    s_nop 0
    s_or_b64 vcc, vcc, s[78:79]
    s_cbranch_scc0 L_h1ok_264
    s_add_u32 s7, s7, 1
    s_cmp_gt_u32 s7, 100000
    s_cbranch_scc1 L_h1ok_264
    v_cmp_u_f32 vcc, v48, v49
    v_cmp_u_f32 s[78:79], v50, v51
    s_nop 0
    s_or_b64 exec, vcc, s[78:79]
    s_cbranch_execz L_rs_265
    buffer_load_dwordx4 v[48:51], v84, s[16:19], s64 offen sc1
L_rs_265:
    s_mov_b64 exec, -1
    v_cmp_u_f32 vcc, v52, v53
    v_cmp_u_f32 s[78:79], v54, v55
    s_nop 0
    s_or_b64 exec, vcc, s[78:79]
    s_cbranch_execz L_rs_266
    buffer_load_dwordx4 v[52:55], v84, s[16:19], s65 offen sc1
L_rs_266:
    s_mov_b64 exec, -1
    v_cmp_u_f32 vcc, v56, v57
    v_cmp_u_f32 s[78:79], v58, v59
    s_nop 0
    s_or_b64 exec, vcc, s[78:79]
    s_cbranch_execz L_rs_267
    buffer_load_dwordx4 v[56:59], v84, s[16:19], s66 offen sc1
L_rs_267:
    s_mov_b64 exec, -1
    v_cmp_u_f32 vcc, v60, v61
    v_cmp_u_f32 s[78:79], v62, v63
    s_nop 0
    s_or_b64 exec, vcc, s[78:79]
    s_cbranch_execz L_rs_268
    buffer_load_dwordx4 v[60:63], v84, s[16:19], s67 offen sc1
L_rs_268:
    s_mov_b64 exec, -1
    s_branch L_h1_263
L_h1ok_264:
    v_permlane32_swap_b32 v80, v82
    v_permlane32_swap_b32 v81, v83
    v_add_f32 v80, v80, v82
    v_add_f32 v81, v81, v83
    s_nop 1
    v_permlane16_swap_b32 v80, v81
    v_add_f32 v80, v80, v81
    s_nop 1
    v_add_f32_dpp v80, v80, v80 row_ror:8 row_mask:0xf bank_mask:0xf
    s_nop 1
    v_mov_b32_dpp v81, v80 row_ror:15 row_mask:0xf bank_mask:0xf
    v_cvt_pk_bf16_f32 v80, v80, v81
    s_nop 1
    v_mov_b32_dpp v4, v80 row_newbcast:0 row_mask:0xf bank_mask:0xf
    v_mov_b32_dpp v5, v80 row_newbcast:2 row_mask:0xf bank_mask:0xf
    v_mov_b32_dpp v6, v80 row_newbcast:4 row_mask:0xf bank_mask:0xf
    v_mov_b32_dpp v7, v80 row_newbcast:6 row_mask:0xf bank_mask:0xf
    s_waitcnt lgkmcnt(0)
    v_cndmask_b32 v8, 0, v4, s[22:23]
    v_cndmask_b32 v9, 0, v5, s[22:23]
    v_cndmask_b32 v10, 0, v6, s[22:23]
    v_cndmask_b32 v11, 0, v7, s[22:23]
    v_cndmask_b32 v4, v4, 0, s[22:23]
    v_cndmask_b32 v5, v5, 0, s[22:23]
    v_cndmask_b32 v6, v6, 0, s[22:23]
    v_cndmask_b32 v7, v7, 0, s[22:23]
    v_mfma_f32_16x16x32_bf16 v[96:99], v[20:23], v[8:11], 0
    v_mfma_f32_16x16x32_bf16 v[100:103], v[28:31], v[8:11], 0
    v_mfma_f32_16x16x32_bf16 v[104:107], v[36:39], v[8:11], 0
    v_mfma_f32_16x16x32_bf16 v[108:111], v[44:47], v[8:11], 0
    v_mfma_f32_16x16x32_bf16 v[96:99], v[16:19], v[4:7], v[96:99]
    v_mfma_f32_16x16x32_bf16 v[100:103], v[24:27], v[4:7], v[100:103]
    v_mfma_f32_16x16x32_bf16 v[104:107], v[32:35], v[4:7], v[104:107]
    v_mfma_f32_16x16x32_bf16 v[108:111], v[40:43], v[4:7], v[108:111]
    s_mov_b32 exec_lo, 0x00030003
    s_mov_b32 exec_hi, 0x00030003
    s_nop 2
    ds_write_b128 v85, v[96:99] offset:0
    ds_write_b128 v85, v[100:103] offset:128
    ds_write_b128 v85, v[104:107] offset:256
    ds_write_b128 v85, v[108:111] offset:384
    s_mov_b64 exec, 1
    ds_add_u32 v245, v240 offset:36
    s_cmp_lg_u32 s3, 0
    s_cbranch_scc1 L_noy
    s_mov_b64 exec, 0xffffffff
    s_mov_b32 s7, 0
L_fl_269:
    ds_read_b32 v8, v245 offset:36
    ds_read_b128 v[48:51], v86 offset:0
    ds_read_b128 v[52:55], v86 offset:512
    ds_read_b128 v[56:59], v86 offset:1024
    ds_read_b128 v[60:63], v86 offset:1536
    s_add_u32 s7, s7, 1
    s_cmp_gt_u32 s7, 33554432
    s_cbranch_scc1 L_flok_270
    s_waitcnt lgkmcnt(4)
    v_cmp_le_u32 vcc, 4, v8
    s_cbranch_vccnz L_flok_270
    s_waitcnt lgkmcnt(0)
    s_branch L_fl_269
L_flok_270:
    s_waitcnt lgkmcnt(2)
    v_pk_add_f32 v[48:49], v[48:49], v[52:53]
    v_pk_add_f32 v[50:51], v[50:51], v[54:55]
    s_waitcnt lgkmcnt(0)
    v_pk_add_f32 v[56:57], v[56:57], v[60:61]
    v_pk_add_f32 v[58:59], v[58:59], v[62:63]
    v_pk_add_f32 v[48:49], v[48:49], v[56:57]
    v_pk_add_f32 v[50:51], v[50:51], v[58:59]
    v_cvt_pk_bf16_f32 v4, v48, v49
    v_cvt_pk_bf16_f32 v5, v50, v51
    buffer_store_dwordx2 v[4:5], v87, s[16:19], s13 offen sc1
L_noy:
    s_cmp_eq_u32 s4, 7
    s_cbranch_scc1 L_wp_271
    s_mov_b64 exec, 0xffffffff
    buffer_load_dword v254, v88, s[40:43], s20 offen
L_wp_271:
    s_endpgm
L_ppath:
    s_cmp_eq_u32 s4, 7
    s_cbranch_scc1 L_pe_272
    s_movk_i32 s6, 3584
    v_lshrrev_b32 v6, 2, v0
    v_mul_lo_u32 v6, v6, s6
    v_lshl_add_u32 v6, v14, 7, v6
    v_lshlrev_b32 v7, 7, v0
    s_sub_u32 s6, s5, 24
    s_lshl_b32 s6, s6, 2
    s_add_u32 s6, s6, s3
    s_mul_i32 s20, s6, 57344
    s_lshl_b32 s7, s4, 9
    s_add_u32 s20, s20, s7
    s_lshl_b32 s21, s4, 18
    s_lshl_b32 s6, s6, 13
    s_add_u32 s21, s21, s6
    s_mov_b32 s7, 0
L_fl_273:
    ds_read_b32 v4, v245 offset:20
    s_add_u32 s7, s7, 1
    s_cmp_gt_u32 s7, 33554432
    s_cbranch_scc1 L_flok_274
    s_waitcnt lgkmcnt(0)
    v_cmp_le_u32 vcc, 4, v4
    s_cbranch_vccnz L_flok_274
    s_sleep 1
    s_branch L_fl_273
L_flok_274:
    s_waitcnt lgkmcnt(0)
    s_lshr_b64 exec, -1, 32
    buffer_load_dword v8, v6, s[32:35], s20 offen
    s_mov_b64 exec, -1
    s_mov_b32 s7, 0
L_fl_275:
    ds_read_b32 v4, v245 offset:32
    s_add_u32 s7, s7, 1
    s_cmp_gt_u32 s7, 33554432
    s_cbranch_scc1 L_flok_276
    s_waitcnt lgkmcnt(0)
    v_cmp_le_u32 vcc, 2, v4
    s_cbranch_vccnz L_flok_276
    s_sleep 1
    s_branch L_fl_275
L_flok_276:
    s_waitcnt lgkmcnt(0)
    s_lshl_b64 exec, -1, 32
    buffer_load_dword v8, v6, s[32:35], s20 offen
    s_mov_b64 exec, -1
    buffer_load_dword v9, v6, s[36:39], s20 offen
L_pe_272:
    s_endpgm
L_gpath:
    s_cmp_ge_u32 s100, 56
    s_cbranch_scc1 L_end
    v_lshlrev_b32 v4, 4, v12
    v_and_b32 v5, 15, v0
    v_add_u32 v7, 141312, v4
    v_add_u32 v6, 146624, v4
    v_cmp_eq_u32 vcc, 1, v5
    s_nop 1
    v_cndmask_b32 v228, v7, v6, vcc
    v_add_u32 v229, 141312, v2
    s_lshl_b32 s6, s3, 4
    s_add_u32 s6, s6, 142848
    v_lshl_add_u32 v230, v5, 1, s6
    v_lshl_add_u32 v232, v5, 6, v4
    v_add_u32 v6, 142400, v232
    v_cmp_gt_u32 vcc, 8, v5
    v_mov_b32 v7, 143360
    s_nop 0
    v_cndmask_b32 v231, v7, v6, vcc
    s_lshl_b32 s76, s100, 11
    s_lshl_b32 s6, s3, 9
    s_add_u32 s76, s76, s6
    s_add_u32 s76, s76, 131072
    v_mov_b32 v233, 0x3f803f80
    s_movk_i32 s6, 3584
    v_lshrrev_b32 v6, 2, v0
    v_mul_lo_u32 v6, v6, s6
    v_lshrrev_b32 v7, 5, v0
    v_xor_b32 v7, v7, v14
    v_lshl_add_u32 v234, v7, 4, v6
    v_xor_b32 v7, 2, v7
    v_lshl_add_u32 v235, v7, 4, v6
    s_mul_i32 s21, s3, 458752
    s_lshl_b32 s6, s100, 6
    s_add_u32 s21, s21, s6
    s_lshl_b32 s22, s100, 15
    s_lshl_b32 s6, s3, 8
    s_add_u32 s22, s22, s6
    s_lshl_b32 s6, s3, 13
    s_add_u32 s23, s6, 32768
    v_lshlrev_b32 v6, 4, v5
    v_lshlrev_b32 v7, 5, v12
    v_xor_b32 v6, v6, v7
    v_lshl_add_u32 v238, v12, 10, v6
    v_xor_b32 v239, 0x80, v238
    v_and_b32 v6, 1, v12
    v_and_b32 v7, 2, v14
    v_or_b32 v6, v6, v7
    v_xor_b32 v6, s3, v6
    v_lshlrev_b32 v6, 4, v6
    v_lshl_add_u32 v6, v15, 6, v6
    v_and_b32 v8, 1, v14
    v_lshl_add_u32 v6, v8, 3, v6
    v_lshl_add_u32 v6, v7, 14, v6
    v_add_u32 v236, 32768, v6
    v_and_b32 v6, 1, v12
    v_lshl_add_u32 v6, v6, 2, v13
    v_lshlrev_b32 v6, 5, v6
    v_lshl_add_u32 v6, v15, 8, v6
    v_lshl_add_u32 v6, v14, 3, v6
    s_lshl_b32 s6, s3, 13
    s_add_u32 s6, s6, 98304
    v_add_u32 v237, s6, v6
    s_mov_b32 s7, 0
L_fl_277:
    ds_read_b32 v4, v245 offset:32
    s_add_u32 s7, s7, 1
    s_cmp_gt_u32 s7, 33554432
    s_cbranch_scc1 L_flok_278
    s_waitcnt lgkmcnt(0)
    v_cmp_le_u32 vcc, 2, v4
    s_cbranch_vccnz L_flok_278
    s_sleep 1
    s_branch L_fl_277
L_flok_278:
    s_waitcnt lgkmcnt(0)
    s_add_u32 m0, s23, 0
    s_add_u32 s6, s21, 0
    buffer_load_dwordx4 v234, s[32:35], s6 offen nt lds
    s_add_u32 m0, s23, 32768
    s_nop 0
    buffer_load_dwordx4 v235, s[36:39], s6 offen nt lds
    s_add_u32 m0, s23, 1024
    s_add_u32 s6, s21, 57344
    buffer_load_dwordx4 v234, s[32:35], s6 offen nt lds
    s_add_u32 m0, s23, 33792
    s_nop 0
    buffer_load_dwordx4 v235, s[36:39], s6 offen nt lds
    s_add_u32 m0, s23, 2048
    s_add_u32 s6, s21, 114688
    buffer_load_dwordx4 v234, s[32:35], s6 offen nt lds
    s_add_u32 m0, s23, 34816
    s_nop 0
    buffer_load_dwordx4 v235, s[36:39], s6 offen nt lds
    s_add_u32 m0, s23, 3072
    s_add_u32 s6, s21, 172032
    buffer_load_dwordx4 v234, s[32:35], s6 offen nt lds
    s_add_u32 m0, s23, 35840
    s_nop 0
    buffer_load_dwordx4 v235, s[36:39], s6 offen nt lds
    s_add_u32 m0, s23, 4096
    s_add_u32 s6, s21, 229376
    buffer_load_dwordx4 v234, s[32:35], s6 offen nt lds
    s_add_u32 m0, s23, 36864
    s_nop 0
    buffer_load_dwordx4 v235, s[36:39], s6 offen nt lds
    s_add_u32 m0, s23, 5120
    s_add_u32 s6, s21, 286720
    buffer_load_dwordx4 v234, s[32:35], s6 offen nt lds
    s_add_u32 m0, s23, 37888
    s_nop 0
    buffer_load_dwordx4 v235, s[36:39], s6 offen nt lds
    s_add_u32 m0, s23, 6144
    s_add_u32 s6, s21, 344064
    buffer_load_dwordx4 v234, s[32:35], s6 offen nt lds
    s_add_u32 m0, s23, 38912
    s_nop 0
    buffer_load_dwordx4 v235, s[36:39], s6 offen nt lds
    s_add_u32 m0, s23, 7168
    s_add_u32 s6, s21, 401408
    buffer_load_dwordx4 v234, s[32:35], s6 offen nt lds
    s_add_u32 m0, s23, 39936
    s_nop 0
    buffer_load_dwordx4 v235, s[36:39], s6 offen nt lds
    s_add_u32 m0, s23, 65536
    s_add_u32 s6, s22, 0
    buffer_load_dwordx4 v238, s[40:43], s6 offen nt lds
    s_add_u32 m0, s23, 66560
    s_add_u32 s6, s22, 4096
    buffer_load_dwordx4 v238, s[40:43], s6 offen nt lds
    s_add_u32 m0, s23, 67584
    s_add_u32 s6, s22, 8192
    buffer_load_dwordx4 v239, s[40:43], s6 offen nt lds
    s_add_u32 m0, s23, 68608
    s_add_u32 s6, s22, 12288
    buffer_load_dwordx4 v239, s[40:43], s6 offen nt lds
    s_add_u32 m0, s23, 69632
    s_add_u32 s6, s22, 16384
    buffer_load_dwordx4 v238, s[40:43], s6 offen nt lds
    s_add_u32 m0, s23, 70656
    s_add_u32 s6, s22, 20480
    buffer_load_dwordx4 v238, s[40:43], s6 offen nt lds
    s_add_u32 m0, s23, 71680
    s_add_u32 s6, s22, 24576
    buffer_load_dwordx4 v239, s[40:43], s6 offen nt lds
    s_add_u32 m0, s23, 72704
    s_add_u32 s6, s22, 28672
    buffer_load_dwordx4 v239, s[40:43], s6 offen nt lds
    v_xor_b32 v209, 32, v237
    v_xor_b32 v210, 64, v237
    v_xor_b32 v211, 96, v237
    v_xor_b32 v212, 128, v237
    v_xor_b32 v213, 160, v237
    v_xor_b32 v214, 192, v237
    v_xor_b32 v215, 224, v237
    s_waitcnt vmcnt(8)
    s_mov_b64 exec, 1
    ds_add_u32 v245, v240 offset:40
    s_mov_b64 exec, -1
    s_mov_b32 s7, 0
L_fl_279:
    ds_read_b32 v4, v245 offset:40
    s_add_u32 s7, s7, 1
    s_cmp_gt_u32 s7, 33554432
    s_cbranch_scc1 L_flok_280
    s_waitcnt lgkmcnt(0)
    v_cmp_le_u32 vcc, 4, v4
    s_cbranch_vccnz L_flok_280
    s_branch L_fl_279
L_flok_280:
    s_waitcnt lgkmcnt(0)
    ds_read_b64_tr_b16 v[32:33], v236 offset:0
    ds_read_b64_tr_b16 v[34:35], v236 offset:256
    ds_read_b64_tr_b16 v[36:37], v236 offset:2048
    ds_read_b64_tr_b16 v[38:39], v236 offset:2304
    ds_read_b64_tr_b16 v[40:41], v236 offset:4096
    ds_read_b64_tr_b16 v[42:43], v236 offset:4352
    ds_read_b64_tr_b16 v[44:45], v236 offset:6144
    ds_read_b64_tr_b16 v[46:47], v236 offset:6400
    ds_read_b64_tr_b16 v[48:49], v236 offset:8192
    ds_read_b64_tr_b16 v[50:51], v236 offset:8448
    ds_read_b64_tr_b16 v[52:53], v236 offset:10240
    ds_read_b64_tr_b16 v[54:55], v236 offset:10496
    ds_read_b64_tr_b16 v[56:57], v236 offset:12288
    ds_read_b64_tr_b16 v[58:59], v236 offset:12544
    s_waitcnt lgkmcnt(8)
    ds_read_b64_tr_b16 v[60:61], v236 offset:14336
    ds_read_b64_tr_b16 v[62:63], v236 offset:14592
    ds_read_b64_tr_b16 v[64:65], v236 offset:16384
    ds_read_b64_tr_b16 v[66:67], v236 offset:16640
    s_waitcnt lgkmcnt(8)
    ds_read_b64_tr_b16 v[68:69], v236 offset:18432
    ds_read_b64_tr_b16 v[70:71], v236 offset:18688
    ds_read_b64_tr_b16 v[72:73], v236 offset:20480
    ds_read_b64_tr_b16 v[74:75], v236 offset:20736
    s_waitcnt lgkmcnt(8)
    ds_read_b64_tr_b16 v[76:77], v236 offset:22528
    ds_read_b64_tr_b16 v[78:79], v236 offset:22784
    ds_read_b64_tr_b16 v[80:81], v236 offset:24576
    ds_read_b64_tr_b16 v[82:83], v236 offset:24832
    s_waitcnt lgkmcnt(8)
    ds_read_b64_tr_b16 v[84:85], v236 offset:26624
    ds_read_b64_tr_b16 v[86:87], v236 offset:26880
    ds_read_b64_tr_b16 v[88:89], v236 offset:28672
    ds_read_b64_tr_b16 v[90:91], v236 offset:28928
    s_waitcnt lgkmcnt(8)
    ds_read_b64_tr_b16 v[92:93], v236 offset:30720
    ds_read_b64_tr_b16 v[94:95], v236 offset:30976
    s_waitcnt vmcnt(0) lgkmcnt(0)
    ds_read_b64_tr_b16 v[96:97], v237
    ds_read_b64_tr_b16 v[98:99], v237 offset:1024
    ds_read_b64_tr_b16 v[100:101], v209
    ds_read_b64_tr_b16 v[102:103], v209 offset:1024
    ds_read_b64_tr_b16 v[104:105], v210
    ds_read_b64_tr_b16 v[106:107], v210 offset:1024
    ds_read_b64_tr_b16 v[108:109], v211
    ds_read_b64_tr_b16 v[110:111], v211 offset:1024
    ds_read_b64_tr_b16 v[112:113], v212
    ds_read_b64_tr_b16 v[114:115], v212 offset:1024
    s_waitcnt lgkmcnt(8)
    ds_read_b64_tr_b16 v[116:117], v213
    ds_read_b64_tr_b16 v[118:119], v213 offset:1024
    ds_read_b64_tr_b16 v[120:121], v214
    ds_read_b64_tr_b16 v[122:123], v214 offset:1024
    s_waitcnt lgkmcnt(8)
    ds_read_b64_tr_b16 v[124:125], v215
    ds_read_b64_tr_b16 v[126:127], v215 offset:1024
    s_waitcnt lgkmcnt(0)
    s_barrier
    ds_read_b128 v[4:7], v229
    ds_read_b128 v[128:131], v228 offset:0
    ds_read_b128 v[132:135], v228 offset:64
    ds_read_b128 v[136:139], v228 offset:128
    ds_read_b128 v[140:143], v228 offset:192
    ds_read_b128 v[144:147], v228 offset:256
    ds_read_b128 v[148:151], v228 offset:320
    ds_read_b128 v[152:155], v228 offset:384
    ds_read_b128 v[156:159], v228 offset:448
    ds_read_b128 v[160:163], v228 offset:512
    ds_read_b128 v[164:167], v228 offset:576
    ds_read_b128 v[168:171], v228 offset:640
    ds_read_b128 v[172:175], v228 offset:704
    ds_read_b128 v[176:179], v228 offset:768
    ds_read_b128 v[180:183], v228 offset:832
    s_waitcnt lgkmcnt(13)
    v_mfma_f32_16x16x32_bf16 v[8:11], v[128:131], v[32:35], 0
    ds_read_b128 v[184:187], v228 offset:896
    ds_read_b128 v[188:191], v228 offset:960
    v_dot2_f32_bf16 v200, v4, v233, 0
    v_dot2_f32_bf16 v201, v4, v4, 0
    v_dot2_f32_bf16 v200, v5, v233, v200
    s_waitcnt lgkmcnt(13)
    v_mfma_f32_16x16x32_bf16 v[8:11], v[132:135], v[36:39], v[8:11]
    v_dot2_f32_bf16 v201, v5, v5, v201
    v_dot2_f32_bf16 v200, v6, v233, v200
    v_dot2_f32_bf16 v201, v6, v6, v201
    v_mfma_f32_16x16x32_bf16 v[8:11], v[136:139], v[40:43], v[8:11]
    v_dot2_f32_bf16 v200, v7, v233, v200
    v_dot2_f32_bf16 v201, v7, v7, v201
    s_nop 1
    v_add_f32_dpp v200, v200, v200 row_ror:8 row_mask:0xf bank_mask:0xf
    s_waitcnt lgkmcnt(11)
    v_mfma_f32_16x16x32_bf16 v[8:11], v[140:143], v[44:47], v[8:11]
    v_add_f32_dpp v201, v201, v201 row_ror:8 row_mask:0xf bank_mask:0xf
    v_add_f32_dpp v200, v200, v200 row_ror:4 row_mask:0xf bank_mask:0xf
    s_nop 0
    v_add_f32_dpp v201, v201, v201 row_ror:4 row_mask:0xf bank_mask:0xf
    v_mfma_f32_16x16x32_bf16 v[8:11], v[144:147], v[48:51], v[8:11]
    v_add_f32_dpp v200, v200, v200 row_ror:2 row_mask:0xf bank_mask:0xf
    v_add_f32_dpp v201, v201, v201 row_ror:2 row_mask:0xf bank_mask:0xf
    s_nop 0
    v_add_f32_dpp v200, v200, v200 row_ror:1 row_mask:0xf bank_mask:0xf
    s_waitcnt lgkmcnt(9)
    v_mfma_f32_16x16x32_bf16 v[8:11], v[148:151], v[52:55], v[8:11]
    v_add_f32_dpp v201, v201, v201 row_ror:1 row_mask:0xf bank_mask:0xf
    v_mov_b32 v202, v200
    v_mov_b32 v203, v201
    v_mfma_f32_16x16x32_bf16 v[8:11], v[152:155], v[56:59], v[8:11]
    v_permlane16_swap_b32 v200, v202
    v_permlane16_swap_b32 v201, v203
    v_add_f32 v200, v200, v202
    s_waitcnt lgkmcnt(7)
    v_mfma_f32_16x16x32_bf16 v[8:11], v[156:159], v[60:63], v[8:11]
    v_add_f32 v201, v201, v203
    v_mov_b32 v202, v200
    v_mov_b32 v203, v201
    v_mfma_f32_16x16x32_bf16 v[8:11], v[160:163], v[64:67], v[8:11]
    v_permlane32_swap_b32 v200, v202
    v_permlane32_swap_b32 v201, v203
    v_add_f32 v200, v200, v202
    s_waitcnt lgkmcnt(5)
    v_mfma_f32_16x16x32_bf16 v[8:11], v[164:167], v[68:71], v[8:11]
    v_add_f32 v201, v201, v203
    v_mul_f32 v200, 0x3b000000, v200
    v_mul_f32 v201, 0x3b000000, v201
    v_mfma_f32_16x16x32_bf16 v[8:11], v[168:171], v[72:75], v[8:11]
    v_fma_f32 v201, -v200, v200, v201
    v_max_f32 v201, 0, v201
    v_cvt_pk_bf16_f32 v202, v200, v201
    s_waitcnt lgkmcnt(3)
    v_mfma_f32_16x16x32_bf16 v[8:11], v[172:175], v[76:79], v[8:11]
    v_lshlrev_b32 v200, 16, v202
    v_and_b32 v201, s60, v202
    v_add_f32 v201, 0x3727c5ac, v201
    v_mfma_f32_16x16x32_bf16 v[8:11], v[176:179], v[80:83], v[8:11]
    v_cvt_pk_bf16_f32 v202, v201, v201
    v_and_b32 v201, s60, v202
    v_sqrt_f32 v201, v201
    s_waitcnt lgkmcnt(1)
    v_mfma_f32_16x16x32_bf16 v[8:11], v[180:183], v[84:87], v[8:11]
    v_cvt_pk_bf16_f32 v202, v201, v201
    v_and_b32 v201, s60, v202
    v_rcp_f32 v201, v201
    v_mfma_f32_16x16x32_bf16 v[8:11], v[184:187], v[88:91], v[8:11]
    s_waitcnt lgkmcnt(0)
    v_mfma_f32_16x16x32_bf16 v[8:11], v[188:191], v[92:95], v[8:11]
    s_nop 7
    v_fma_f32 v4, -v200, v9, v8
    v_mul_f32 v4, v4, v201
    v_mul_f32 v5, s59, v4
    v_exp_f32 v5, -v5
    v_mov_b32_dpp v6, v4 row_ror:8 row_mask:0xf bank_mask:0xf
    v_add_f32 v5, 1.0, v5
    v_rcp_f32 v5, v5
    s_nop 0
    v_mul_f32 v5, v5, v6
    v_cvt_pk_bf16_f32 v5, v5, v5
    s_mov_b64 exec, 0xff
    ds_write_b16 v230, v5
    s_mov_b64 exec, -1
    s_waitcnt lgkmcnt(0)
    s_barrier
    ds_read_b128 v[192:195], v231 offset:448
    ds_read_b128 v[196:199], v231 offset:384
    ds_read_b128 v[200:203], v231 offset:320
    ds_read_b128 v[204:207], v231 offset:256
    ds_read_b128 v[208:211], v231 offset:192
    ds_read_b128 v[212:215], v231 offset:128
    ds_read_b128 v[216:219], v231 offset:64
    ds_read_b128 v[220:223], v231 offset:0
    s_waitcnt lgkmcnt(7)
    v_mfma_f32_16x16x32_bf16 v[8:11], v[96:99], v[192:195], 0
    s_waitcnt lgkmcnt(6)
    v_mfma_f32_16x16x32_bf16 v[8:11], v[100:103], v[196:199], v[8:11]
    s_waitcnt lgkmcnt(5)
    v_mfma_f32_16x16x32_bf16 v[8:11], v[104:107], v[200:203], v[8:11]
    s_waitcnt lgkmcnt(4)
    v_mfma_f32_16x16x32_bf16 v[8:11], v[108:111], v[204:207], v[8:11]
    s_waitcnt lgkmcnt(3)
    v_mfma_f32_16x16x32_bf16 v[8:11], v[112:115], v[208:211], v[8:11]
    s_waitcnt lgkmcnt(2)
    v_mfma_f32_16x16x32_bf16 v[8:11], v[116:119], v[212:215], v[8:11]
    s_waitcnt lgkmcnt(1)
    v_mfma_f32_16x16x32_bf16 v[8:11], v[120:123], v[216:219], v[8:11]
    s_waitcnt lgkmcnt(0)
    v_mfma_f32_16x16x32_bf16 v[8:11], v[124:127], v[220:223], v[8:11]
    s_mov_b32 exec_lo, 0x00ff00ff
    s_mov_b32 exec_hi, 0x00ff00ff
    s_nop 5
    buffer_store_dwordx4 v[8:11], v232, s[16:19], s76 offen sc1
L_end:
    s_endpgm
L_code_end:
.section .rodata,"a"
.p2align 6
.amdhsa_kernel sequential_preLN__gqa_block_cached__glu_gated_glu__decode_kernel
  .amdhsa_next_free_vgpr 256
  .amdhsa_next_free_sgpr 102
  .amdhsa_accum_offset 256
  .amdhsa_group_segment_fixed_size 0
  .amdhsa_kernarg_size 96
  .amdhsa_user_sgpr_count 2
  .amdhsa_user_sgpr_kernarg_segment_ptr 1
  .amdhsa_system_sgpr_workgroup_id_x 1
.end_amdhsa_kernel
```
